```python
import torch

def _softmax(x, axis=-1):
    return torch.softmax(x, dim=axis)
def _gelu(x):
    return torch.nn.functional.gelu(x, approximate="tanh")
def _silu(x):
    return torch.nn.functional.silu(x)
def _sigmoid(x):
    return torch.sigmoid(x)
def _layernorm(x, axis=-1, eps=1e-5):
    m = x.mean(dim=axis, keepdim=True)
    v = x.var(dim=axis, keepdim=True, unbiased=False)
    return (x - m) / torch.sqrt(v + eps)
def _scatter_add(tgt, idx, src, axis=0):
    return tgt.clone().index_add_(axis, idx, src)
def _segment_sum(src, seg, n):
    out = torch.zeros((n,) + src.shape[1:], dtype=src.dtype)
    return out.index_add_(0, seg, src)
def _pad(x, pw):
    flat = tuple(v for pair in reversed(pw) for v in pair)
    return torch.nn.functional.pad(x, flat)

kernel_name = 'gated_mix__softmax_full_mha__swiglu_ffn__prompt'

def setup_inputs():

    _w = (lambda a: (lambda t: t.to(torch.bfloat16) if t.is_floating_point() else t)(torch.as_tensor(a)))
    def _A_setup():
        B, S, D = 1, 2048, 512
        return {
            "x": _w((lambda *s: torch.randn(*s, dtype=torch.bfloat16) * 0.05)(B, S, D)),
            "wqkv": _w((lambda *s: torch.randn(*s, dtype=torch.bfloat16) * 0.8)(D, 3 * D)),
            "wo": _w((lambda *s: torch.randn(*s, dtype=torch.bfloat16) * 0.05)(D, D)),
        }
    _A_in = _A_setup()

    def _B_setup():
        B, S, D, F = 1, 2048, 512, 1376
        return {
            "x": _w((lambda *s: torch.randn(*s, dtype=torch.bfloat16) * 0.05)(B, S, D)),
            "w_gate": _w((lambda *s: torch.randn(*s, dtype=torch.bfloat16) * 0.1)(D, F)),
            "w_up": _w((lambda *s: torch.randn(*s, dtype=torch.bfloat16) * 0.1)(D, F)),
            "w_down": _w((lambda *s: torch.randn(*s, dtype=torch.bfloat16) * 0.1)(F, D)),
        }
    _B_in = _B_setup()

    return {
        "A_x": _A_in["x"],
        "A_wqkv": _A_in["wqkv"],
        "A_wo": _A_in["wo"],
        "B_x": _B_in["x"],
        "B_w_gate": _B_in["w_gate"],
        "B_w_up": _B_in["w_up"],
        "B_w_down": _B_in["w_down"],
        "gate_w": _w((lambda *s: torch.randn(*s, dtype=torch.bfloat16) * 0.05)(512) * 16.0),
    }

def reference(A_x, A_wqkv, A_wo, B_x, B_w_gate, B_w_up, B_w_down, gate_w):
    def _A_ref(x, wqkv, wo):
        B, S, D = x.shape
        H = 32; Dh = D // H
        qkv = (lambda x, *d: x.permute(*d))((x @ wqkv).reshape(B, S, 3, H, Dh), 2, 0, 3, 1, 4)
        q, k, v = qkv[0], qkv[1], qkv[2]
        scale = Dh ** -0.5
        scores = torch.einsum("bhqd,bhkd->bhqk", q, k) * scale
        p = _softmax(scores, axis=-1)
        o = torch.einsum("bhqk,bhkd->bhqd", p, v)
        return (lambda x, *d: x.permute(*d))(o, 0, 2, 1, 3).reshape(B, S, D) @ wo

    def _B_ref(x, w_gate, w_up, w_down):
        g = _silu(x @ w_gate)
        u = x @ w_up
        return (g * u) @ w_down

    x = A_x
    g = _sigmoid((x * gate_w).sum(-1, keepdims=True))
    a = _A_ref(x, A_wqkv, A_wo)
    b = _B_ref(x, B_w_gate, B_w_up, B_w_down)
    return g * a + (1 - g) * b
```

```asm
; @launch kernel=k1_qkv_kernel grid=(256,1,1) block=(256,1,1) lds=81920
; @launch kernel=k2_mix_kernel grid=(512,1,1) block=(256,1,1) lds=81920
.amdgcn_target "amdgcn-amd-amdhsa--gfx950"
.text
.globl k1_qkv_kernel
.p2align 8
.type k1_qkv_kernel,@function
k1_qkv_kernel:
  s_cmp_ge_u32 s2, 0x100
  s_cbranch_scc1 k1_qkv_kernel_end
  s_load_dwordx16 s[16:31], s[0:1], 0
  s_load_dwordx2 s[32:33], s[0:1], 64
  s_load_dwordx2 s[34:35], s[0:1], 80
  s_waitcnt lgkmcnt(0)
  v_and_b32 v1, 63, v0
  v_lshrrev_b32 v2, 6, v0
  s_nop 0
  v_readfirstlane_b32 s60, v2
  v_and_b32 v3, 31, v1
  v_lshrrev_b32 v4, 5, v1
  s_and_b32 s3, s2, 7
  s_lshr_b32 s4, s2, 3
  s_and_b32 s5, s3, 1
  s_lshl_b32 s5, s5, 2
  s_and_b32 s6, s4, 3
  s_add_u32 s62, s5, s6
  s_lshr_b32 s5, s3, 1
  s_lshl_b32 s5, s5, 3
  s_lshr_b32 s6, s4, 2
  s_add_u32 s61, s5, s6
  s_mov_b32 s40, s16
  s_mov_b32 s41, s17
  s_mov_b32 s42, 0x200000
  s_mov_b32 s43, 0x20000
  s_mov_b32 s44, s18
  s_mov_b32 s45, s19
  s_mov_b32 s46, 0x180000
  s_mov_b32 s47, 0x20000
  v_lshlrev_b32 v7, 4, v1
  v_lshrrev_b32 v30, 3, v1
  s_lshl_b32 s68, s61, 6
  s_lshl_b32 s69, s60, 4
  s_add_u32 s68, s68, s69
  v_add_u32 v30, s68, v30
  v_lshlrev_b32 v30, 10, v30
  v_and_b32 v31, 7, v1
  v_lshrrev_b32 v32, 4, v1
  v_xor_b32 v33, v31, v32
  v_xor_b32 v34, 4, v33
  v_lshlrev_b32 v33, 4, v33
  v_lshlrev_b32 v34, 4, v34
  v_add_u32 v35, v30, v33
  v_add_u32 v36, v30, v34
  v_add_u32 v36, 0x2000, v36
  s_lshl_b32 s69, s60, 11
  s_add_u32 s69, s69, 49152
  s_add_u32 m0, s69, 0
  s_movk_i32 s71, 0
  buffer_load_dwordx4 v35, s[40:43], s71 offen lds
  s_add_u32 m0, s69, 1024
  s_movk_i32 s71, 0
  buffer_load_dwordx4 v36, s[40:43], s71 offen lds
  v_lshrrev_b32 v28, 3, v1
  v_and_b32 v29, 3, v28
  v_lshlrev_b32 v29, 1, v29
  v_xor_b32 v29, v31, v29
  v_lshlrev_b32 v29, 4, v29
  s_lshl_b32 s68, s60, 3
  v_add_u32 v28, s68, v28
  v_mul_u32_u24 v28, 3072, v28
  v_add_u32 v28, v28, v29
  s_lshl_b32 s68, s62, 7
  v_add_u32 v28, s68, v28
  s_lshl_b32 s70, s60, 10
  s_add_u32 m0, s70, 0
  s_mov_b32 s71, 0
  buffer_load_dwordx4 v28, s[44:47], s71 offen lds
  s_add_u32 m0, s70, 4096
  s_mov_b32 s71, 1024
  buffer_load_dwordx4 v28, s[44:47], s71 offen lds
  s_add_u32 m0, s70, 8192
  s_mov_b32 s71, 2048
  buffer_load_dwordx4 v28, s[44:47], s71 offen lds
  s_mov_b32 s48, s34
  s_mov_b32 s49, s35
  s_mov_b32 s50, 0x1600000
  s_mov_b32 s51, 0x20000
  s_mov_b32 s56, s30
  s_mov_b32 s57, s31
  s_mov_b32 s58, 0x400
  s_mov_b32 s59, 0x20000
  v_lshlrev_b32 v7, 4, v1
  s_lshl_b32 s64, s61, 6
  s_lshl_b32 s65, s62, 3
  s_add_u32 s64, s64, s65
  s_lshl_b32 s65, s60, 1
  s_add_u32 s64, s64, s65
  s_lshl_b32 s67, s64, 10
  s_mov_b32 s52, s67
  buffer_load_dwordx4 v[16:19], v7, s[40:43], s52 offen
  buffer_load_dwordx4 v[20:23], v7, s[40:43], s52 offen offset:1024
  buffer_load_dwordx4 v[24:27], v7, s[56:59], 0 offen
  s_add_u32 m0, s70, 12288
  s_mov_b32 s71, 98304
  buffer_load_dwordx4 v28, s[44:47], s71 offen lds
  s_add_u32 m0, s70, 16384
  s_mov_b32 s71, 99328
  buffer_load_dwordx4 v28, s[44:47], s71 offen lds
  s_add_u32 m0, s70, 20480
  s_mov_b32 s71, 100352
  buffer_load_dwordx4 v28, s[44:47], s71 offen lds
  s_add_u32 m0, s69, 8192
  s_movk_i32 s71, 128
  buffer_load_dwordx4 v35, s[40:43], s71 offen lds
  s_add_u32 m0, s69, 9216
  s_movk_i32 s71, 128
  buffer_load_dwordx4 v36, s[40:43], s71 offen lds
  s_add_u32 m0, s70, 24576
  s_mov_b32 s71, 196608
  buffer_load_dwordx4 v28, s[44:47], s71 offen lds
  s_add_u32 m0, s70, 28672
  s_mov_b32 s71, 197632
  buffer_load_dwordx4 v28, s[44:47], s71 offen lds
  s_add_u32 m0, s70, 32768
  s_mov_b32 s71, 198656
  buffer_load_dwordx4 v28, s[44:47], s71 offen lds
  s_add_u32 m0, s70, 36864
  s_mov_b32 s71, 294912
  buffer_load_dwordx4 v28, s[44:47], s71 offen lds
  s_add_u32 m0, s70, 40960
  s_mov_b32 s71, 295936
  buffer_load_dwordx4 v28, s[44:47], s71 offen lds
  s_add_u32 m0, s70, 45056
  s_mov_b32 s71, 296960
  buffer_load_dwordx4 v28, s[44:47], s71 offen lds
  s_add_u32 m0, s69, 16384
  s_movk_i32 s71, 256
  buffer_load_dwordx4 v35, s[40:43], s71 offen lds
  s_add_u32 m0, s69, 17408
  s_movk_i32 s71, 256
  buffer_load_dwordx4 v36, s[40:43], s71 offen lds
  s_lshr_b32 s54, s2, 3
  s_and_b32 s54, s54, 31
  s_lshl_b32 s54, s54, 2
  s_add_u32 s54, s54, s60
  v_lshrrev_b32 v60, 5, v1
  v_mul_u32_u24 v60, 3072, v60
  v_and_b32 v61, 31, v1
  v_lshlrev_b32 v61, 4, v61
  v_add_u32 v60, v60, v61
  s_mul_i32 s55, s54, 12288
  s_and_b32 s53, s2, 1
  s_lshl_b32 s53, s53, 9
  s_add_u32 s55, s55, s53
  s_add_u32 s53, s55, 0
  buffer_load_dwordx4 v[152:155], v60, s[44:47], s53 offen
  s_add_u32 s53, s55, 1024
  buffer_load_dwordx4 v[152:155], v60, s[44:47], s53 offen
  s_add_u32 s53, s55, 2048
  buffer_load_dwordx4 v[152:155], v60, s[44:47], s53 offen
  s_add_u32 s53, s55, 6144
  buffer_load_dwordx4 v[152:155], v60, s[44:47], s53 offen
  s_add_u32 s53, s55, 7168
  buffer_load_dwordx4 v[152:155], v60, s[44:47], s53 offen
  s_add_u32 s53, s55, 8192
  buffer_load_dwordx4 v[152:155], v60, s[44:47], s53 offen
  s_lshr_b32 s53, s2, 1
  s_and_b32 s53, s53, 3
  s_lshl_b32 s53, s53, 19
  s_lshl_b32 s55, s54, 12
  s_add_u32 s55, s55, s53
  buffer_load_dwordx4 v[152:155], v7, s[40:43], s55 offen offset:0
  buffer_load_dwordx4 v[152:155], v7, s[40:43], s55 offen offset:1024
  buffer_load_dwordx4 v[152:155], v7, s[40:43], s55 offen offset:2048
  buffer_load_dwordx4 v[152:155], v7, s[40:43], s55 offen offset:3072
  v_lshrrev_b32 v37, 1, v3
  v_and_b32 v37, 7, v37
  v_lshlrev_b32 v38, 7, v3
  s_and_b32 s66, s60, 1
  s_lshl_b32 s68, s66, 12
  s_add_u32 s68, s68, 49152
  v_add_u32 v38, s68, v38
  v_add_u32 v39, 0, v4
  v_xor_b32 v39, v39, v37
  v_lshlrev_b32 v39, 4, v39
  v_add_u32 v40, v38, v39
  v_xor_b32 v44, 0x1000, v40
  v_add_u32 v39, 2, v4
  v_xor_b32 v39, v39, v37
  v_lshlrev_b32 v39, 4, v39
  v_add_u32 v41, v38, v39
  v_xor_b32 v45, 0x1000, v41
  v_add_u32 v39, 4, v4
  v_xor_b32 v39, v39, v37
  v_lshlrev_b32 v39, 4, v39
  v_add_u32 v42, v38, v39
  v_xor_b32 v46, 0x1000, v42
  v_add_u32 v39, 6, v4
  v_xor_b32 v39, v39, v37
  v_lshlrev_b32 v39, 4, v39
  v_add_u32 v43, v38, v39
  v_xor_b32 v47, 0x1000, v43
  v_lshrrev_b32 v48, 1, v32
  v_lshlrev_b32 v48, 3, v48
  v_and_b32 v49, 15, v1
  v_lshrrev_b32 v50, 2, v49
  v_add_u32 v48, v48, v50
  v_lshlrev_b32 v48, 7, v48
  v_and_b32 v51, 3, v49
  v_lshlrev_b32 v51, 3, v51
  v_add_u32 v48, v48, v51
  v_and_b32 v51, 1, v32
  v_xor_b32 v52, s60, v50
  v_lshlrev_b32 v52, 5, v52
  v_lshlrev_b32 v53, 12, v51
  v_add_u32 v52, v52, v53
  v_add_u32 v52, v52, v48
  s_and_b32 s68, s60, 2
  v_add_u32 v53, s68, v51
  v_xor_b32 v53, v53, v50
  v_lshlrev_b32 v53, 5, v53
  v_add_u32 v53, v53, v48
  v_add_u32 v53, 0x2000, v53
  v_mov_b32 v64, 0
  v_mov_b32 v65, 0
  v_mov_b32 v66, 0
  v_mov_b32 v67, 0
  v_mov_b32 v68, 0
  v_mov_b32 v69, 0
  v_mov_b32 v70, 0
  v_mov_b32 v71, 0
  v_mov_b32 v72, 0
  v_mov_b32 v73, 0
  v_mov_b32 v74, 0
  v_mov_b32 v75, 0
  v_mov_b32 v76, 0
  v_mov_b32 v77, 0
  v_mov_b32 v78, 0
  v_mov_b32 v79, 0
  v_mov_b32 v80, 0
  v_mov_b32 v81, 0
  v_mov_b32 v82, 0
  v_mov_b32 v83, 0
  v_mov_b32 v84, 0
  v_mov_b32 v85, 0
  v_mov_b32 v86, 0
  v_mov_b32 v87, 0
  v_mov_b32 v88, 0
  v_mov_b32 v89, 0
  v_mov_b32 v90, 0
  v_mov_b32 v91, 0
  v_mov_b32 v92, 0
  v_mov_b32 v93, 0
  v_mov_b32 v94, 0
  v_mov_b32 v95, 0
  v_mov_b32 v96, 0
  v_mov_b32 v97, 0
  v_mov_b32 v98, 0
  v_mov_b32 v99, 0
  v_mov_b32 v100, 0
  v_mov_b32 v101, 0
  v_mov_b32 v102, 0
  v_mov_b32 v103, 0
  v_mov_b32 v104, 0
  v_mov_b32 v105, 0
  v_mov_b32 v106, 0
  v_mov_b32 v107, 0
  v_mov_b32 v108, 0
  v_mov_b32 v109, 0
  v_mov_b32 v110, 0
  v_mov_b32 v111, 0
  s_waitcnt vmcnt(23)
  v_lshlrev_b32 v56, 16, v16
  v_and_b32 v57, 0xffff0000, v16
  v_lshlrev_b32 v58, 16, v24
  v_and_b32 v59, 0xffff0000, v24
  v_mul_f32 v54, v56, v58
  v_fmac_f32 v54, v57, v59
  v_lshlrev_b32 v56, 16, v17
  v_and_b32 v57, 0xffff0000, v17
  v_lshlrev_b32 v58, 16, v25
  v_and_b32 v59, 0xffff0000, v25
  v_fmac_f32 v54, v56, v58
  v_fmac_f32 v54, v57, v59
  v_lshlrev_b32 v56, 16, v18
  v_and_b32 v57, 0xffff0000, v18
  v_lshlrev_b32 v58, 16, v26
  v_and_b32 v59, 0xffff0000, v26
  v_fmac_f32 v54, v56, v58
  v_fmac_f32 v54, v57, v59
  v_lshlrev_b32 v56, 16, v19
  v_and_b32 v57, 0xffff0000, v19
  v_lshlrev_b32 v58, 16, v27
  v_and_b32 v59, 0xffff0000, v27
  v_fmac_f32 v54, v56, v58
  v_fmac_f32 v54, v57, v59
  v_lshlrev_b32 v56, 16, v20
  v_and_b32 v57, 0xffff0000, v20
  v_lshlrev_b32 v58, 16, v24
  v_and_b32 v59, 0xffff0000, v24
  v_mul_f32 v55, v56, v58
  v_fmac_f32 v55, v57, v59
  v_lshlrev_b32 v56, 16, v21
  v_and_b32 v57, 0xffff0000, v21
  v_lshlrev_b32 v58, 16, v25
  v_and_b32 v59, 0xffff0000, v25
  v_fmac_f32 v55, v56, v58
  v_fmac_f32 v55, v57, v59
  v_lshlrev_b32 v56, 16, v22
  v_and_b32 v57, 0xffff0000, v22
  v_lshlrev_b32 v58, 16, v26
  v_and_b32 v59, 0xffff0000, v26
  v_fmac_f32 v55, v56, v58
  v_fmac_f32 v55, v57, v59
  v_lshlrev_b32 v56, 16, v23
  v_and_b32 v57, 0xffff0000, v23
  v_lshlrev_b32 v58, 16, v27
  v_and_b32 v59, 0xffff0000, v27
  v_fmac_f32 v55, v56, v58
  v_fmac_f32 v55, v57, v59
  v_add_f32_dpp v54, v54, v54 row_shr:1 row_mask:0xf bank_mask:0xf bound_ctrl:0
  s_nop 1
  v_add_f32_dpp v54, v54, v54 row_shr:2 row_mask:0xf bank_mask:0xf bound_ctrl:0
  s_nop 1
  v_add_f32_dpp v54, v54, v54 row_shr:4 row_mask:0xf bank_mask:0xf bound_ctrl:0
  s_nop 1
  v_add_f32_dpp v54, v54, v54 row_shr:8 row_mask:0xf bank_mask:0xf bound_ctrl:0
  s_nop 1
  v_add_f32_dpp v54, v54, v54 row_bcast:15 row_mask:0xa bank_mask:0xf bound_ctrl:0
  s_nop 1
  v_add_f32_dpp v54, v54, v54 row_bcast:31 row_mask:0xc bank_mask:0xf bound_ctrl:0
  v_add_f32_dpp v55, v55, v55 row_shr:1 row_mask:0xf bank_mask:0xf bound_ctrl:0
  s_nop 1
  v_add_f32_dpp v55, v55, v55 row_shr:2 row_mask:0xf bank_mask:0xf bound_ctrl:0
  s_nop 1
  v_add_f32_dpp v55, v55, v55 row_shr:4 row_mask:0xf bank_mask:0xf bound_ctrl:0
  s_nop 1
  v_add_f32_dpp v55, v55, v55 row_shr:8 row_mask:0xf bank_mask:0xf bound_ctrl:0
  s_nop 1
  v_add_f32_dpp v55, v55, v55 row_bcast:15 row_mask:0xa bank_mask:0xf bound_ctrl:0
  s_nop 1
  v_add_f32_dpp v55, v55, v55 row_bcast:31 row_mask:0xc bank_mask:0xf bound_ctrl:0
  v_mul_f32 v54, 0xbfb8aa3b, v54
  v_exp_f32 v54, v54
  s_nop 0
  v_add_f32 v54, 1.0, v54
  v_rcp_f32 v54, v54
  v_mul_f32 v55, 0xbfb8aa3b, v55
  v_exp_f32 v55, v55
  s_nop 0
  v_add_f32 v55, 1.0, v55
  v_rcp_f32 v55, v55
  v_cmp_eq_u32 vcc, 63, v1
  s_nop 3
  s_and_saveexec_b64 s[12:13], vcc
  s_lshl_b32 s72, s64, 2
  s_add_u32 s72, s72, 20979712
  v_mov_b32 v56, 0
  buffer_store_dwordx2 v[54:55], v56, s[48:51], s72 offen
  s_mov_b64 exec, s[12:13]
  s_lshl_b32 s14, s2, 2
  s_add_u32 s14, s14, s60
  s_lshl_b32 s14, s14, 10
  s_add_u32 s15, s14, 0x100000
  s_waitcnt vmcnt(24) lgkmcnt(0)
  s_barrier
  ds_read_b128 v[112:115], v40 offset:0
  ds_read_b128 v[116:119], v44 offset:0
  ds_read_b64_tr_b16 v[120:121], v52 offset:0
  ds_read_b64_tr_b16 v[122:123], v52 offset:512
  ds_read_b64_tr_b16 v[124:125], v53 offset:0
  ds_read_b64_tr_b16 v[126:127], v53 offset:512
  s_waitcnt lgkmcnt(0)
  ds_read_b128 v[128:131], v41 offset:0
  ds_read_b128 v[132:135], v45 offset:0
  ds_read_b64_tr_b16 v[136:137], v52 offset:2048
  ds_read_b64_tr_b16 v[138:139], v52 offset:2560
  ds_read_b64_tr_b16 v[140:141], v53 offset:2048
  ds_read_b64_tr_b16 v[142:143], v53 offset:2560
  v_mfma_f32_32x32x16_bf16 v[64:79], v[120:123], v[112:115], v[64:79]
  v_mfma_f32_32x32x16_bf16 v[80:95], v[120:123], v[116:119], v[80:95]
  v_mfma_f32_32x32x16_bf16 v[96:111], v[112:115], v[124:127], v[96:111]
  s_waitcnt vmcnt(21) lgkmcnt(0)
  s_barrier
  ds_read_b128 v[112:115], v42 offset:0
  ds_read_b128 v[116:119], v46 offset:0
  ds_read_b64_tr_b16 v[120:121], v52 offset:12288
  ds_read_b64_tr_b16 v[122:123], v52 offset:12800
  ds_read_b64_tr_b16 v[124:125], v53 offset:12288
  ds_read_b64_tr_b16 v[126:127], v53 offset:12800
  v_mfma_f32_32x32x16_bf16 v[64:79], v[136:139], v[128:131], v[64:79]
  v_mfma_f32_32x32x16_bf16 v[80:95], v[136:139], v[132:135], v[80:95]
  v_mfma_f32_32x32x16_bf16 v[96:111], v[128:131], v[140:143], v[96:111]
  s_add_u32 m0, s70, 0
  s_mov_b32 s71, 393216
  buffer_load_dwordx4 v28, s[44:47], s71 offen lds
  s_add_u32 m0, s70, 4096
  s_mov_b32 s71, 394240
  buffer_load_dwordx4 v28, s[44:47], s71 offen lds
  s_add_u32 m0, s70, 8192
  s_mov_b32 s71, 395264
  buffer_load_dwordx4 v28, s[44:47], s71 offen lds
  s_waitcnt lgkmcnt(0)
  ds_read_b128 v[128:131], v43 offset:0
  ds_read_b128 v[132:135], v47 offset:0
  ds_read_b64_tr_b16 v[136:137], v52 offset:14336
  ds_read_b64_tr_b16 v[138:139], v52 offset:14848
  ds_read_b64_tr_b16 v[140:141], v53 offset:14336
  ds_read_b64_tr_b16 v[142:143], v53 offset:14848
  v_mfma_f32_32x32x16_bf16 v[64:79], v[120:123], v[112:115], v[64:79]
  v_mfma_f32_32x32x16_bf16 v[80:95], v[120:123], v[116:119], v[80:95]
  v_mfma_f32_32x32x16_bf16 v[96:111], v[112:115], v[124:127], v[96:111]
  s_waitcnt vmcnt(19) lgkmcnt(0)
  s_barrier
  ds_read_b128 v[112:115], v40 offset:8192
  ds_read_b128 v[116:119], v44 offset:8192
  ds_read_b64_tr_b16 v[120:121], v52 offset:24576
  ds_read_b64_tr_b16 v[122:123], v52 offset:25088
  ds_read_b64_tr_b16 v[124:125], v53 offset:24576
  ds_read_b64_tr_b16 v[126:127], v53 offset:25088
  v_mfma_f32_32x32x16_bf16 v[64:79], v[136:139], v[128:131], v[64:79]
  v_mfma_f32_32x32x16_bf16 v[80:95], v[136:139], v[132:135], v[80:95]
  v_mfma_f32_32x32x16_bf16 v[96:111], v[128:131], v[140:143], v[96:111]
  s_add_u32 m0, s70, 12288
  s_mov_b32 s71, 491520
  buffer_load_dwordx4 v28, s[44:47], s71 offen lds
  s_add_u32 m0, s70, 16384
  s_mov_b32 s71, 492544
  buffer_load_dwordx4 v28, s[44:47], s71 offen lds
  s_add_u32 m0, s70, 20480
  s_mov_b32 s71, 493568
  buffer_load_dwordx4 v28, s[44:47], s71 offen lds
  s_add_u32 m0, s69, 0
  s_movk_i32 s71, 384
  buffer_load_dwordx4 v35, s[40:43], s71 offen lds
  s_add_u32 m0, s69, 1024
  s_movk_i32 s71, 384
  buffer_load_dwordx4 v36, s[40:43], s71 offen lds
  s_waitcnt lgkmcnt(0)
  ds_read_b128 v[128:131], v41 offset:8192
  ds_read_b128 v[132:135], v45 offset:8192
  ds_read_b64_tr_b16 v[136:137], v52 offset:26624
  ds_read_b64_tr_b16 v[138:139], v52 offset:27136
  ds_read_b64_tr_b16 v[140:141], v53 offset:26624
  ds_read_b64_tr_b16 v[142:143], v53 offset:27136
  v_mfma_f32_32x32x16_bf16 v[64:79], v[120:123], v[112:115], v[64:79]
  v_mfma_f32_32x32x16_bf16 v[80:95], v[120:123], v[116:119], v[80:95]
  v_mfma_f32_32x32x16_bf16 v[96:111], v[112:115], v[124:127], v[96:111]
  s_waitcnt vmcnt(21) lgkmcnt(0)
  s_barrier
  ds_read_b128 v[112:115], v42 offset:8192
  ds_read_b128 v[116:119], v46 offset:8192
  ds_read_b64_tr_b16 v[120:121], v52 offset:36864
  ds_read_b64_tr_b16 v[122:123], v52 offset:37376
  ds_read_b64_tr_b16 v[124:125], v53 offset:36864
  ds_read_b64_tr_b16 v[126:127], v53 offset:37376
  v_mfma_f32_32x32x16_bf16 v[64:79], v[136:139], v[128:131], v[64:79]
  v_mfma_f32_32x32x16_bf16 v[80:95], v[136:139], v[132:135], v[80:95]
  v_mfma_f32_32x32x16_bf16 v[96:111], v[128:131], v[140:143], v[96:111]
  s_add_u32 m0, s70, 24576
  s_mov_b32 s71, 589824
  buffer_load_dwordx4 v28, s[44:47], s71 offen lds
  s_add_u32 m0, s70, 28672
  s_mov_b32 s71, 590848
  buffer_load_dwordx4 v28, s[44:47], s71 offen lds
  s_add_u32 m0, s70, 32768
  s_mov_b32 s71, 591872
  buffer_load_dwordx4 v28, s[44:47], s71 offen lds
  s_waitcnt lgkmcnt(0)
  ds_read_b128 v[128:131], v43 offset:8192
  ds_read_b128 v[132:135], v47 offset:8192
  ds_read_b64_tr_b16 v[136:137], v52 offset:38912
  ds_read_b64_tr_b16 v[138:139], v52 offset:39424
  ds_read_b64_tr_b16 v[140:141], v53 offset:38912
  ds_read_b64_tr_b16 v[142:143], v53 offset:39424
  v_mfma_f32_32x32x16_bf16 v[64:79], v[120:123], v[112:115], v[64:79]
  v_mfma_f32_32x32x16_bf16 v[80:95], v[120:123], v[116:119], v[80:95]
  v_mfma_f32_32x32x16_bf16 v[96:111], v[112:115], v[124:127], v[96:111]
  s_waitcnt vmcnt(8) lgkmcnt(0)
  s_barrier
  ds_read_b128 v[112:115], v40 offset:16384
  ds_read_b128 v[116:119], v44 offset:16384
  ds_read_b64_tr_b16 v[120:121], v52 offset:0
  ds_read_b64_tr_b16 v[122:123], v52 offset:512
  ds_read_b64_tr_b16 v[124:125], v53 offset:0
  ds_read_b64_tr_b16 v[126:127], v53 offset:512
  v_mfma_f32_32x32x16_bf16 v[64:79], v[136:139], v[128:131], v[64:79]
  v_mfma_f32_32x32x16_bf16 v[80:95], v[136:139], v[132:135], v[80:95]
  v_mfma_f32_32x32x16_bf16 v[96:111], v[128:131], v[140:143], v[96:111]
  s_add_u32 m0, s70, 36864
  s_mov_b32 s71, 688128
  buffer_load_dwordx4 v28, s[44:47], s71 offen lds
  s_add_u32 m0, s70, 40960
  s_mov_b32 s71, 689152
  buffer_load_dwordx4 v28, s[44:47], s71 offen lds
  s_add_u32 m0, s70, 45056
  s_mov_b32 s71, 690176
  buffer_load_dwordx4 v28, s[44:47], s71 offen lds
  s_add_u32 m0, s69, 8192
  s_movk_i32 s71, 512
  buffer_load_dwordx4 v35, s[40:43], s71 offen lds
  s_add_u32 m0, s69, 9216
  s_movk_i32 s71, 512
  buffer_load_dwordx4 v36, s[40:43], s71 offen lds
  s_waitcnt lgkmcnt(0)
  ds_read_b128 v[128:131], v41 offset:16384
  ds_read_b128 v[132:135], v45 offset:16384
  ds_read_b64_tr_b16 v[136:137], v52 offset:2048
  ds_read_b64_tr_b16 v[138:139], v52 offset:2560
  ds_read_b64_tr_b16 v[140:141], v53 offset:2048
  ds_read_b64_tr_b16 v[142:143], v53 offset:2560
  v_mfma_f32_32x32x16_bf16 v[64:79], v[120:123], v[112:115], v[64:79]
  v_mfma_f32_32x32x16_bf16 v[80:95], v[120:123], v[116:119], v[80:95]
  v_mfma_f32_32x32x16_bf16 v[96:111], v[112:115], v[124:127], v[96:111]
  s_waitcnt vmcnt(10) lgkmcnt(0)
  s_barrier
  ds_read_b128 v[112:115], v42 offset:16384
  ds_read_b128 v[116:119], v46 offset:16384
  ds_read_b64_tr_b16 v[120:121], v52 offset:12288
  ds_read_b64_tr_b16 v[122:123], v52 offset:12800
  ds_read_b64_tr_b16 v[124:125], v53 offset:12288
  ds_read_b64_tr_b16 v[126:127], v53 offset:12800
  v_mfma_f32_32x32x16_bf16 v[64:79], v[136:139], v[128:131], v[64:79]
  v_mfma_f32_32x32x16_bf16 v[80:95], v[136:139], v[132:135], v[80:95]
  v_mfma_f32_32x32x16_bf16 v[96:111], v[128:131], v[140:143], v[96:111]
  s_add_u32 m0, s70, 0
  s_mov_b32 s71, 786432
  buffer_load_dwordx4 v28, s[44:47], s71 offen lds
  s_add_u32 m0, s70, 4096
  s_mov_b32 s71, 787456
  buffer_load_dwordx4 v28, s[44:47], s71 offen lds
  s_add_u32 m0, s70, 8192
  s_mov_b32 s71, 788480
  buffer_load_dwordx4 v28, s[44:47], s71 offen lds
  s_waitcnt lgkmcnt(0)
  ds_read_b128 v[128:131], v43 offset:16384
  ds_read_b128 v[132:135], v47 offset:16384
  ds_read_b64_tr_b16 v[136:137], v52 offset:14336
  ds_read_b64_tr_b16 v[138:139], v52 offset:14848
  ds_read_b64_tr_b16 v[140:141], v53 offset:14336
  ds_read_b64_tr_b16 v[142:143], v53 offset:14848
  v_mfma_f32_32x32x16_bf16 v[64:79], v[120:123], v[112:115], v[64:79]
  v_mfma_f32_32x32x16_bf16 v[80:95], v[120:123], v[116:119], v[80:95]
  v_mfma_f32_32x32x16_bf16 v[96:111], v[112:115], v[124:127], v[96:111]
  s_waitcnt vmcnt(8) lgkmcnt(0)
  s_barrier
  ds_read_b128 v[112:115], v40 offset:0
  ds_read_b128 v[116:119], v44 offset:0
  ds_read_b64_tr_b16 v[120:121], v52 offset:24576
  ds_read_b64_tr_b16 v[122:123], v52 offset:25088
  ds_read_b64_tr_b16 v[124:125], v53 offset:24576
  ds_read_b64_tr_b16 v[126:127], v53 offset:25088
  v_mfma_f32_32x32x16_bf16 v[64:79], v[136:139], v[128:131], v[64:79]
  v_mfma_f32_32x32x16_bf16 v[80:95], v[136:139], v[132:135], v[80:95]
  v_mfma_f32_32x32x16_bf16 v[96:111], v[128:131], v[140:143], v[96:111]
  s_add_u32 m0, s70, 12288
  s_mov_b32 s71, 884736
  buffer_load_dwordx4 v28, s[44:47], s71 offen lds
  s_add_u32 m0, s70, 16384
  s_mov_b32 s71, 885760
  buffer_load_dwordx4 v28, s[44:47], s71 offen lds
  s_add_u32 m0, s70, 20480
  s_mov_b32 s71, 886784
  buffer_load_dwordx4 v28, s[44:47], s71 offen lds
  s_add_u32 m0, s69, 16384
  s_movk_i32 s71, 640
  buffer_load_dwordx4 v35, s[40:43], s71 offen lds
  s_add_u32 m0, s69, 17408
  s_movk_i32 s71, 640
  buffer_load_dwordx4 v36, s[40:43], s71 offen lds
  s_waitcnt lgkmcnt(0)
  ds_read_b128 v[128:131], v41 offset:0
  ds_read_b128 v[132:135], v45 offset:0
  ds_read_b64_tr_b16 v[136:137], v52 offset:26624
  ds_read_b64_tr_b16 v[138:139], v52 offset:27136
  ds_read_b64_tr_b16 v[140:141], v53 offset:26624
  ds_read_b64_tr_b16 v[142:143], v53 offset:27136
  v_mfma_f32_32x32x16_bf16 v[64:79], v[120:123], v[112:115], v[64:79]
  v_mfma_f32_32x32x16_bf16 v[80:95], v[120:123], v[116:119], v[80:95]
  v_mfma_f32_32x32x16_bf16 v[96:111], v[112:115], v[124:127], v[96:111]
  s_waitcnt vmcnt(10) lgkmcnt(0)
  s_barrier
  ds_read_b128 v[112:115], v42 offset:0
  ds_read_b128 v[116:119], v46 offset:0
  ds_read_b64_tr_b16 v[120:121], v52 offset:36864
  ds_read_b64_tr_b16 v[122:123], v52 offset:37376
  ds_read_b64_tr_b16 v[124:125], v53 offset:36864
  ds_read_b64_tr_b16 v[126:127], v53 offset:37376
  v_mfma_f32_32x32x16_bf16 v[64:79], v[136:139], v[128:131], v[64:79]
  v_mfma_f32_32x32x16_bf16 v[80:95], v[136:139], v[132:135], v[80:95]
  v_mfma_f32_32x32x16_bf16 v[96:111], v[128:131], v[140:143], v[96:111]
  s_add_u32 m0, s70, 24576
  s_mov_b32 s71, 983040
  buffer_load_dwordx4 v28, s[44:47], s71 offen lds
  s_add_u32 m0, s70, 28672
  s_mov_b32 s71, 984064
  buffer_load_dwordx4 v28, s[44:47], s71 offen lds
  s_add_u32 m0, s70, 32768
  s_mov_b32 s71, 985088
  buffer_load_dwordx4 v28, s[44:47], s71 offen lds
  s_waitcnt lgkmcnt(0)
  ds_read_b128 v[128:131], v43 offset:0
  ds_read_b128 v[132:135], v47 offset:0
  ds_read_b64_tr_b16 v[136:137], v52 offset:38912
  ds_read_b64_tr_b16 v[138:139], v52 offset:39424
  ds_read_b64_tr_b16 v[140:141], v53 offset:38912
  ds_read_b64_tr_b16 v[142:143], v53 offset:39424
  v_mfma_f32_32x32x16_bf16 v[64:79], v[120:123], v[112:115], v[64:79]
  v_mfma_f32_32x32x16_bf16 v[80:95], v[120:123], v[116:119], v[80:95]
  v_mfma_f32_32x32x16_bf16 v[96:111], v[112:115], v[124:127], v[96:111]
  s_waitcnt vmcnt(8) lgkmcnt(0)
  s_barrier
  ds_read_b128 v[112:115], v40 offset:8192
  ds_read_b128 v[116:119], v44 offset:8192
  ds_read_b64_tr_b16 v[120:121], v52 offset:0
  ds_read_b64_tr_b16 v[122:123], v52 offset:512
  ds_read_b64_tr_b16 v[124:125], v53 offset:0
  ds_read_b64_tr_b16 v[126:127], v53 offset:512
  v_mfma_f32_32x32x16_bf16 v[64:79], v[136:139], v[128:131], v[64:79]
  v_mfma_f32_32x32x16_bf16 v[80:95], v[136:139], v[132:135], v[80:95]
  v_mfma_f32_32x32x16_bf16 v[96:111], v[128:131], v[140:143], v[96:111]
  s_add_u32 m0, s70, 36864
  s_mov_b32 s71, 1081344
  buffer_load_dwordx4 v28, s[44:47], s71 offen lds
  s_add_u32 m0, s70, 40960
  s_mov_b32 s71, 1082368
  buffer_load_dwordx4 v28, s[44:47], s71 offen lds
  s_add_u32 m0, s70, 45056
  s_mov_b32 s71, 1083392
  buffer_load_dwordx4 v28, s[44:47], s71 offen lds
  s_add_u32 m0, s69, 0
  s_movk_i32 s71, 768
  buffer_load_dwordx4 v35, s[40:43], s71 offen lds
  s_add_u32 m0, s69, 1024
  s_movk_i32 s71, 768
  buffer_load_dwordx4 v36, s[40:43], s71 offen lds
  s_waitcnt lgkmcnt(0)
  ds_read_b128 v[128:131], v41 offset:8192
  ds_read_b128 v[132:135], v45 offset:8192
  ds_read_b64_tr_b16 v[136:137], v52 offset:2048
  ds_read_b64_tr_b16 v[138:139], v52 offset:2560
  ds_read_b64_tr_b16 v[140:141], v53 offset:2048
  ds_read_b64_tr_b16 v[142:143], v53 offset:2560
  v_mfma_f32_32x32x16_bf16 v[64:79], v[120:123], v[112:115], v[64:79]
  v_mfma_f32_32x32x16_bf16 v[80:95], v[120:123], v[116:119], v[80:95]
  v_mfma_f32_32x32x16_bf16 v[96:111], v[112:115], v[124:127], v[96:111]
  s_waitcnt vmcnt(10) lgkmcnt(0)
  s_barrier
  ds_read_b128 v[112:115], v42 offset:8192
  ds_read_b128 v[116:119], v46 offset:8192
  ds_read_b64_tr_b16 v[120:121], v52 offset:12288
  ds_read_b64_tr_b16 v[122:123], v52 offset:12800
  ds_read_b64_tr_b16 v[124:125], v53 offset:12288
  ds_read_b64_tr_b16 v[126:127], v53 offset:12800
  v_mfma_f32_32x32x16_bf16 v[64:79], v[136:139], v[128:131], v[64:79]
  v_mfma_f32_32x32x16_bf16 v[80:95], v[136:139], v[132:135], v[80:95]
  v_mfma_f32_32x32x16_bf16 v[96:111], v[128:131], v[140:143], v[96:111]
  s_add_u32 m0, s70, 0
  s_mov_b32 s71, 1179648
  buffer_load_dwordx4 v28, s[44:47], s71 offen lds
  s_add_u32 m0, s70, 4096
  s_mov_b32 s71, 1180672
  buffer_load_dwordx4 v28, s[44:47], s71 offen lds
  s_add_u32 m0, s70, 8192
  s_mov_b32 s71, 1181696
  buffer_load_dwordx4 v28, s[44:47], s71 offen lds
  s_waitcnt lgkmcnt(0)
  ds_read_b128 v[128:131], v43 offset:8192
  ds_read_b128 v[132:135], v47 offset:8192
  ds_read_b64_tr_b16 v[136:137], v52 offset:14336
  ds_read_b64_tr_b16 v[138:139], v52 offset:14848
  ds_read_b64_tr_b16 v[140:141], v53 offset:14336
  ds_read_b64_tr_b16 v[142:143], v53 offset:14848
  v_mfma_f32_32x32x16_bf16 v[64:79], v[120:123], v[112:115], v[64:79]
  v_mfma_f32_32x32x16_bf16 v[80:95], v[120:123], v[116:119], v[80:95]
  v_mfma_f32_32x32x16_bf16 v[96:111], v[112:115], v[124:127], v[96:111]
  s_waitcnt vmcnt(8) lgkmcnt(0)
  s_barrier
  ds_read_b128 v[112:115], v40 offset:16384
  ds_read_b128 v[116:119], v44 offset:16384
  ds_read_b64_tr_b16 v[120:121], v52 offset:24576
  ds_read_b64_tr_b16 v[122:123], v52 offset:25088
  ds_read_b64_tr_b16 v[124:125], v53 offset:24576
  ds_read_b64_tr_b16 v[126:127], v53 offset:25088
  v_mfma_f32_32x32x16_bf16 v[64:79], v[136:139], v[128:131], v[64:79]
  v_mfma_f32_32x32x16_bf16 v[80:95], v[136:139], v[132:135], v[80:95]
  v_mfma_f32_32x32x16_bf16 v[96:111], v[128:131], v[140:143], v[96:111]
  s_add_u32 m0, s70, 12288
  s_mov_b32 s71, 1277952
  buffer_load_dwordx4 v28, s[44:47], s71 offen lds
  s_add_u32 m0, s70, 16384
  s_mov_b32 s71, 1278976
  buffer_load_dwordx4 v28, s[44:47], s71 offen lds
  s_add_u32 m0, s70, 20480
  s_mov_b32 s71, 1280000
  buffer_load_dwordx4 v28, s[44:47], s71 offen lds
  s_add_u32 m0, s69, 8192
  s_movk_i32 s71, 896
  buffer_load_dwordx4 v35, s[40:43], s71 offen lds
  s_add_u32 m0, s69, 9216
  s_movk_i32 s71, 896
  buffer_load_dwordx4 v36, s[40:43], s71 offen lds
  s_waitcnt lgkmcnt(0)
  ds_read_b128 v[128:131], v41 offset:16384
  ds_read_b128 v[132:135], v45 offset:16384
  ds_read_b64_tr_b16 v[136:137], v52 offset:26624
  ds_read_b64_tr_b16 v[138:139], v52 offset:27136
  ds_read_b64_tr_b16 v[140:141], v53 offset:26624
  ds_read_b64_tr_b16 v[142:143], v53 offset:27136
  v_mfma_f32_32x32x16_bf16 v[64:79], v[120:123], v[112:115], v[64:79]
  v_mfma_f32_32x32x16_bf16 v[80:95], v[120:123], v[116:119], v[80:95]
  v_mfma_f32_32x32x16_bf16 v[96:111], v[112:115], v[124:127], v[96:111]
  s_waitcnt vmcnt(10) lgkmcnt(0)
  s_barrier
  ds_read_b128 v[112:115], v42 offset:16384
  ds_read_b128 v[116:119], v46 offset:16384
  ds_read_b64_tr_b16 v[120:121], v52 offset:36864
  ds_read_b64_tr_b16 v[122:123], v52 offset:37376
  ds_read_b64_tr_b16 v[124:125], v53 offset:36864
  ds_read_b64_tr_b16 v[126:127], v53 offset:37376
  v_mfma_f32_32x32x16_bf16 v[64:79], v[136:139], v[128:131], v[64:79]
  v_mfma_f32_32x32x16_bf16 v[80:95], v[136:139], v[132:135], v[80:95]
  v_mfma_f32_32x32x16_bf16 v[96:111], v[128:131], v[140:143], v[96:111]
  s_add_u32 m0, s70, 24576
  s_mov_b32 s71, 1376256
  buffer_load_dwordx4 v28, s[44:47], s71 offen lds
  s_add_u32 m0, s70, 28672
  s_mov_b32 s71, 1377280
  buffer_load_dwordx4 v28, s[44:47], s71 offen lds
  s_add_u32 m0, s70, 32768
  s_mov_b32 s71, 1378304
  buffer_load_dwordx4 v28, s[44:47], s71 offen lds
  s_waitcnt lgkmcnt(0)
  ds_read_b128 v[128:131], v43 offset:16384
  ds_read_b128 v[132:135], v47 offset:16384
  ds_read_b64_tr_b16 v[136:137], v52 offset:38912
  ds_read_b64_tr_b16 v[138:139], v52 offset:39424
  ds_read_b64_tr_b16 v[140:141], v53 offset:38912
  ds_read_b64_tr_b16 v[142:143], v53 offset:39424
  v_mfma_f32_32x32x16_bf16 v[64:79], v[120:123], v[112:115], v[64:79]
  v_mfma_f32_32x32x16_bf16 v[80:95], v[120:123], v[116:119], v[80:95]
  v_mfma_f32_32x32x16_bf16 v[96:111], v[112:115], v[124:127], v[96:111]
  s_waitcnt vmcnt(8) lgkmcnt(0)
  s_barrier
  ds_read_b128 v[112:115], v40 offset:0
  ds_read_b128 v[116:119], v44 offset:0
  ds_read_b64_tr_b16 v[120:121], v52 offset:0
  ds_read_b64_tr_b16 v[122:123], v52 offset:512
  ds_read_b64_tr_b16 v[124:125], v53 offset:0
  ds_read_b64_tr_b16 v[126:127], v53 offset:512
  v_mfma_f32_32x32x16_bf16 v[64:79], v[136:139], v[128:131], v[64:79]
  v_mfma_f32_32x32x16_bf16 v[80:95], v[136:139], v[132:135], v[80:95]
  v_mfma_f32_32x32x16_bf16 v[96:111], v[128:131], v[140:143], v[96:111]
  s_add_u32 m0, s70, 36864
  s_mov_b32 s71, 1474560
  buffer_load_dwordx4 v28, s[44:47], s71 offen lds
  s_add_u32 m0, s70, 40960
  s_mov_b32 s71, 1475584
  buffer_load_dwordx4 v28, s[44:47], s71 offen lds
  s_add_u32 m0, s70, 45056
  s_mov_b32 s71, 1476608
  buffer_load_dwordx4 v28, s[44:47], s71 offen lds
  s_waitcnt lgkmcnt(0)
  ds_read_b128 v[128:131], v41 offset:0
  ds_read_b128 v[132:135], v45 offset:0
  ds_read_b64_tr_b16 v[136:137], v52 offset:2048
  ds_read_b64_tr_b16 v[138:139], v52 offset:2560
  ds_read_b64_tr_b16 v[140:141], v53 offset:2048
  ds_read_b64_tr_b16 v[142:143], v53 offset:2560
  v_mfma_f32_32x32x16_bf16 v[64:79], v[120:123], v[112:115], v[64:79]
  v_mfma_f32_32x32x16_bf16 v[80:95], v[120:123], v[116:119], v[80:95]
  v_mfma_f32_32x32x16_bf16 v[96:111], v[112:115], v[124:127], v[96:111]
  s_waitcnt vmcnt(8) lgkmcnt(0)
  s_barrier
  ds_read_b128 v[112:115], v42 offset:0
  ds_read_b128 v[116:119], v46 offset:0
  ds_read_b64_tr_b16 v[120:121], v52 offset:12288
  ds_read_b64_tr_b16 v[122:123], v52 offset:12800
  ds_read_b64_tr_b16 v[124:125], v53 offset:12288
  ds_read_b64_tr_b16 v[126:127], v53 offset:12800
  v_mfma_f32_32x32x16_bf16 v[64:79], v[136:139], v[128:131], v[64:79]
  v_mfma_f32_32x32x16_bf16 v[80:95], v[136:139], v[132:135], v[80:95]
  v_mfma_f32_32x32x16_bf16 v[96:111], v[128:131], v[140:143], v[96:111]
  s_mov_b32 s8, s24
  s_mov_b32 s9, s25
  s_mov_b32 s10, 0x158000
  s_mov_b32 s11, 0x20000
  buffer_load_dwordx4 v[152:155], v7, s[8:11], s14 offen
  s_mov_b32 s8, s24
  s_mov_b32 s9, s25
  s_mov_b32 s10, 0x158000
  s_mov_b32 s11, 0x20000
  buffer_load_dwordx4 v[152:155], v7, s[8:11], s15 offen
  s_mov_b32 s8, s26
  s_mov_b32 s9, s27
  s_mov_b32 s10, 0x158000
  s_mov_b32 s11, 0x20000
  buffer_load_dwordx4 v[152:155], v7, s[8:11], s14 offen
  s_mov_b32 s8, s26
  s_mov_b32 s9, s27
  s_mov_b32 s10, 0x158000
  s_mov_b32 s11, 0x20000
  buffer_load_dwordx4 v[152:155], v7, s[8:11], s15 offen
  s_mov_b32 s8, s28
  s_mov_b32 s9, s29
  s_mov_b32 s10, 0x158000
  s_mov_b32 s11, 0x20000
  buffer_load_dwordx4 v[152:155], v7, s[8:11], s14 offen
  s_mov_b32 s8, s28
  s_mov_b32 s9, s29
  s_mov_b32 s10, 0x158000
  s_mov_b32 s11, 0x20000
  buffer_load_dwordx4 v[152:155], v7, s[8:11], s15 offen
  s_mov_b32 s8, s20
  s_mov_b32 s9, s21
  s_mov_b32 s10, 0x80000
  s_mov_b32 s11, 0x20000
  buffer_load_dwordx4 v[152:155], v7, s[8:11], s14 offen
  s_waitcnt lgkmcnt(0)
  ds_read_b128 v[128:131], v43 offset:0
  ds_read_b128 v[132:135], v47 offset:0
  ds_read_b64_tr_b16 v[136:137], v52 offset:14336
  ds_read_b64_tr_b16 v[138:139], v52 offset:14848
  ds_read_b64_tr_b16 v[140:141], v53 offset:14336
  ds_read_b64_tr_b16 v[142:143], v53 offset:14848
  v_mfma_f32_32x32x16_bf16 v[64:79], v[120:123], v[112:115], v[64:79]
  v_mfma_f32_32x32x16_bf16 v[80:95], v[120:123], v[116:119], v[80:95]
  v_mfma_f32_32x32x16_bf16 v[96:111], v[112:115], v[124:127], v[96:111]
  s_waitcnt vmcnt(10) lgkmcnt(0)
  s_barrier
  ds_read_b128 v[112:115], v40 offset:8192
  ds_read_b128 v[116:119], v44 offset:8192
  ds_read_b64_tr_b16 v[120:121], v52 offset:24576
  ds_read_b64_tr_b16 v[122:123], v52 offset:25088
  ds_read_b64_tr_b16 v[124:125], v53 offset:24576
  ds_read_b64_tr_b16 v[126:127], v53 offset:25088
  v_mfma_f32_32x32x16_bf16 v[64:79], v[136:139], v[128:131], v[64:79]
  v_mfma_f32_32x32x16_bf16 v[80:95], v[136:139], v[132:135], v[80:95]
  v_mfma_f32_32x32x16_bf16 v[96:111], v[128:131], v[140:143], v[96:111]
  s_waitcnt lgkmcnt(0)
  ds_read_b128 v[128:131], v41 offset:8192
  ds_read_b128 v[132:135], v45 offset:8192
  ds_read_b64_tr_b16 v[136:137], v52 offset:26624
  ds_read_b64_tr_b16 v[138:139], v52 offset:27136
  ds_read_b64_tr_b16 v[140:141], v53 offset:26624
  ds_read_b64_tr_b16 v[142:143], v53 offset:27136
  v_mfma_f32_32x32x16_bf16 v[64:79], v[120:123], v[112:115], v[64:79]
  v_mfma_f32_32x32x16_bf16 v[80:95], v[120:123], v[116:119], v[80:95]
  v_mfma_f32_32x32x16_bf16 v[96:111], v[112:115], v[124:127], v[96:111]
  s_waitcnt vmcnt(7) lgkmcnt(0)
  s_barrier
  ds_read_b128 v[112:115], v42 offset:8192
  ds_read_b128 v[116:119], v46 offset:8192
  ds_read_b64_tr_b16 v[120:121], v52 offset:36864
  ds_read_b64_tr_b16 v[122:123], v52 offset:37376
  ds_read_b64_tr_b16 v[124:125], v53 offset:36864
  ds_read_b64_tr_b16 v[126:127], v53 offset:37376
  v_mfma_f32_32x32x16_bf16 v[64:79], v[136:139], v[128:131], v[64:79]
  v_mfma_f32_32x32x16_bf16 v[80:95], v[136:139], v[132:135], v[80:95]
  v_mfma_f32_32x32x16_bf16 v[96:111], v[128:131], v[140:143], v[96:111]
  s_waitcnt lgkmcnt(0)
  ds_read_b128 v[128:131], v43 offset:8192
  ds_read_b128 v[132:135], v47 offset:8192
  ds_read_b64_tr_b16 v[136:137], v52 offset:38912
  ds_read_b64_tr_b16 v[138:139], v52 offset:39424
  ds_read_b64_tr_b16 v[140:141], v53 offset:38912
  ds_read_b64_tr_b16 v[142:143], v53 offset:39424
  v_mfma_f32_32x32x16_bf16 v[64:79], v[120:123], v[112:115], v[64:79]
  v_mfma_f32_32x32x16_bf16 v[80:95], v[120:123], v[116:119], v[80:95]
  v_mfma_f32_32x32x16_bf16 v[96:111], v[112:115], v[124:127], v[96:111]
  s_waitcnt lgkmcnt(0)
  v_mfma_f32_32x32x16_bf16 v[64:79], v[136:139], v[128:131], v[64:79]
  v_mfma_f32_32x32x16_bf16 v[80:95], v[136:139], v[132:135], v[80:95]
  v_mfma_f32_32x32x16_bf16 v[96:111], v[128:131], v[140:143], v[96:111]
  s_lshl_b32 s63, s62, 2
  s_add_u32 s63, s63, s60
  s_lshl_b32 s64, s61, 1
  s_add_u32 s65, s64, s66
  s_xor_b32 s66, s65, 1
  s_mov_b32 s72, 0x3eb8aa3b
  s_lshl_b32 s73, s63, 6
  s_nop 2
  v_mul_f32 v64, s72, v64
  v_mul_f32 v65, s72, v65
  v_mul_f32 v66, s72, v66
  v_mul_f32 v67, s72, v67
  v_mul_f32 v68, s72, v68
  v_mul_f32 v69, s72, v69
  v_mul_f32 v70, s72, v70
  v_mul_f32 v71, s72, v71
  v_cvt_pk_bf16_f32 v112, v64, v65
  v_cvt_pk_bf16_f32 v113, v66, v67
  v_cvt_pk_bf16_f32 v114, v68, v69
  v_cvt_pk_bf16_f32 v115, v70, v71
  v_cvt_pk_bf16_f32 v116, v72, v73
  v_cvt_pk_bf16_f32 v117, v74, v75
  v_cvt_pk_bf16_f32 v118, v76, v77
  v_cvt_pk_bf16_f32 v119, v78, v79
  s_add_u32 s74, s73, s65
  s_lshl_b32 s75, s74, 10
  s_add_u32 s75, s75, 0
  buffer_store_dwordx4 v[112:115], v7, s[48:51], s75 offen
  s_lshl_b32 s75, s74, 11
  s_add_u32 s75, s75, 2097152
  buffer_store_dwordx4 v[116:119], v7, s[48:51], s75 offen
  v_mul_f32 v54, v72, v72
  v_fmac_f32 v54, v73, v73
  v_fmac_f32 v54, v74, v74
  v_fmac_f32 v54, v75, v75
  v_fmac_f32 v54, v76, v76
  v_fmac_f32 v54, v77, v77
  v_fmac_f32 v54, v78, v78
  v_fmac_f32 v54, v79, v79
  v_mov_b32 v56, v54
  s_nop 1
  v_permlane32_swap_b32 v54, v56
  v_add_f32 v54, v54, v56
  s_nop 1
  v_max_f32_dpp v54, v54, v54 row_shr:1 row_mask:0xf bank_mask:0xf bound_ctrl:0
  s_nop 1
  v_max_f32_dpp v54, v54, v54 row_shr:2 row_mask:0xf bank_mask:0xf bound_ctrl:0
  s_nop 1
  v_max_f32_dpp v54, v54, v54 row_shr:4 row_mask:0xf bank_mask:0xf bound_ctrl:0
  s_nop 1
  v_max_f32_dpp v54, v54, v54 row_shr:8 row_mask:0xf bank_mask:0xf bound_ctrl:0
  s_nop 1
  v_max_f32_dpp v54, v54, v54 row_bcast:15 row_mask:0xa bank_mask:0xf bound_ctrl:0
  v_cmp_eq_u32 vcc, 31, v1
  s_nop 3
  s_and_saveexec_b64 s[12:13], vcc
  s_lshl_b32 s75, s74, 2
  s_add_u32 s75, s75, 20971520
  v_mov_b32 v56, 0
  buffer_store_dword v54, v56, s[48:51], s75 offen
  s_mov_b64 exec, s[12:13]
  v_mul_f32 v80, s72, v80
  v_mul_f32 v81, s72, v81
  v_mul_f32 v82, s72, v82
  v_mul_f32 v83, s72, v83
  v_mul_f32 v84, s72, v84
  v_mul_f32 v85, s72, v85
  v_mul_f32 v86, s72, v86
  v_mul_f32 v87, s72, v87
  v_cvt_pk_bf16_f32 v128, v80, v81
  v_cvt_pk_bf16_f32 v129, v82, v83
  v_cvt_pk_bf16_f32 v130, v84, v85
  v_cvt_pk_bf16_f32 v131, v86, v87
  v_cvt_pk_bf16_f32 v132, v88, v89
  v_cvt_pk_bf16_f32 v133, v90, v91
  v_cvt_pk_bf16_f32 v134, v92, v93
  v_cvt_pk_bf16_f32 v135, v94, v95
  s_add_u32 s74, s73, s66
  s_lshl_b32 s75, s74, 10
  s_add_u32 s75, s75, 0
  buffer_store_dwordx4 v[128:131], v7, s[48:51], s75 offen
  s_lshl_b32 s75, s74, 11
  s_add_u32 s75, s75, 2097152
  buffer_store_dwordx4 v[132:135], v7, s[48:51], s75 offen
  v_mul_f32 v55, v88, v88
  v_fmac_f32 v55, v89, v89
  v_fmac_f32 v55, v90, v90
  v_fmac_f32 v55, v91, v91
  v_fmac_f32 v55, v92, v92
  v_fmac_f32 v55, v93, v93
  v_fmac_f32 v55, v94, v94
  v_fmac_f32 v55, v95, v95
  v_mov_b32 v56, v55
  s_nop 1
  v_permlane32_swap_b32 v55, v56
  v_add_f32 v55, v55, v56
  s_nop 1
  v_max_f32_dpp v55, v55, v55 row_shr:1 row_mask:0xf bank_mask:0xf bound_ctrl:0
  s_nop 1
  v_max_f32_dpp v55, v55, v55 row_shr:2 row_mask:0xf bank_mask:0xf bound_ctrl:0
  s_nop 1
  v_max_f32_dpp v55, v55, v55 row_shr:4 row_mask:0xf bank_mask:0xf bound_ctrl:0
  s_nop 1
  v_max_f32_dpp v55, v55, v55 row_shr:8 row_mask:0xf bank_mask:0xf bound_ctrl:0
  s_nop 1
  v_max_f32_dpp v55, v55, v55 row_bcast:15 row_mask:0xa bank_mask:0xf bound_ctrl:0
  v_cmp_eq_u32 vcc, 31, v1
  s_nop 3
  s_and_saveexec_b64 s[12:13], vcc
  s_lshl_b32 s75, s74, 2
  s_add_u32 s75, s75, 20971520
  v_mov_b32 v56, 0
  buffer_store_dword v55, v56, s[48:51], s75 offen
  s_mov_b64 exec, s[12:13]
  v_cvt_pk_bf16_f32 v144, v96, v97
  v_cvt_pk_bf16_f32 v145, v98, v99
  v_cvt_pk_bf16_f32 v146, v100, v101
  v_cvt_pk_bf16_f32 v147, v102, v103
  v_cvt_pk_bf16_f32 v148, v104, v105
  v_cvt_pk_bf16_f32 v149, v106, v107
  v_cvt_pk_bf16_f32 v150, v108, v109
  v_cvt_pk_bf16_f32 v151, v110, v111
  v_lshrrev_b32 v56, 4, v1
  v_and_b32 v56, 1, v56
  v_lshlrev_b32 v56, 17, v56
  v_lshlrev_b32 v57, 8, v4
  v_add_u32 v56, v56, v57
  v_and_b32 v57, 15, v1
  v_lshlrev_b32 v57, 4, v57
  v_add_u32 v56, v56, v57
  s_lshl_b32 s74, s62, 2
  s_and_b32 s75, s60, 2
  s_add_u32 s74, s74, s75
  s_lshl_b32 s74, s74, 6
  s_add_u32 s74, s74, s65
  s_lshl_b32 s74, s74, 11
  s_add_u32 s74, s74, 2097152
  buffer_store_dwordx4 v[144:147], v56, s[48:51], s74 offen offset:1024
  buffer_store_dwordx4 v[148:151], v56, s[48:51], s74 offen offset:1536
  s_cmp_lg_u32 s60, 0
  s_cbranch_scc1 k1_qkv_kernel_nocnt
  v_mov_b32 v48, 0
  v_mov_b32 v49, 0
  v_mov_b32 v50, 0
  v_mov_b32 v51, 0
  s_lshl_b32 s72, s2, 7
  s_add_u32 s72, s72, 0x1410000
  s_add_u32 s73, s72, 0x8000
  s_mov_b64 exec, 0xff
  buffer_store_dwordx4 v[48:51], v7, s[48:51], s72 offen
  buffer_store_dwordx4 v[48:51], v7, s[48:51], s73 offen
  s_mov_b64 exec, -1
  s_cmp_lg_u32 s2, 0
  s_cbranch_scc1 k1_qkv_kernel_nocnt
  s_mov_b32 s72, 20987904
  buffer_store_dwordx4 v[48:51], v7, s[48:51], s72 offen
  buffer_store_dwordx4 v[48:51], v7, s[48:51], s72 offen offset:1024
  buffer_store_dwordx4 v[48:51], v7, s[48:51], s72 offen offset:2048
  buffer_store_dwordx4 v[48:51], v7, s[48:51], s72 offen offset:3072
k1_qkv_kernel_nocnt:
k1_qkv_kernel_end:
  s_endpgm
.globl k2_mix_kernel
.p2align 8
.type k2_mix_kernel,@function
k2_mix_kernel:
  s_cmp_ge_u32 s2, 0x200
  s_cbranch_scc1 k2_mix_kernel_end
  s_load_dwordx16 s[16:31], s[0:1], 0
  s_load_dwordx2 s[32:33], s[0:1], 64
  s_load_dwordx2 s[34:35], s[0:1], 80
  s_cmp_ge_u32 s2, 0x100
  s_cbranch_scc1 k2_mix_kernel_G
  s_waitcnt lgkmcnt(0)
  s_setprio 3
  v_and_b32 v1, 63, v0
  v_lshrrev_b32 v2, 6, v0
  s_nop 0
  v_readfirstlane_b32 s60, v2
  v_lshlrev_b32 v5, 4, v1
  s_and_b32 s3, s2, 7
  s_lshl_b32 s3, s3, 2
  s_lshr_b32 s4, s2, 3
  s_and_b32 s4, s4, 3
  s_add_u32 s61, s3, s4
  s_lshr_b32 s62, s2, 5
  s_mov_b32 s48, s34
  s_mov_b32 s49, s35
  s_mov_b32 s50, 0x1600000
  s_mov_b32 s51, 0x20000
  s_lshl_b32 s64, s61, 6
  s_lshl_b32 s65, s60, 1
  s_add_u32 s66, s64, s65
  s_lshl_b32 s66, s66, 11
  s_add_u32 s66, s66, 2097152
  s_mul_i32 s67, s60, 4128
  s_add_u32 m0, s67, 0
  s_add_u32 s68, s66, 0
  buffer_load_dwordx4 v5, s[48:51], s68 offen offset:0 lds
  buffer_load_dwordx4 v5, s[48:51], s68 offen offset:1024 lds
  buffer_load_dwordx4 v5, s[48:51], s68 offen offset:2048 lds
  buffer_load_dwordx4 v5, s[48:51], s68 offen offset:3072 lds
  v_and_b32 v3, 31, v1
  v_lshrrev_b32 v4, 5, v1
  s_lshl_b32 s63, s62, 3
  s_add_u32 s63, s63, s65
  s_add_u32 s65, s64, s63
  s_lshl_b32 s65, s65, 10
  s_add_u32 s65, s65, 0
  buffer_load_dwordx4 v[8:11], v5, s[48:51], s65 offen
  buffer_load_dwordx4 v[12:15], v5, s[48:51], s65 offen offset:1024
  v_lshlrev_b32 v6, 2, v1
  s_lshl_b32 s65, s64, 2
  s_add_u32 s65, s65, 20971520
  buffer_load_dword v152, v6, s[48:51], s65 offen
  v_lshlrev_b32 v6, 2, v3
  s_lshl_b32 s65, s63, 7
  s_add_u32 s65, s65, 20979712
  buffer_load_dword v153, v6, s[48:51], s65 offen
  buffer_load_dword v154, v6, s[48:51], s65 offen offset:128
  v_lshlrev_b32 v6, 8, v4
  v_and_b32 v7, 15, v1
  v_lshlrev_b32 v7, 4, v7
  v_add_u32 v6, v6, v7
  v_and_b32 v157, 27, v1
  v_cmp_eq_u32 vcc, 16, v157
  v_mov_b32 v157, 16
  s_nop 0
  v_cndmask_b32 v158, v157, 0, vcc
  v_cmp_gt_u32 vcc, 16, v3
  v_add_u32 v157, 3072, v158
  s_nop 0
  v_cndmask_b32 v160, v157, v6, vcc
  v_add_u32 v157, 2560, v158
  v_cndmask_b32 v161, v157, v6, vcc
  v_add_u32 v157, 1024, v158
  v_cndmask_b32 v162, v157, v6, vcc
  v_add_u32 v157, 512, v158
  v_cndmask_b32 v163, v157, v6, vcc
  v_and_b32 v157, 1, v1
  v_cmp_eq_u32 vcc, 0, v157
  v_mov_b32 v157, 0x3f803f80
  s_nop 0
  v_cndmask_b32 v157, 0, v157, vcc
  v_mov_b32 v136, v157
  v_mov_b32 v137, v157
  v_mov_b32 v138, v157
  v_mov_b32 v139, v157
  v_lshrrev_b32 v157, 3, v1
  v_mul_u32_u24 v157, 16512, v157
  v_lshrrev_b32 v158, 1, v1
  v_and_b32 v158, 3, v158
  v_mul_u32_u24 v158, 4128, v158
  v_add_u32 v157, v157, v158
  v_and_b32 v158, 1, v1
  v_lshlrev_b32 v158, 4, v158
  v_add_u32 v157, v157, v158
  s_mov_b64 exec, 0xffffffff
  ds_write_b128 v157, v[136:139] offset:4096
  s_mov_b64 exec, -1
  v_mov_b32 v80, 0
  v_mov_b32 v81, 0
  v_mov_b32 v82, 0
  v_mov_b32 v83, 0
  v_mov_b32 v84, 0
  v_mov_b32 v85, 0
  v_mov_b32 v86, 0
  v_mov_b32 v87, 0
  v_mov_b32 v88, 0
  v_mov_b32 v89, 0
  v_mov_b32 v90, 0
  v_mov_b32 v91, 0
  v_mov_b32 v92, 0
  v_mov_b32 v93, 0
  v_mov_b32 v94, 0
  v_mov_b32 v95, 0
  v_mov_b32 v96, 0
  v_mov_b32 v97, 0
  v_mov_b32 v98, 0
  v_mov_b32 v99, 0
  v_mov_b32 v100, 0
  v_mov_b32 v101, 0
  v_mov_b32 v102, 0
  v_mov_b32 v103, 0
  v_mov_b32 v104, 0
  v_mov_b32 v105, 0
  v_mov_b32 v106, 0
  v_mov_b32 v107, 0
  v_mov_b32 v108, 0
  v_mov_b32 v109, 0
  v_mov_b32 v110, 0
  v_mov_b32 v111, 0
  s_mov_b32 s70, 0xffff
  s_mov_b32 s71, 0xffff
  s_waitcnt vmcnt(0)
  v_max_f32_dpp v152, v152, v152 row_shr:1 row_mask:0xf bank_mask:0xf bound_ctrl:0
  s_nop 1
  v_max_f32_dpp v152, v152, v152 row_shr:2 row_mask:0xf bank_mask:0xf bound_ctrl:0
  s_nop 1
  v_max_f32_dpp v152, v152, v152 row_shr:4 row_mask:0xf bank_mask:0xf bound_ctrl:0
  s_nop 1
  v_max_f32_dpp v152, v152, v152 row_shr:8 row_mask:0xf bank_mask:0xf bound_ctrl:0
  s_nop 1
  v_max_f32_dpp v152, v152, v152 row_bcast:15 row_mask:0xa bank_mask:0xf bound_ctrl:0
  s_nop 1
  v_max_f32_dpp v152, v152, v152 row_bcast:31 row_mask:0xc bank_mask:0xf bound_ctrl:0
  s_nop 0
  v_readlane_b32 s69, v152, 63
  v_lshlrev_b32 v157, 16, v8
  v_and_b32 v158, 0xffff0000, v8
  v_mul_f32 v155, v157, v157
  v_fmac_f32 v155, v158, v158
  v_lshlrev_b32 v157, 16, v9
  v_and_b32 v158, 0xffff0000, v9
  v_fmac_f32 v155, v157, v157
  v_fmac_f32 v155, v158, v158
  v_lshlrev_b32 v157, 16, v10
  v_and_b32 v158, 0xffff0000, v10
  v_fmac_f32 v155, v157, v157
  v_fmac_f32 v155, v158, v158
  v_lshlrev_b32 v157, 16, v11
  v_and_b32 v158, 0xffff0000, v11
  v_fmac_f32 v155, v157, v157
  v_fmac_f32 v155, v158, v158
  v_mov_b32 v157, v155
  s_nop 1
  v_permlane32_swap_b32 v155, v157
  v_add_f32 v155, v155, v157
  v_mul_f32 v155, s69, v155
  v_sqrt_f32 v155, v155
  s_nop 0
  v_mul_f32 v155, 0xbf8147ae, v155
  v_mov_b32 v16, v155
  v_mov_b32 v17, v155
  v_mov_b32 v18, v155
  v_mov_b32 v19, v155
  v_mov_b32 v20, v155
  v_mov_b32 v21, v155
  v_mov_b32 v22, v155
  v_mov_b32 v23, v155
  v_mov_b32 v24, v155
  v_mov_b32 v25, v155
  v_mov_b32 v26, v155
  v_mov_b32 v27, v155
  v_mov_b32 v28, v155
  v_mov_b32 v29, v155
  v_mov_b32 v30, v155
  v_mov_b32 v31, v155
  v_lshlrev_b32 v157, 16, v12
  v_and_b32 v158, 0xffff0000, v12
  v_mul_f32 v156, v157, v157
  v_fmac_f32 v156, v158, v158
  v_lshlrev_b32 v157, 16, v13
  v_and_b32 v158, 0xffff0000, v13
  v_fmac_f32 v156, v157, v157
  v_fmac_f32 v156, v158, v158
  v_lshlrev_b32 v157, 16, v14
  v_and_b32 v158, 0xffff0000, v14
  v_fmac_f32 v156, v157, v157
  v_fmac_f32 v156, v158, v158
  v_lshlrev_b32 v157, 16, v15
  v_and_b32 v158, 0xffff0000, v15
  v_fmac_f32 v156, v157, v157
  v_fmac_f32 v156, v158, v158
  v_mov_b32 v157, v156
  s_nop 1
  v_permlane32_swap_b32 v156, v157
  v_add_f32 v156, v156, v157
  v_mul_f32 v156, s69, v156
  v_sqrt_f32 v156, v156
  s_nop 0
  v_mul_f32 v156, 0xbf8147ae, v156
  v_mov_b32 v32, v156
  v_mov_b32 v33, v156
  v_mov_b32 v34, v156
  v_mov_b32 v35, v156
  v_mov_b32 v36, v156
  v_mov_b32 v37, v156
  v_mov_b32 v38, v156
  v_mov_b32 v39, v156
  v_mov_b32 v40, v156
  v_mov_b32 v41, v156
  v_mov_b32 v42, v156
  v_mov_b32 v43, v156
  v_mov_b32 v44, v156
  v_mov_b32 v45, v156
  v_mov_b32 v46, v156
  v_mov_b32 v47, v156
  s_setprio 1
  s_waitcnt vmcnt(0) lgkmcnt(0)
  s_barrier
  ds_read_b128 v[128:131], v5 offset:0
  ds_read_b128 v[136:139], v160 offset:1024
  ds_read_b128 v[140:143], v161 offset:1536
  s_waitcnt lgkmcnt(2)
  v_mfma_f32_32x32x16_bf16 v[48:63], v[128:131], v[8:11], v[16:31]
  s_waitcnt lgkmcnt(0)
  s_nop 10
  v_exp_f32 v48, v48
  v_exp_f32 v49, v49
  v_exp_f32 v50, v50
  v_exp_f32 v51, v51
  v_cvt_pk_bf16_f32 v112, v48, v49
  v_exp_f32 v52, v52
  v_exp_f32 v53, v53
  v_cvt_pk_bf16_f32 v113, v50, v51
  v_mfma_f32_32x32x16_bf16 v[64:79], v[128:131], v[12:15], v[32:47]
  ds_read_b128 v[132:135], v5 offset:2048
  ds_read_b128 v[144:147], v162 offset:3072
  ds_read_b128 v[148:151], v163 offset:3584
  v_exp_f32 v54, v54
  v_exp_f32 v55, v55
  v_cvt_pk_bf16_f32 v114, v52, v53
  v_exp_f32 v56, v56
  v_exp_f32 v57, v57
  v_cvt_pk_bf16_f32 v115, v54, v55
  v_exp_f32 v58, v58
  v_exp_f32 v59, v59
  v_mfma_f32_32x32x16_bf16 v[80:95], v[136:139], v[112:115], v[80:95]
  s_add_u32 m0, s67, 16512
  s_add_u32 s68, s66, 16384
  buffer_load_dwordx4 v5, s[48:51], s68 offen offset:0 lds
  v_cvt_pk_bf16_f32 v116, v56, v57
  v_exp_f32 v60, v60
  v_exp_f32 v61, v61
  v_cvt_pk_bf16_f32 v117, v58, v59
  v_exp_f32 v62, v62
  v_exp_f32 v63, v63
  v_cvt_pk_bf16_f32 v118, v60, v61
  v_cvt_pk_bf16_f32 v119, v62, v63
  v_exp_f32 v64, v64
  v_exp_f32 v65, v65
  v_mfma_f32_32x32x16_bf16 v[80:95], v[140:143], v[116:119], v[80:95]
  buffer_load_dwordx4 v5, s[48:51], s68 offen offset:1024 lds
  v_exp_f32 v66, v66
  v_exp_f32 v67, v67
  v_cvt_pk_bf16_f32 v120, v64, v65
  v_exp_f32 v68, v68
  v_exp_f32 v69, v69
  v_cvt_pk_bf16_f32 v121, v66, v67
  s_waitcnt lgkmcnt(0)
  v_mfma_f32_32x32x16_bf16 v[48:63], v[132:135], v[8:11], v[16:31]
  buffer_load_dwordx4 v5, s[48:51], s68 offen offset:2048 lds
  v_exp_f32 v70, v70
  v_exp_f32 v71, v71
  v_cvt_pk_bf16_f32 v122, v68, v69
  v_exp_f32 v72, v72
  v_exp_f32 v73, v73
  v_cvt_pk_bf16_f32 v123, v70, v71
  v_exp_f32 v74, v74
  v_exp_f32 v75, v75
  v_mfma_f32_32x32x16_bf16 v[96:111], v[136:139], v[120:123], v[96:111]
  buffer_load_dwordx4 v5, s[48:51], s68 offen offset:3072 lds
  v_cvt_pk_bf16_f32 v124, v72, v73
  v_exp_f32 v76, v76
  v_exp_f32 v77, v77
  v_cvt_pk_bf16_f32 v125, v74, v75
  v_exp_f32 v78, v78
  v_exp_f32 v79, v79
  v_cvt_pk_bf16_f32 v126, v76, v77
  v_cvt_pk_bf16_f32 v127, v78, v79
  v_exp_f32 v48, v48
  v_exp_f32 v49, v49
  v_mfma_f32_32x32x16_bf16 v[96:111], v[140:143], v[124:127], v[96:111]
  v_exp_f32 v50, v50
  v_exp_f32 v51, v51
  v_cvt_pk_bf16_f32 v112, v48, v49
  v_exp_f32 v52, v52
  v_exp_f32 v53, v53
  v_cvt_pk_bf16_f32 v113, v50, v51
  v_mfma_f32_32x32x16_bf16 v[64:79], v[132:135], v[12:15], v[32:47]
  ds_read_b128 v[128:131], v5 offset:4128
  ds_read_b128 v[136:139], v160 offset:5152
  ds_read_b128 v[140:143], v161 offset:5664
  v_exp_f32 v54, v54
  v_exp_f32 v55, v55
  v_cvt_pk_bf16_f32 v114, v52, v53
  v_exp_f32 v56, v56
  v_exp_f32 v57, v57
  v_cvt_pk_bf16_f32 v115, v54, v55
  v_exp_f32 v58, v58
  v_exp_f32 v59, v59
  v_mfma_f32_32x32x16_bf16 v[80:95], v[144:147], v[112:115], v[80:95]
  s_add_u32 m0, s67, 33024
  s_add_u32 s68, s66, 32768
  buffer_load_dwordx4 v5, s[48:51], s68 offen offset:0 lds
  v_cvt_pk_bf16_f32 v116, v56, v57
  v_exp_f32 v60, v60
  v_exp_f32 v61, v61
  v_cvt_pk_bf16_f32 v117, v58, v59
  v_exp_f32 v62, v62
  v_exp_f32 v63, v63
  v_cvt_pk_bf16_f32 v118, v60, v61
  v_cvt_pk_bf16_f32 v119, v62, v63
  v_exp_f32 v64, v64
  v_exp_f32 v65, v65
  v_mfma_f32_32x32x16_bf16 v[80:95], v[148:151], v[116:119], v[80:95]
  buffer_load_dwordx4 v5, s[48:51], s68 offen offset:1024 lds
  v_exp_f32 v66, v66
  v_exp_f32 v67, v67
  v_cvt_pk_bf16_f32 v120, v64, v65
  v_exp_f32 v68, v68
  v_exp_f32 v69, v69
  v_cvt_pk_bf16_f32 v121, v66, v67
  s_waitcnt lgkmcnt(0)
  v_mfma_f32_32x32x16_bf16 v[48:63], v[128:131], v[8:11], v[16:31]
  buffer_load_dwordx4 v5, s[48:51], s68 offen offset:2048 lds
  v_exp_f32 v70, v70
  v_exp_f32 v71, v71
  v_cvt_pk_bf16_f32 v122, v68, v69
  v_exp_f32 v72, v72
  v_exp_f32 v73, v73
  v_cvt_pk_bf16_f32 v123, v70, v71
  v_exp_f32 v74, v74
  v_exp_f32 v75, v75
  v_mfma_f32_32x32x16_bf16 v[96:111], v[144:147], v[120:123], v[96:111]
  buffer_load_dwordx4 v5, s[48:51], s68 offen offset:3072 lds
  v_cvt_pk_bf16_f32 v124, v72, v73
  v_exp_f32 v76, v76
  v_exp_f32 v77, v77
  v_cvt_pk_bf16_f32 v125, v74, v75
  v_exp_f32 v78, v78
  v_exp_f32 v79, v79
  v_cvt_pk_bf16_f32 v126, v76, v77
  v_cvt_pk_bf16_f32 v127, v78, v79
  v_exp_f32 v48, v48
  v_exp_f32 v49, v49
  v_mfma_f32_32x32x16_bf16 v[96:111], v[148:151], v[124:127], v[96:111]
  v_exp_f32 v50, v50
  v_exp_f32 v51, v51
  v_cvt_pk_bf16_f32 v112, v48, v49
  v_exp_f32 v52, v52
  v_exp_f32 v53, v53
  v_cvt_pk_bf16_f32 v113, v50, v51
  v_mfma_f32_32x32x16_bf16 v[64:79], v[128:131], v[12:15], v[32:47]
  ds_read_b128 v[132:135], v5 offset:6176
  ds_read_b128 v[144:147], v162 offset:7200
  ds_read_b128 v[148:151], v163 offset:7712
  v_exp_f32 v54, v54
  v_exp_f32 v55, v55
  v_cvt_pk_bf16_f32 v114, v52, v53
  v_exp_f32 v56, v56
  v_exp_f32 v57, v57
  v_cvt_pk_bf16_f32 v115, v54, v55
  v_exp_f32 v58, v58
  v_exp_f32 v59, v59
  v_mfma_f32_32x32x16_bf16 v[80:95], v[136:139], v[112:115], v[80:95]
  s_add_u32 m0, s67, 49536
  s_add_u32 s68, s66, 49152
  buffer_load_dwordx4 v5, s[48:51], s68 offen offset:0 lds
  v_cvt_pk_bf16_f32 v116, v56, v57
  v_exp_f32 v60, v60
  v_exp_f32 v61, v61
  v_cvt_pk_bf16_f32 v117, v58, v59
  v_exp_f32 v62, v62
  v_exp_f32 v63, v63
  v_cvt_pk_bf16_f32 v118, v60, v61
  v_cvt_pk_bf16_f32 v119, v62, v63
  v_exp_f32 v64, v64
  v_exp_f32 v65, v65
  v_mfma_f32_32x32x16_bf16 v[80:95], v[140:143], v[116:119], v[80:95]
  buffer_load_dwordx4 v5, s[48:51], s68 offen offset:1024 lds
  v_exp_f32 v66, v66
  v_exp_f32 v67, v67
  v_cvt_pk_bf16_f32 v120, v64, v65
  v_exp_f32 v68, v68
  v_exp_f32 v69, v69
  v_cvt_pk_bf16_f32 v121, v66, v67
  s_waitcnt lgkmcnt(0)
  v_mfma_f32_32x32x16_bf16 v[48:63], v[132:135], v[8:11], v[16:31]
  buffer_load_dwordx4 v5, s[48:51], s68 offen offset:2048 lds
  v_exp_f32 v70, v70
  v_exp_f32 v71, v71
  v_cvt_pk_bf16_f32 v122, v68, v69
  v_exp_f32 v72, v72
  v_exp_f32 v73, v73
  v_cvt_pk_bf16_f32 v123, v70, v71
  v_exp_f32 v74, v74
  v_exp_f32 v75, v75
  v_mfma_f32_32x32x16_bf16 v[96:111], v[136:139], v[120:123], v[96:111]
  buffer_load_dwordx4 v5, s[48:51], s68 offen offset:3072 lds
  v_cvt_pk_bf16_f32 v124, v72, v73
  v_exp_f32 v76, v76
  v_exp_f32 v77, v77
  v_cvt_pk_bf16_f32 v125, v74, v75
  v_exp_f32 v78, v78
  v_exp_f32 v79, v79
  v_cvt_pk_bf16_f32 v126, v76, v77
  v_cvt_pk_bf16_f32 v127, v78, v79
  v_exp_f32 v48, v48
  v_exp_f32 v49, v49
  v_mfma_f32_32x32x16_bf16 v[96:111], v[140:143], v[124:127], v[96:111]
  v_exp_f32 v50, v50
  v_exp_f32 v51, v51
  v_cvt_pk_bf16_f32 v112, v48, v49
  v_exp_f32 v52, v52
  v_exp_f32 v53, v53
  v_cvt_pk_bf16_f32 v113, v50, v51
  v_mfma_f32_32x32x16_bf16 v[64:79], v[132:135], v[12:15], v[32:47]
  ds_read_b128 v[128:131], v5 offset:8256
  ds_read_b128 v[136:139], v160 offset:9280
  ds_read_b128 v[140:143], v161 offset:9792
  v_exp_f32 v54, v54
  v_exp_f32 v55, v55
  v_cvt_pk_bf16_f32 v114, v52, v53
  v_exp_f32 v56, v56
  v_exp_f32 v57, v57
  v_cvt_pk_bf16_f32 v115, v54, v55
  v_exp_f32 v58, v58
  v_exp_f32 v59, v59
  v_mfma_f32_32x32x16_bf16 v[80:95], v[144:147], v[112:115], v[80:95]
  v_cvt_pk_bf16_f32 v116, v56, v57
  v_exp_f32 v60, v60
  v_exp_f32 v61, v61
  v_cvt_pk_bf16_f32 v117, v58, v59
  v_exp_f32 v62, v62
  v_exp_f32 v63, v63
  v_cvt_pk_bf16_f32 v118, v60, v61
  v_cvt_pk_bf16_f32 v119, v62, v63
  v_exp_f32 v64, v64
  v_exp_f32 v65, v65
  v_mfma_f32_32x32x16_bf16 v[80:95], v[148:151], v[116:119], v[80:95]
  v_exp_f32 v66, v66
  v_exp_f32 v67, v67
  v_cvt_pk_bf16_f32 v120, v64, v65
  v_exp_f32 v68, v68
  v_exp_f32 v69, v69
  v_cvt_pk_bf16_f32 v121, v66, v67
  s_waitcnt lgkmcnt(0)
  v_mfma_f32_32x32x16_bf16 v[48:63], v[128:131], v[8:11], v[16:31]
  v_exp_f32 v70, v70
  v_exp_f32 v71, v71
  v_cvt_pk_bf16_f32 v122, v68, v69
  v_exp_f32 v72, v72
  v_exp_f32 v73, v73
  v_cvt_pk_bf16_f32 v123, v70, v71
  v_exp_f32 v74, v74
  v_exp_f32 v75, v75
  v_mfma_f32_32x32x16_bf16 v[96:111], v[144:147], v[120:123], v[96:111]
  v_cvt_pk_bf16_f32 v124, v72, v73
  v_exp_f32 v76, v76
  v_exp_f32 v77, v77
  v_cvt_pk_bf16_f32 v125, v74, v75
  v_exp_f32 v78, v78
  v_exp_f32 v79, v79
  v_cvt_pk_bf16_f32 v126, v76, v77
  v_cvt_pk_bf16_f32 v127, v78, v79
  v_exp_f32 v48, v48
  v_exp_f32 v49, v49
  v_mfma_f32_32x32x16_bf16 v[96:111], v[148:151], v[124:127], v[96:111]
  v_exp_f32 v50, v50
  v_exp_f32 v51, v51
  v_cvt_pk_bf16_f32 v112, v48, v49
  v_exp_f32 v52, v52
  v_exp_f32 v53, v53
  v_cvt_pk_bf16_f32 v113, v50, v51
  v_mfma_f32_32x32x16_bf16 v[64:79], v[128:131], v[12:15], v[32:47]
  ds_read_b128 v[132:135], v5 offset:10304
  ds_read_b128 v[144:147], v162 offset:11328
  ds_read_b128 v[148:151], v163 offset:11840
  v_exp_f32 v54, v54
  v_exp_f32 v55, v55
  v_cvt_pk_bf16_f32 v114, v52, v53
  v_exp_f32 v56, v56
  v_exp_f32 v57, v57
  v_cvt_pk_bf16_f32 v115, v54, v55
  v_exp_f32 v58, v58
  v_exp_f32 v59, v59
  v_mfma_f32_32x32x16_bf16 v[80:95], v[136:139], v[112:115], v[80:95]
  v_cvt_pk_bf16_f32 v116, v56, v57
  v_exp_f32 v60, v60
  v_exp_f32 v61, v61
  v_cvt_pk_bf16_f32 v117, v58, v59
  v_exp_f32 v62, v62
  v_exp_f32 v63, v63
  v_cvt_pk_bf16_f32 v118, v60, v61
  v_cvt_pk_bf16_f32 v119, v62, v63
  v_exp_f32 v64, v64
  v_exp_f32 v65, v65
  v_mfma_f32_32x32x16_bf16 v[80:95], v[140:143], v[116:119], v[80:95]
  v_exp_f32 v66, v66
  v_exp_f32 v67, v67
  v_cvt_pk_bf16_f32 v120, v64, v65
  v_exp_f32 v68, v68
  v_exp_f32 v69, v69
  v_cvt_pk_bf16_f32 v121, v66, v67
  s_waitcnt lgkmcnt(0)
  v_mfma_f32_32x32x16_bf16 v[48:63], v[132:135], v[8:11], v[16:31]
  v_exp_f32 v70, v70
  v_exp_f32 v71, v71
  v_cvt_pk_bf16_f32 v122, v68, v69
  v_exp_f32 v72, v72
  v_exp_f32 v73, v73
  v_cvt_pk_bf16_f32 v123, v70, v71
  v_exp_f32 v74, v74
  v_exp_f32 v75, v75
  v_mfma_f32_32x32x16_bf16 v[96:111], v[136:139], v[120:123], v[96:111]
  v_cvt_pk_bf16_f32 v124, v72, v73
  v_exp_f32 v76, v76
  v_exp_f32 v77, v77
  v_cvt_pk_bf16_f32 v125, v74, v75
  v_exp_f32 v78, v78
  v_exp_f32 v79, v79
  v_cvt_pk_bf16_f32 v126, v76, v77
  v_cvt_pk_bf16_f32 v127, v78, v79
  v_exp_f32 v48, v48
  v_exp_f32 v49, v49
  v_mfma_f32_32x32x16_bf16 v[96:111], v[140:143], v[124:127], v[96:111]
  v_exp_f32 v50, v50
  v_exp_f32 v51, v51
  v_cvt_pk_bf16_f32 v112, v48, v49
  v_exp_f32 v52, v52
  v_exp_f32 v53, v53
  v_cvt_pk_bf16_f32 v113, v50, v51
  v_mfma_f32_32x32x16_bf16 v[64:79], v[132:135], v[12:15], v[32:47]
  ds_read_b128 v[128:131], v5 offset:12384
  ds_read_b128 v[136:139], v160 offset:13408
  ds_read_b128 v[140:143], v161 offset:13920
  v_exp_f32 v54, v54
  v_exp_f32 v55, v55
  v_cvt_pk_bf16_f32 v114, v52, v53
  v_exp_f32 v56, v56
  v_exp_f32 v57, v57
  v_cvt_pk_bf16_f32 v115, v54, v55
  v_exp_f32 v58, v58
  v_exp_f32 v59, v59
  v_mfma_f32_32x32x16_bf16 v[80:95], v[144:147], v[112:115], v[80:95]
  v_cvt_pk_bf16_f32 v116, v56, v57
  v_exp_f32 v60, v60
  v_exp_f32 v61, v61
  v_cvt_pk_bf16_f32 v117, v58, v59
  v_exp_f32 v62, v62
  v_exp_f32 v63, v63
  v_cvt_pk_bf16_f32 v118, v60, v61
  v_cvt_pk_bf16_f32 v119, v62, v63
  v_exp_f32 v64, v64
  v_exp_f32 v65, v65
  v_mfma_f32_32x32x16_bf16 v[80:95], v[148:151], v[116:119], v[80:95]
  v_exp_f32 v66, v66
  v_exp_f32 v67, v67
  v_cvt_pk_bf16_f32 v120, v64, v65
  v_exp_f32 v68, v68
  v_exp_f32 v69, v69
  v_cvt_pk_bf16_f32 v121, v66, v67
  s_waitcnt lgkmcnt(0)
  v_mfma_f32_32x32x16_bf16 v[48:63], v[128:131], v[8:11], v[16:31]
  v_exp_f32 v70, v70
  v_exp_f32 v71, v71
  v_cvt_pk_bf16_f32 v122, v68, v69
  v_exp_f32 v72, v72
  v_exp_f32 v73, v73
  v_cvt_pk_bf16_f32 v123, v70, v71
  v_exp_f32 v74, v74
  v_exp_f32 v75, v75
  v_mfma_f32_32x32x16_bf16 v[96:111], v[144:147], v[120:123], v[96:111]
  v_cvt_pk_bf16_f32 v124, v72, v73
  v_exp_f32 v76, v76
  v_exp_f32 v77, v77
  v_cvt_pk_bf16_f32 v125, v74, v75
  v_exp_f32 v78, v78
  v_exp_f32 v79, v79
  v_cvt_pk_bf16_f32 v126, v76, v77
  v_cvt_pk_bf16_f32 v127, v78, v79
  v_exp_f32 v48, v48
  v_exp_f32 v49, v49
  v_mfma_f32_32x32x16_bf16 v[96:111], v[148:151], v[124:127], v[96:111]
  v_exp_f32 v50, v50
  v_exp_f32 v51, v51
  v_cvt_pk_bf16_f32 v112, v48, v49
  v_exp_f32 v52, v52
  v_exp_f32 v53, v53
  v_cvt_pk_bf16_f32 v113, v50, v51
  v_mfma_f32_32x32x16_bf16 v[64:79], v[128:131], v[12:15], v[32:47]
  ds_read_b128 v[132:135], v5 offset:14432
  ds_read_b128 v[144:147], v162 offset:15456
  ds_read_b128 v[148:151], v163 offset:15968
  v_exp_f32 v54, v54
  v_exp_f32 v55, v55
  v_cvt_pk_bf16_f32 v114, v52, v53
  v_exp_f32 v56, v56
  v_exp_f32 v57, v57
  v_cvt_pk_bf16_f32 v115, v54, v55
  v_exp_f32 v58, v58
  v_exp_f32 v59, v59
  v_mfma_f32_32x32x16_bf16 v[80:95], v[136:139], v[112:115], v[80:95]
  v_cvt_pk_bf16_f32 v116, v56, v57
  v_exp_f32 v60, v60
  v_exp_f32 v61, v61
  v_cvt_pk_bf16_f32 v117, v58, v59
  v_exp_f32 v62, v62
  v_exp_f32 v63, v63
  v_cvt_pk_bf16_f32 v118, v60, v61
  v_cvt_pk_bf16_f32 v119, v62, v63
  v_exp_f32 v64, v64
  v_exp_f32 v65, v65
  v_mfma_f32_32x32x16_bf16 v[80:95], v[140:143], v[116:119], v[80:95]
  v_exp_f32 v66, v66
  v_exp_f32 v67, v67
  v_cvt_pk_bf16_f32 v120, v64, v65
  v_exp_f32 v68, v68
  v_exp_f32 v69, v69
  v_cvt_pk_bf16_f32 v121, v66, v67
  s_waitcnt lgkmcnt(0)
  v_mfma_f32_32x32x16_bf16 v[48:63], v[132:135], v[8:11], v[16:31]
  v_exp_f32 v70, v70
  v_exp_f32 v71, v71
  v_cvt_pk_bf16_f32 v122, v68, v69
  v_exp_f32 v72, v72
  v_exp_f32 v73, v73
  v_cvt_pk_bf16_f32 v123, v70, v71
  v_exp_f32 v74, v74
  v_exp_f32 v75, v75
  v_mfma_f32_32x32x16_bf16 v[96:111], v[136:139], v[120:123], v[96:111]
  v_cvt_pk_bf16_f32 v124, v72, v73
  v_exp_f32 v76, v76
  v_exp_f32 v77, v77
  v_cvt_pk_bf16_f32 v125, v74, v75
  v_exp_f32 v78, v78
  v_exp_f32 v79, v79
  v_cvt_pk_bf16_f32 v126, v76, v77
  v_cvt_pk_bf16_f32 v127, v78, v79
  v_exp_f32 v48, v48
  v_exp_f32 v49, v49
  v_mfma_f32_32x32x16_bf16 v[96:111], v[140:143], v[124:127], v[96:111]
  v_exp_f32 v50, v50
  v_exp_f32 v51, v51
  v_cvt_pk_bf16_f32 v112, v48, v49
  v_exp_f32 v52, v52
  v_exp_f32 v53, v53
  v_cvt_pk_bf16_f32 v113, v50, v51
  s_waitcnt vmcnt(8)
  s_barrier
  v_mfma_f32_32x32x16_bf16 v[64:79], v[132:135], v[12:15], v[32:47]
  ds_read_b128 v[128:131], v5 offset:16512
  ds_read_b128 v[136:139], v160 offset:17536
  ds_read_b128 v[140:143], v161 offset:18048
  v_exp_f32 v54, v54
  v_exp_f32 v55, v55
  v_cvt_pk_bf16_f32 v114, v52, v53
  v_exp_f32 v56, v56
  v_exp_f32 v57, v57
  v_cvt_pk_bf16_f32 v115, v54, v55
  v_exp_f32 v58, v58
  v_exp_f32 v59, v59
  v_mfma_f32_32x32x16_bf16 v[80:95], v[144:147], v[112:115], v[80:95]
  s_add_u32 m0, s67, 0
  s_add_u32 s68, s66, 65536
  buffer_load_dwordx4 v5, s[48:51], s68 offen offset:0 lds
  v_cvt_pk_bf16_f32 v116, v56, v57
  v_exp_f32 v60, v60
  v_exp_f32 v61, v61
  v_cvt_pk_bf16_f32 v117, v58, v59
  v_exp_f32 v62, v62
  v_exp_f32 v63, v63
  v_cvt_pk_bf16_f32 v118, v60, v61
  v_cvt_pk_bf16_f32 v119, v62, v63
  v_exp_f32 v64, v64
  v_exp_f32 v65, v65
  v_mfma_f32_32x32x16_bf16 v[80:95], v[148:151], v[116:119], v[80:95]
  buffer_load_dwordx4 v5, s[48:51], s68 offen offset:1024 lds
  v_exp_f32 v66, v66
  v_exp_f32 v67, v67
  v_cvt_pk_bf16_f32 v120, v64, v65
  v_exp_f32 v68, v68
  v_exp_f32 v69, v69
  v_cvt_pk_bf16_f32 v121, v66, v67
  s_waitcnt lgkmcnt(0)
  v_mfma_f32_32x32x16_bf16 v[48:63], v[128:131], v[8:11], v[16:31]
  buffer_load_dwordx4 v5, s[48:51], s68 offen offset:2048 lds
  v_exp_f32 v70, v70
  v_exp_f32 v71, v71
  v_cvt_pk_bf16_f32 v122, v68, v69
  v_exp_f32 v72, v72
  v_exp_f32 v73, v73
  v_cvt_pk_bf16_f32 v123, v70, v71
  v_exp_f32 v74, v74
  v_exp_f32 v75, v75
  v_mfma_f32_32x32x16_bf16 v[96:111], v[144:147], v[120:123], v[96:111]
  buffer_load_dwordx4 v5, s[48:51], s68 offen offset:3072 lds
  v_cvt_pk_bf16_f32 v124, v72, v73
  v_exp_f32 v76, v76
  v_exp_f32 v77, v77
  v_cvt_pk_bf16_f32 v125, v74, v75
  v_exp_f32 v78, v78
  v_exp_f32 v79, v79
  v_cvt_pk_bf16_f32 v126, v76, v77
  v_cvt_pk_bf16_f32 v127, v78, v79
  v_exp_f32 v48, v48
  v_exp_f32 v49, v49
  v_mfma_f32_32x32x16_bf16 v[96:111], v[148:151], v[124:127], v[96:111]
  v_exp_f32 v50, v50
  v_exp_f32 v51, v51
  v_cvt_pk_bf16_f32 v112, v48, v49
  v_exp_f32 v52, v52
  v_exp_f32 v53, v53
  v_cvt_pk_bf16_f32 v113, v50, v51
  v_mfma_f32_32x32x16_bf16 v[64:79], v[128:131], v[12:15], v[32:47]
  ds_read_b128 v[132:135], v5 offset:18560
  ds_read_b128 v[144:147], v162 offset:19584
  ds_read_b128 v[148:151], v163 offset:20096
  v_exp_f32 v54, v54
  v_exp_f32 v55, v55
  v_cvt_pk_bf16_f32 v114, v52, v53
  v_exp_f32 v56, v56
  v_exp_f32 v57, v57
  v_cvt_pk_bf16_f32 v115, v54, v55
  v_exp_f32 v58, v58
  v_exp_f32 v59, v59
  v_mfma_f32_32x32x16_bf16 v[80:95], v[136:139], v[112:115], v[80:95]
  v_cvt_pk_bf16_f32 v116, v56, v57
  v_exp_f32 v60, v60
  v_exp_f32 v61, v61
  v_cvt_pk_bf16_f32 v117, v58, v59
  v_exp_f32 v62, v62
  v_exp_f32 v63, v63
  v_cvt_pk_bf16_f32 v118, v60, v61
  v_cvt_pk_bf16_f32 v119, v62, v63
  v_exp_f32 v64, v64
  v_exp_f32 v65, v65
  v_mfma_f32_32x32x16_bf16 v[80:95], v[140:143], v[116:119], v[80:95]
  v_exp_f32 v66, v66
  v_exp_f32 v67, v67
  v_cvt_pk_bf16_f32 v120, v64, v65
  v_exp_f32 v68, v68
  v_exp_f32 v69, v69
  v_cvt_pk_bf16_f32 v121, v66, v67
  s_waitcnt lgkmcnt(0)
  v_mfma_f32_32x32x16_bf16 v[48:63], v[132:135], v[8:11], v[16:31]
  v_exp_f32 v70, v70
  v_exp_f32 v71, v71
  v_cvt_pk_bf16_f32 v122, v68, v69
  v_exp_f32 v72, v72
  v_exp_f32 v73, v73
  v_cvt_pk_bf16_f32 v123, v70, v71
  v_exp_f32 v74, v74
  v_exp_f32 v75, v75
  v_mfma_f32_32x32x16_bf16 v[96:111], v[136:139], v[120:123], v[96:111]
  v_cvt_pk_bf16_f32 v124, v72, v73
  v_exp_f32 v76, v76
  v_exp_f32 v77, v77
  v_cvt_pk_bf16_f32 v125, v74, v75
  v_exp_f32 v78, v78
  v_exp_f32 v79, v79
  v_cvt_pk_bf16_f32 v126, v76, v77
  v_cvt_pk_bf16_f32 v127, v78, v79
  v_exp_f32 v48, v48
  v_exp_f32 v49, v49
  v_mfma_f32_32x32x16_bf16 v[96:111], v[140:143], v[124:127], v[96:111]
  v_exp_f32 v50, v50
  v_exp_f32 v51, v51
  v_cvt_pk_bf16_f32 v112, v48, v49
  v_exp_f32 v52, v52
  v_exp_f32 v53, v53
  v_cvt_pk_bf16_f32 v113, v50, v51
  v_mfma_f32_32x32x16_bf16 v[64:79], v[132:135], v[12:15], v[32:47]
  ds_read_b128 v[128:131], v5 offset:20640
  ds_read_b128 v[136:139], v160 offset:21664
  ds_read_b128 v[140:143], v161 offset:22176
  v_exp_f32 v54, v54
  v_exp_f32 v55, v55
  v_cvt_pk_bf16_f32 v114, v52, v53
  v_exp_f32 v56, v56
  v_exp_f32 v57, v57
  v_cvt_pk_bf16_f32 v115, v54, v55
  v_exp_f32 v58, v58
  v_exp_f32 v59, v59
  v_mfma_f32_32x32x16_bf16 v[80:95], v[144:147], v[112:115], v[80:95]
  v_cvt_pk_bf16_f32 v116, v56, v57
  v_exp_f32 v60, v60
  v_exp_f32 v61, v61
  v_cvt_pk_bf16_f32 v117, v58, v59
  v_exp_f32 v62, v62
  v_exp_f32 v63, v63
  v_cvt_pk_bf16_f32 v118, v60, v61
  v_cvt_pk_bf16_f32 v119, v62, v63
  v_exp_f32 v64, v64
  v_exp_f32 v65, v65
  v_mfma_f32_32x32x16_bf16 v[80:95], v[148:151], v[116:119], v[80:95]
  v_exp_f32 v66, v66
  v_exp_f32 v67, v67
  v_cvt_pk_bf16_f32 v120, v64, v65
  v_exp_f32 v68, v68
  v_exp_f32 v69, v69
  v_cvt_pk_bf16_f32 v121, v66, v67
  s_waitcnt lgkmcnt(0)
  v_mfma_f32_32x32x16_bf16 v[48:63], v[128:131], v[8:11], v[16:31]
  v_exp_f32 v70, v70
  v_exp_f32 v71, v71
  v_cvt_pk_bf16_f32 v122, v68, v69
  v_exp_f32 v72, v72
  v_exp_f32 v73, v73
  v_cvt_pk_bf16_f32 v123, v70, v71
  v_exp_f32 v74, v74
  v_exp_f32 v75, v75
  v_mfma_f32_32x32x16_bf16 v[96:111], v[144:147], v[120:123], v[96:111]
  v_cvt_pk_bf16_f32 v124, v72, v73
  v_exp_f32 v76, v76
  v_exp_f32 v77, v77
  v_cvt_pk_bf16_f32 v125, v74, v75
  v_exp_f32 v78, v78
  v_exp_f32 v79, v79
  v_cvt_pk_bf16_f32 v126, v76, v77
  v_cvt_pk_bf16_f32 v127, v78, v79
  v_exp_f32 v48, v48
  v_exp_f32 v49, v49
  v_mfma_f32_32x32x16_bf16 v[96:111], v[148:151], v[124:127], v[96:111]
  v_exp_f32 v50, v50
  v_exp_f32 v51, v51
  v_cvt_pk_bf16_f32 v112, v48, v49
  v_exp_f32 v52, v52
  v_exp_f32 v53, v53
  v_cvt_pk_bf16_f32 v113, v50, v51
  v_mfma_f32_32x32x16_bf16 v[64:79], v[128:131], v[12:15], v[32:47]
  ds_read_b128 v[132:135], v5 offset:22688
  ds_read_b128 v[144:147], v162 offset:23712
  ds_read_b128 v[148:151], v163 offset:24224
  v_exp_f32 v54, v54
  v_exp_f32 v55, v55
  v_cvt_pk_bf16_f32 v114, v52, v53
  v_exp_f32 v56, v56
  v_exp_f32 v57, v57
  v_cvt_pk_bf16_f32 v115, v54, v55
  v_exp_f32 v58, v58
  v_exp_f32 v59, v59
  v_mfma_f32_32x32x16_bf16 v[80:95], v[136:139], v[112:115], v[80:95]
  v_cvt_pk_bf16_f32 v116, v56, v57
  v_exp_f32 v60, v60
  v_exp_f32 v61, v61
  v_cvt_pk_bf16_f32 v117, v58, v59
  v_exp_f32 v62, v62
  v_exp_f32 v63, v63
  v_cvt_pk_bf16_f32 v118, v60, v61
  v_cvt_pk_bf16_f32 v119, v62, v63
  v_exp_f32 v64, v64
  v_exp_f32 v65, v65
  v_mfma_f32_32x32x16_bf16 v[80:95], v[140:143], v[116:119], v[80:95]
  v_exp_f32 v66, v66
  v_exp_f32 v67, v67
  v_cvt_pk_bf16_f32 v120, v64, v65
  v_exp_f32 v68, v68
  v_exp_f32 v69, v69
  v_cvt_pk_bf16_f32 v121, v66, v67
  s_waitcnt lgkmcnt(0)
  v_mfma_f32_32x32x16_bf16 v[48:63], v[132:135], v[8:11], v[16:31]
  v_exp_f32 v70, v70
  v_exp_f32 v71, v71
  v_cvt_pk_bf16_f32 v122, v68, v69
  v_exp_f32 v72, v72
  v_exp_f32 v73, v73
  v_cvt_pk_bf16_f32 v123, v70, v71
  v_exp_f32 v74, v74
  v_exp_f32 v75, v75
  v_mfma_f32_32x32x16_bf16 v[96:111], v[136:139], v[120:123], v[96:111]
  v_cvt_pk_bf16_f32 v124, v72, v73
  v_exp_f32 v76, v76
  v_exp_f32 v77, v77
  v_cvt_pk_bf16_f32 v125, v74, v75
  v_exp_f32 v78, v78
  v_exp_f32 v79, v79
  v_cvt_pk_bf16_f32 v126, v76, v77
  v_cvt_pk_bf16_f32 v127, v78, v79
  v_exp_f32 v48, v48
  v_exp_f32 v49, v49
  v_mfma_f32_32x32x16_bf16 v[96:111], v[140:143], v[124:127], v[96:111]
  v_exp_f32 v50, v50
  v_exp_f32 v51, v51
  v_cvt_pk_bf16_f32 v112, v48, v49
  v_exp_f32 v52, v52
  v_exp_f32 v53, v53
  v_cvt_pk_bf16_f32 v113, v50, v51
  v_mfma_f32_32x32x16_bf16 v[64:79], v[132:135], v[12:15], v[32:47]
  ds_read_b128 v[128:131], v5 offset:24768
  ds_read_b128 v[136:139], v160 offset:25792
  ds_read_b128 v[140:143], v161 offset:26304
  v_exp_f32 v54, v54
  v_exp_f32 v55, v55
  v_cvt_pk_bf16_f32 v114, v52, v53
  v_exp_f32 v56, v56
  v_exp_f32 v57, v57
  v_cvt_pk_bf16_f32 v115, v54, v55
  v_exp_f32 v58, v58
  v_exp_f32 v59, v59
  v_mfma_f32_32x32x16_bf16 v[80:95], v[144:147], v[112:115], v[80:95]
  v_cvt_pk_bf16_f32 v116, v56, v57
  v_exp_f32 v60, v60
  v_exp_f32 v61, v61
  v_cvt_pk_bf16_f32 v117, v58, v59
  v_exp_f32 v62, v62
  v_exp_f32 v63, v63
  v_cvt_pk_bf16_f32 v118, v60, v61
  v_cvt_pk_bf16_f32 v119, v62, v63
  v_exp_f32 v64, v64
  v_exp_f32 v65, v65
  v_mfma_f32_32x32x16_bf16 v[80:95], v[148:151], v[116:119], v[80:95]
  v_exp_f32 v66, v66
  v_exp_f32 v67, v67
  v_cvt_pk_bf16_f32 v120, v64, v65
  v_exp_f32 v68, v68
  v_exp_f32 v69, v69
  v_cvt_pk_bf16_f32 v121, v66, v67
  s_waitcnt lgkmcnt(0)
  v_mfma_f32_32x32x16_bf16 v[48:63], v[128:131], v[8:11], v[16:31]
  v_exp_f32 v70, v70
  v_exp_f32 v71, v71
  v_cvt_pk_bf16_f32 v122, v68, v69
  v_exp_f32 v72, v72
  v_exp_f32 v73, v73
  v_cvt_pk_bf16_f32 v123, v70, v71
  v_exp_f32 v74, v74
  v_exp_f32 v75, v75
  v_mfma_f32_32x32x16_bf16 v[96:111], v[144:147], v[120:123], v[96:111]
  v_cvt_pk_bf16_f32 v124, v72, v73
  v_exp_f32 v76, v76
  v_exp_f32 v77, v77
  v_cvt_pk_bf16_f32 v125, v74, v75
  v_exp_f32 v78, v78
  v_exp_f32 v79, v79
  v_cvt_pk_bf16_f32 v126, v76, v77
  v_cvt_pk_bf16_f32 v127, v78, v79
  v_exp_f32 v48, v48
  v_exp_f32 v49, v49
  v_mfma_f32_32x32x16_bf16 v[96:111], v[148:151], v[124:127], v[96:111]
  v_exp_f32 v50, v50
  v_exp_f32 v51, v51
  v_cvt_pk_bf16_f32 v112, v48, v49
  v_exp_f32 v52, v52
  v_exp_f32 v53, v53
  v_cvt_pk_bf16_f32 v113, v50, v51
  v_mfma_f32_32x32x16_bf16 v[64:79], v[128:131], v[12:15], v[32:47]
  ds_read_b128 v[132:135], v5 offset:26816
  ds_read_b128 v[144:147], v162 offset:27840
  ds_read_b128 v[148:151], v163 offset:28352
  v_exp_f32 v54, v54
  v_exp_f32 v55, v55
  v_cvt_pk_bf16_f32 v114, v52, v53
  v_exp_f32 v56, v56
  v_exp_f32 v57, v57
  v_cvt_pk_bf16_f32 v115, v54, v55
  v_exp_f32 v58, v58
  v_exp_f32 v59, v59
  v_mfma_f32_32x32x16_bf16 v[80:95], v[136:139], v[112:115], v[80:95]
  v_cvt_pk_bf16_f32 v116, v56, v57
  v_exp_f32 v60, v60
  v_exp_f32 v61, v61
  v_cvt_pk_bf16_f32 v117, v58, v59
  v_exp_f32 v62, v62
  v_exp_f32 v63, v63
  v_cvt_pk_bf16_f32 v118, v60, v61
  v_cvt_pk_bf16_f32 v119, v62, v63
  v_exp_f32 v64, v64
  v_exp_f32 v65, v65
  v_mfma_f32_32x32x16_bf16 v[80:95], v[140:143], v[116:119], v[80:95]
  v_exp_f32 v66, v66
  v_exp_f32 v67, v67
  v_cvt_pk_bf16_f32 v120, v64, v65
  v_exp_f32 v68, v68
  v_exp_f32 v69, v69
  v_cvt_pk_bf16_f32 v121, v66, v67
  s_waitcnt lgkmcnt(0)
  v_mfma_f32_32x32x16_bf16 v[48:63], v[132:135], v[8:11], v[16:31]
  v_exp_f32 v70, v70
  v_exp_f32 v71, v71
  v_cvt_pk_bf16_f32 v122, v68, v69
  v_exp_f32 v72, v72
  v_exp_f32 v73, v73
  v_cvt_pk_bf16_f32 v123, v70, v71
  v_exp_f32 v74, v74
  v_exp_f32 v75, v75
  v_mfma_f32_32x32x16_bf16 v[96:111], v[136:139], v[120:123], v[96:111]
  v_cvt_pk_bf16_f32 v124, v72, v73
  v_exp_f32 v76, v76
  v_exp_f32 v77, v77
  v_cvt_pk_bf16_f32 v125, v74, v75
  v_exp_f32 v78, v78
  v_exp_f32 v79, v79
  v_cvt_pk_bf16_f32 v126, v76, v77
  v_cvt_pk_bf16_f32 v127, v78, v79
  v_exp_f32 v48, v48
  v_exp_f32 v49, v49
  v_mfma_f32_32x32x16_bf16 v[96:111], v[140:143], v[124:127], v[96:111]
  v_exp_f32 v50, v50
  v_exp_f32 v51, v51
  v_cvt_pk_bf16_f32 v112, v48, v49
  v_exp_f32 v52, v52
  v_exp_f32 v53, v53
  v_cvt_pk_bf16_f32 v113, v50, v51
  v_mfma_f32_32x32x16_bf16 v[64:79], v[132:135], v[12:15], v[32:47]
  ds_read_b128 v[128:131], v5 offset:28896
  ds_read_b128 v[136:139], v160 offset:29920
  ds_read_b128 v[140:143], v161 offset:30432
  v_exp_f32 v54, v54
  v_exp_f32 v55, v55
  v_cvt_pk_bf16_f32 v114, v52, v53
  v_exp_f32 v56, v56
  v_exp_f32 v57, v57
  v_cvt_pk_bf16_f32 v115, v54, v55
  v_exp_f32 v58, v58
  v_exp_f32 v59, v59
  v_mfma_f32_32x32x16_bf16 v[80:95], v[144:147], v[112:115], v[80:95]
  v_cvt_pk_bf16_f32 v116, v56, v57
  v_exp_f32 v60, v60
  v_exp_f32 v61, v61
  v_cvt_pk_bf16_f32 v117, v58, v59
  v_exp_f32 v62, v62
  v_exp_f32 v63, v63
  v_cvt_pk_bf16_f32 v118, v60, v61
  v_cvt_pk_bf16_f32 v119, v62, v63
  v_exp_f32 v64, v64
  v_exp_f32 v65, v65
  v_mfma_f32_32x32x16_bf16 v[80:95], v[148:151], v[116:119], v[80:95]
  v_exp_f32 v66, v66
  v_exp_f32 v67, v67
  v_cvt_pk_bf16_f32 v120, v64, v65
  v_exp_f32 v68, v68
  v_exp_f32 v69, v69
  v_cvt_pk_bf16_f32 v121, v66, v67
  s_waitcnt lgkmcnt(0)
  v_mfma_f32_32x32x16_bf16 v[48:63], v[128:131], v[8:11], v[16:31]
  v_exp_f32 v70, v70
  v_exp_f32 v71, v71
  v_cvt_pk_bf16_f32 v122, v68, v69
  v_exp_f32 v72, v72
  v_exp_f32 v73, v73
  v_cvt_pk_bf16_f32 v123, v70, v71
  v_exp_f32 v74, v74
  v_exp_f32 v75, v75
  v_mfma_f32_32x32x16_bf16 v[96:111], v[144:147], v[120:123], v[96:111]
  v_cvt_pk_bf16_f32 v124, v72, v73
  v_exp_f32 v76, v76
  v_exp_f32 v77, v77
  v_cvt_pk_bf16_f32 v125, v74, v75
  v_exp_f32 v78, v78
  v_exp_f32 v79, v79
  v_cvt_pk_bf16_f32 v126, v76, v77
  v_cvt_pk_bf16_f32 v127, v78, v79
  v_exp_f32 v48, v48
  v_exp_f32 v49, v49
  v_mfma_f32_32x32x16_bf16 v[96:111], v[148:151], v[124:127], v[96:111]
  v_exp_f32 v50, v50
  v_exp_f32 v51, v51
  v_cvt_pk_bf16_f32 v112, v48, v49
  v_exp_f32 v52, v52
  v_exp_f32 v53, v53
  v_cvt_pk_bf16_f32 v113, v50, v51
  v_mfma_f32_32x32x16_bf16 v[64:79], v[128:131], v[12:15], v[32:47]
  ds_read_b128 v[132:135], v5 offset:30944
  ds_read_b128 v[144:147], v162 offset:31968
  ds_read_b128 v[148:151], v163 offset:32480
  v_exp_f32 v54, v54
  v_exp_f32 v55, v55
  v_cvt_pk_bf16_f32 v114, v52, v53
  v_exp_f32 v56, v56
  v_exp_f32 v57, v57
  v_cvt_pk_bf16_f32 v115, v54, v55
  v_exp_f32 v58, v58
  v_exp_f32 v59, v59
  v_mfma_f32_32x32x16_bf16 v[80:95], v[136:139], v[112:115], v[80:95]
  v_cvt_pk_bf16_f32 v116, v56, v57
  v_exp_f32 v60, v60
  v_exp_f32 v61, v61
  v_cvt_pk_bf16_f32 v117, v58, v59
  v_exp_f32 v62, v62
  v_exp_f32 v63, v63
  v_cvt_pk_bf16_f32 v118, v60, v61
  v_cvt_pk_bf16_f32 v119, v62, v63
  v_exp_f32 v64, v64
  v_exp_f32 v65, v65
  v_mfma_f32_32x32x16_bf16 v[80:95], v[140:143], v[116:119], v[80:95]
  v_exp_f32 v66, v66
  v_exp_f32 v67, v67
  v_cvt_pk_bf16_f32 v120, v64, v65
  v_exp_f32 v68, v68
  v_exp_f32 v69, v69
  v_cvt_pk_bf16_f32 v121, v66, v67
  s_waitcnt lgkmcnt(0)
  v_mfma_f32_32x32x16_bf16 v[48:63], v[132:135], v[8:11], v[16:31]
  v_exp_f32 v70, v70
  v_exp_f32 v71, v71
  v_cvt_pk_bf16_f32 v122, v68, v69
  v_exp_f32 v72, v72
  v_exp_f32 v73, v73
  v_cvt_pk_bf16_f32 v123, v70, v71
  v_exp_f32 v74, v74
  v_exp_f32 v75, v75
  v_mfma_f32_32x32x16_bf16 v[96:111], v[136:139], v[120:123], v[96:111]
  v_cvt_pk_bf16_f32 v124, v72, v73
  v_exp_f32 v76, v76
  v_exp_f32 v77, v77
  v_cvt_pk_bf16_f32 v125, v74, v75
  v_exp_f32 v78, v78
  v_exp_f32 v79, v79
  v_cvt_pk_bf16_f32 v126, v76, v77
  v_cvt_pk_bf16_f32 v127, v78, v79
  v_exp_f32 v48, v48
  v_exp_f32 v49, v49
  v_mfma_f32_32x32x16_bf16 v[96:111], v[140:143], v[124:127], v[96:111]
  v_exp_f32 v50, v50
  v_exp_f32 v51, v51
  v_cvt_pk_bf16_f32 v112, v48, v49
  v_exp_f32 v52, v52
  v_exp_f32 v53, v53
  v_cvt_pk_bf16_f32 v113, v50, v51
  s_waitcnt vmcnt(8)
  s_barrier
  v_mfma_f32_32x32x16_bf16 v[64:79], v[132:135], v[12:15], v[32:47]
  ds_read_b128 v[128:131], v5 offset:33024
  ds_read_b128 v[136:139], v160 offset:34048
  ds_read_b128 v[140:143], v161 offset:34560
  v_exp_f32 v54, v54
  v_exp_f32 v55, v55
  v_cvt_pk_bf16_f32 v114, v52, v53
  v_exp_f32 v56, v56
  v_exp_f32 v57, v57
  v_cvt_pk_bf16_f32 v115, v54, v55
  v_exp_f32 v58, v58
  v_exp_f32 v59, v59
  v_mfma_f32_32x32x16_bf16 v[80:95], v[144:147], v[112:115], v[80:95]
  s_add_u32 m0, s67, 16512
  s_add_u32 s68, s66, 81920
  buffer_load_dwordx4 v5, s[48:51], s68 offen offset:0 lds
  v_cvt_pk_bf16_f32 v116, v56, v57
  v_exp_f32 v60, v60
  v_exp_f32 v61, v61
  v_cvt_pk_bf16_f32 v117, v58, v59
  v_exp_f32 v62, v62
  v_exp_f32 v63, v63
  v_cvt_pk_bf16_f32 v118, v60, v61
  v_cvt_pk_bf16_f32 v119, v62, v63
  v_exp_f32 v64, v64
  v_exp_f32 v65, v65
  v_mfma_f32_32x32x16_bf16 v[80:95], v[148:151], v[116:119], v[80:95]
  buffer_load_dwordx4 v5, s[48:51], s68 offen offset:1024 lds
  v_exp_f32 v66, v66
  v_exp_f32 v67, v67
  v_cvt_pk_bf16_f32 v120, v64, v65
  v_exp_f32 v68, v68
  v_exp_f32 v69, v69
  v_cvt_pk_bf16_f32 v121, v66, v67
  s_waitcnt lgkmcnt(0)
  v_mfma_f32_32x32x16_bf16 v[48:63], v[128:131], v[8:11], v[16:31]
  buffer_load_dwordx4 v5, s[48:51], s68 offen offset:2048 lds
  v_exp_f32 v70, v70
  v_exp_f32 v71, v71
  v_cvt_pk_bf16_f32 v122, v68, v69
  v_exp_f32 v72, v72
  v_exp_f32 v73, v73
  v_cvt_pk_bf16_f32 v123, v70, v71
  v_exp_f32 v74, v74
  v_exp_f32 v75, v75
  v_mfma_f32_32x32x16_bf16 v[96:111], v[144:147], v[120:123], v[96:111]
  buffer_load_dwordx4 v5, s[48:51], s68 offen offset:3072 lds
  v_cvt_pk_bf16_f32 v124, v72, v73
  v_exp_f32 v76, v76
  v_exp_f32 v77, v77
  v_cvt_pk_bf16_f32 v125, v74, v75
  v_exp_f32 v78, v78
  v_exp_f32 v79, v79
  v_cvt_pk_bf16_f32 v126, v76, v77
  v_cvt_pk_bf16_f32 v127, v78, v79
  v_exp_f32 v48, v48
  v_exp_f32 v49, v49
  v_mfma_f32_32x32x16_bf16 v[96:111], v[148:151], v[124:127], v[96:111]
  v_exp_f32 v50, v50
  v_exp_f32 v51, v51
  v_cvt_pk_bf16_f32 v112, v48, v49
  v_exp_f32 v52, v52
  v_exp_f32 v53, v53
  v_cvt_pk_bf16_f32 v113, v50, v51
  v_mfma_f32_32x32x16_bf16 v[64:79], v[128:131], v[12:15], v[32:47]
  ds_read_b128 v[132:135], v5 offset:35072
  ds_read_b128 v[144:147], v162 offset:36096
  ds_read_b128 v[148:151], v163 offset:36608
  v_exp_f32 v54, v54
  v_exp_f32 v55, v55
  v_cvt_pk_bf16_f32 v114, v52, v53
  v_exp_f32 v56, v56
  v_exp_f32 v57, v57
  v_cvt_pk_bf16_f32 v115, v54, v55
  v_exp_f32 v58, v58
  v_exp_f32 v59, v59
  v_mfma_f32_32x32x16_bf16 v[80:95], v[136:139], v[112:115], v[80:95]
  v_cvt_pk_bf16_f32 v116, v56, v57
  v_exp_f32 v60, v60
  v_exp_f32 v61, v61
  v_cvt_pk_bf16_f32 v117, v58, v59
  v_exp_f32 v62, v62
  v_exp_f32 v63, v63
  v_cvt_pk_bf16_f32 v118, v60, v61
  v_cvt_pk_bf16_f32 v119, v62, v63
  v_exp_f32 v64, v64
  v_exp_f32 v65, v65
  v_mfma_f32_32x32x16_bf16 v[80:95], v[140:143], v[116:119], v[80:95]
  v_exp_f32 v66, v66
  v_exp_f32 v67, v67
  v_cvt_pk_bf16_f32 v120, v64, v65
  v_exp_f32 v68, v68
  v_exp_f32 v69, v69
  v_cvt_pk_bf16_f32 v121, v66, v67
  s_waitcnt lgkmcnt(0)
  v_mfma_f32_32x32x16_bf16 v[48:63], v[132:135], v[8:11], v[16:31]
  v_exp_f32 v70, v70
  v_exp_f32 v71, v71
  v_cvt_pk_bf16_f32 v122, v68, v69
  v_exp_f32 v72, v72
  v_exp_f32 v73, v73
  v_cvt_pk_bf16_f32 v123, v70, v71
  v_exp_f32 v74, v74
  v_exp_f32 v75, v75
  v_mfma_f32_32x32x16_bf16 v[96:111], v[136:139], v[120:123], v[96:111]
  v_cvt_pk_bf16_f32 v124, v72, v73
  v_exp_f32 v76, v76
  v_exp_f32 v77, v77
  v_cvt_pk_bf16_f32 v125, v74, v75
  v_exp_f32 v78, v78
  v_exp_f32 v79, v79
  v_cvt_pk_bf16_f32 v126, v76, v77
  v_cvt_pk_bf16_f32 v127, v78, v79
  v_exp_f32 v48, v48
  v_exp_f32 v49, v49
  v_mfma_f32_32x32x16_bf16 v[96:111], v[140:143], v[124:127], v[96:111]
  v_exp_f32 v50, v50
  v_exp_f32 v51, v51
  v_cvt_pk_bf16_f32 v112, v48, v49
  v_exp_f32 v52, v52
  v_exp_f32 v53, v53
  v_cvt_pk_bf16_f32 v113, v50, v51
  v_mfma_f32_32x32x16_bf16 v[64:79], v[132:135], v[12:15], v[32:47]
  ds_read_b128 v[128:131], v5 offset:37152
  ds_read_b128 v[136:139], v160 offset:38176
  ds_read_b128 v[140:143], v161 offset:38688
  v_exp_f32 v54, v54
  v_exp_f32 v55, v55
  v_cvt_pk_bf16_f32 v114, v52, v53
  v_exp_f32 v56, v56
  v_exp_f32 v57, v57
  v_cvt_pk_bf16_f32 v115, v54, v55
  v_exp_f32 v58, v58
  v_exp_f32 v59, v59
  v_mfma_f32_32x32x16_bf16 v[80:95], v[144:147], v[112:115], v[80:95]
  v_cvt_pk_bf16_f32 v116, v56, v57
  v_exp_f32 v60, v60
  v_exp_f32 v61, v61
  v_cvt_pk_bf16_f32 v117, v58, v59
  v_exp_f32 v62, v62
  v_exp_f32 v63, v63
  v_cvt_pk_bf16_f32 v118, v60, v61
  v_cvt_pk_bf16_f32 v119, v62, v63
  v_exp_f32 v64, v64
  v_exp_f32 v65, v65
  v_mfma_f32_32x32x16_bf16 v[80:95], v[148:151], v[116:119], v[80:95]
  v_exp_f32 v66, v66
  v_exp_f32 v67, v67
  v_cvt_pk_bf16_f32 v120, v64, v65
  v_exp_f32 v68, v68
  v_exp_f32 v69, v69
  v_cvt_pk_bf16_f32 v121, v66, v67
  s_waitcnt lgkmcnt(0)
  v_mfma_f32_32x32x16_bf16 v[48:63], v[128:131], v[8:11], v[16:31]
  v_exp_f32 v70, v70
  v_exp_f32 v71, v71
  v_cvt_pk_bf16_f32 v122, v68, v69
  v_exp_f32 v72, v72
  v_exp_f32 v73, v73
  v_cvt_pk_bf16_f32 v123, v70, v71
  v_exp_f32 v74, v74
  v_exp_f32 v75, v75
  v_mfma_f32_32x32x16_bf16 v[96:111], v[144:147], v[120:123], v[96:111]
  v_cvt_pk_bf16_f32 v124, v72, v73
  v_exp_f32 v76, v76
  v_exp_f32 v77, v77
  v_cvt_pk_bf16_f32 v125, v74, v75
  v_exp_f32 v78, v78
  v_exp_f32 v79, v79
  v_cvt_pk_bf16_f32 v126, v76, v77
  v_cvt_pk_bf16_f32 v127, v78, v79
  v_exp_f32 v48, v48
  v_exp_f32 v49, v49
  v_mfma_f32_32x32x16_bf16 v[96:111], v[148:151], v[124:127], v[96:111]
  v_exp_f32 v50, v50
  v_exp_f32 v51, v51
  v_cvt_pk_bf16_f32 v112, v48, v49
  v_exp_f32 v52, v52
  v_exp_f32 v53, v53
  v_cvt_pk_bf16_f32 v113, v50, v51
  v_mfma_f32_32x32x16_bf16 v[64:79], v[128:131], v[12:15], v[32:47]
  ds_read_b128 v[132:135], v5 offset:39200
  ds_read_b128 v[144:147], v162 offset:40224
  ds_read_b128 v[148:151], v163 offset:40736
  v_exp_f32 v54, v54
  v_exp_f32 v55, v55
  v_cvt_pk_bf16_f32 v114, v52, v53
  v_exp_f32 v56, v56
  v_exp_f32 v57, v57
  v_cvt_pk_bf16_f32 v115, v54, v55
  v_exp_f32 v58, v58
  v_exp_f32 v59, v59
  v_mfma_f32_32x32x16_bf16 v[80:95], v[136:139], v[112:115], v[80:95]
  v_cvt_pk_bf16_f32 v116, v56, v57
  v_exp_f32 v60, v60
  v_exp_f32 v61, v61
  v_cvt_pk_bf16_f32 v117, v58, v59
  v_exp_f32 v62, v62
  v_exp_f32 v63, v63
  v_cvt_pk_bf16_f32 v118, v60, v61
  v_cvt_pk_bf16_f32 v119, v62, v63
  v_exp_f32 v64, v64
  v_exp_f32 v65, v65
  v_mfma_f32_32x32x16_bf16 v[80:95], v[140:143], v[116:119], v[80:95]
  v_exp_f32 v66, v66
  v_exp_f32 v67, v67
  v_cvt_pk_bf16_f32 v120, v64, v65
  v_exp_f32 v68, v68
  v_exp_f32 v69, v69
  v_cvt_pk_bf16_f32 v121, v66, v67
  s_waitcnt lgkmcnt(0)
  v_mfma_f32_32x32x16_bf16 v[48:63], v[132:135], v[8:11], v[16:31]
  v_exp_f32 v70, v70
  v_exp_f32 v71, v71
  v_cvt_pk_bf16_f32 v122, v68, v69
  v_exp_f32 v72, v72
  v_exp_f32 v73, v73
  v_cvt_pk_bf16_f32 v123, v70, v71
  v_exp_f32 v74, v74
  v_exp_f32 v75, v75
  v_mfma_f32_32x32x16_bf16 v[96:111], v[136:139], v[120:123], v[96:111]
  v_cvt_pk_bf16_f32 v124, v72, v73
  v_exp_f32 v76, v76
  v_exp_f32 v77, v77
  v_cvt_pk_bf16_f32 v125, v74, v75
  v_exp_f32 v78, v78
  v_exp_f32 v79, v79
  v_cvt_pk_bf16_f32 v126, v76, v77
  v_cvt_pk_bf16_f32 v127, v78, v79
  v_exp_f32 v48, v48
  v_exp_f32 v49, v49
  v_mfma_f32_32x32x16_bf16 v[96:111], v[140:143], v[124:127], v[96:111]
  v_exp_f32 v50, v50
  v_exp_f32 v51, v51
  v_cvt_pk_bf16_f32 v112, v48, v49
  v_exp_f32 v52, v52
  v_exp_f32 v53, v53
  v_cvt_pk_bf16_f32 v113, v50, v51
  v_mfma_f32_32x32x16_bf16 v[64:79], v[132:135], v[12:15], v[32:47]
  ds_read_b128 v[128:131], v5 offset:41280
  ds_read_b128 v[136:139], v160 offset:42304
  ds_read_b128 v[140:143], v161 offset:42816
  v_exp_f32 v54, v54
  v_exp_f32 v55, v55
  v_cvt_pk_bf16_f32 v114, v52, v53
  v_exp_f32 v56, v56
  v_exp_f32 v57, v57
  v_cvt_pk_bf16_f32 v115, v54, v55
  v_exp_f32 v58, v58
  v_exp_f32 v59, v59
  v_mfma_f32_32x32x16_bf16 v[80:95], v[144:147], v[112:115], v[80:95]
  v_cvt_pk_bf16_f32 v116, v56, v57
  v_exp_f32 v60, v60
  v_exp_f32 v61, v61
  v_cvt_pk_bf16_f32 v117, v58, v59
  v_exp_f32 v62, v62
  v_exp_f32 v63, v63
  v_cvt_pk_bf16_f32 v118, v60, v61
  v_cvt_pk_bf16_f32 v119, v62, v63
  v_exp_f32 v64, v64
  v_exp_f32 v65, v65
  v_mfma_f32_32x32x16_bf16 v[80:95], v[148:151], v[116:119], v[80:95]
  v_exp_f32 v66, v66
  v_exp_f32 v67, v67
  v_cvt_pk_bf16_f32 v120, v64, v65
  v_exp_f32 v68, v68
  v_exp_f32 v69, v69
  v_cvt_pk_bf16_f32 v121, v66, v67
  s_waitcnt lgkmcnt(0)
  v_mfma_f32_32x32x16_bf16 v[48:63], v[128:131], v[8:11], v[16:31]
  v_exp_f32 v70, v70
  v_exp_f32 v71, v71
  v_cvt_pk_bf16_f32 v122, v68, v69
  v_exp_f32 v72, v72
  v_exp_f32 v73, v73
  v_cvt_pk_bf16_f32 v123, v70, v71
  v_exp_f32 v74, v74
  v_exp_f32 v75, v75
  v_mfma_f32_32x32x16_bf16 v[96:111], v[144:147], v[120:123], v[96:111]
  v_cvt_pk_bf16_f32 v124, v72, v73
  v_exp_f32 v76, v76
  v_exp_f32 v77, v77
  v_cvt_pk_bf16_f32 v125, v74, v75
  v_exp_f32 v78, v78
  v_exp_f32 v79, v79
  v_cvt_pk_bf16_f32 v126, v76, v77
  v_cvt_pk_bf16_f32 v127, v78, v79
  v_exp_f32 v48, v48
  v_exp_f32 v49, v49
  v_mfma_f32_32x32x16_bf16 v[96:111], v[148:151], v[124:127], v[96:111]
  v_exp_f32 v50, v50
  v_exp_f32 v51, v51
  v_cvt_pk_bf16_f32 v112, v48, v49
  v_exp_f32 v52, v52
  v_exp_f32 v53, v53
  v_cvt_pk_bf16_f32 v113, v50, v51
  v_mfma_f32_32x32x16_bf16 v[64:79], v[128:131], v[12:15], v[32:47]
  ds_read_b128 v[132:135], v5 offset:43328
  ds_read_b128 v[144:147], v162 offset:44352
  ds_read_b128 v[148:151], v163 offset:44864
  v_exp_f32 v54, v54
  v_exp_f32 v55, v55
  v_cvt_pk_bf16_f32 v114, v52, v53
  v_exp_f32 v56, v56
  v_exp_f32 v57, v57
  v_cvt_pk_bf16_f32 v115, v54, v55
  v_exp_f32 v58, v58
  v_exp_f32 v59, v59
  v_mfma_f32_32x32x16_bf16 v[80:95], v[136:139], v[112:115], v[80:95]
  v_cvt_pk_bf16_f32 v116, v56, v57
  v_exp_f32 v60, v60
  v_exp_f32 v61, v61
  v_cvt_pk_bf16_f32 v117, v58, v59
  v_exp_f32 v62, v62
  v_exp_f32 v63, v63
  v_cvt_pk_bf16_f32 v118, v60, v61
  v_cvt_pk_bf16_f32 v119, v62, v63
  v_exp_f32 v64, v64
  v_exp_f32 v65, v65
  v_mfma_f32_32x32x16_bf16 v[80:95], v[140:143], v[116:119], v[80:95]
  v_exp_f32 v66, v66
  v_exp_f32 v67, v67
  v_cvt_pk_bf16_f32 v120, v64, v65
  v_exp_f32 v68, v68
  v_exp_f32 v69, v69
  v_cvt_pk_bf16_f32 v121, v66, v67
  s_waitcnt lgkmcnt(0)
  v_mfma_f32_32x32x16_bf16 v[48:63], v[132:135], v[8:11], v[16:31]
  v_exp_f32 v70, v70
  v_exp_f32 v71, v71
  v_cvt_pk_bf16_f32 v122, v68, v69
  v_exp_f32 v72, v72
  v_exp_f32 v73, v73
  v_cvt_pk_bf16_f32 v123, v70, v71
  v_exp_f32 v74, v74
  v_exp_f32 v75, v75
  v_mfma_f32_32x32x16_bf16 v[96:111], v[136:139], v[120:123], v[96:111]
  v_cvt_pk_bf16_f32 v124, v72, v73
  v_exp_f32 v76, v76
  v_exp_f32 v77, v77
  v_cvt_pk_bf16_f32 v125, v74, v75
  v_exp_f32 v78, v78
  v_exp_f32 v79, v79
  v_cvt_pk_bf16_f32 v126, v76, v77
  v_cvt_pk_bf16_f32 v127, v78, v79
  v_exp_f32 v48, v48
  v_exp_f32 v49, v49
  v_mfma_f32_32x32x16_bf16 v[96:111], v[140:143], v[124:127], v[96:111]
  v_exp_f32 v50, v50
  v_exp_f32 v51, v51
  v_cvt_pk_bf16_f32 v112, v48, v49
  v_exp_f32 v52, v52
  v_exp_f32 v53, v53
  v_cvt_pk_bf16_f32 v113, v50, v51
  v_mfma_f32_32x32x16_bf16 v[64:79], v[132:135], v[12:15], v[32:47]
  ds_read_b128 v[128:131], v5 offset:45408
  ds_read_b128 v[136:139], v160 offset:46432
  ds_read_b128 v[140:143], v161 offset:46944
  v_exp_f32 v54, v54
  v_exp_f32 v55, v55
  v_cvt_pk_bf16_f32 v114, v52, v53
  v_exp_f32 v56, v56
  v_exp_f32 v57, v57
  v_cvt_pk_bf16_f32 v115, v54, v55
  v_exp_f32 v58, v58
  v_exp_f32 v59, v59
  v_mfma_f32_32x32x16_bf16 v[80:95], v[144:147], v[112:115], v[80:95]
  v_cvt_pk_bf16_f32 v116, v56, v57
  v_exp_f32 v60, v60
  v_exp_f32 v61, v61
  v_cvt_pk_bf16_f32 v117, v58, v59
  v_exp_f32 v62, v62
  v_exp_f32 v63, v63
  v_cvt_pk_bf16_f32 v118, v60, v61
  v_cvt_pk_bf16_f32 v119, v62, v63
  v_exp_f32 v64, v64
  v_exp_f32 v65, v65
  v_mfma_f32_32x32x16_bf16 v[80:95], v[148:151], v[116:119], v[80:95]
  v_exp_f32 v66, v66
  v_exp_f32 v67, v67
  v_cvt_pk_bf16_f32 v120, v64, v65
  v_exp_f32 v68, v68
  v_exp_f32 v69, v69
  v_cvt_pk_bf16_f32 v121, v66, v67
  s_waitcnt lgkmcnt(0)
  v_mfma_f32_32x32x16_bf16 v[48:63], v[128:131], v[8:11], v[16:31]
  v_exp_f32 v70, v70
  v_exp_f32 v71, v71
  v_cvt_pk_bf16_f32 v122, v68, v69
  v_exp_f32 v72, v72
  v_exp_f32 v73, v73
  v_cvt_pk_bf16_f32 v123, v70, v71
  v_exp_f32 v74, v74
  v_exp_f32 v75, v75
  v_mfma_f32_32x32x16_bf16 v[96:111], v[144:147], v[120:123], v[96:111]
  v_cvt_pk_bf16_f32 v124, v72, v73
  v_exp_f32 v76, v76
  v_exp_f32 v77, v77
  v_cvt_pk_bf16_f32 v125, v74, v75
  v_exp_f32 v78, v78
  v_exp_f32 v79, v79
  v_cvt_pk_bf16_f32 v126, v76, v77
  v_cvt_pk_bf16_f32 v127, v78, v79
  v_exp_f32 v48, v48
  v_exp_f32 v49, v49
  v_mfma_f32_32x32x16_bf16 v[96:111], v[148:151], v[124:127], v[96:111]
  v_exp_f32 v50, v50
  v_exp_f32 v51, v51
  v_cvt_pk_bf16_f32 v112, v48, v49
  v_exp_f32 v52, v52
  v_exp_f32 v53, v53
  v_cvt_pk_bf16_f32 v113, v50, v51
  v_mfma_f32_32x32x16_bf16 v[64:79], v[128:131], v[12:15], v[32:47]
  ds_read_b128 v[132:135], v5 offset:47456
  ds_read_b128 v[144:147], v162 offset:48480
  ds_read_b128 v[148:151], v163 offset:48992
  v_exp_f32 v54, v54
  v_exp_f32 v55, v55
  v_cvt_pk_bf16_f32 v114, v52, v53
  v_exp_f32 v56, v56
  v_exp_f32 v57, v57
  v_cvt_pk_bf16_f32 v115, v54, v55
  v_exp_f32 v58, v58
  v_exp_f32 v59, v59
  v_mfma_f32_32x32x16_bf16 v[80:95], v[136:139], v[112:115], v[80:95]
  v_cvt_pk_bf16_f32 v116, v56, v57
  v_exp_f32 v60, v60
  v_exp_f32 v61, v61
  v_cvt_pk_bf16_f32 v117, v58, v59
  v_exp_f32 v62, v62
  v_exp_f32 v63, v63
  v_cvt_pk_bf16_f32 v118, v60, v61
  v_cvt_pk_bf16_f32 v119, v62, v63
  v_exp_f32 v64, v64
  v_exp_f32 v65, v65
  v_mfma_f32_32x32x16_bf16 v[80:95], v[140:143], v[116:119], v[80:95]
  v_exp_f32 v66, v66
  v_exp_f32 v67, v67
  v_cvt_pk_bf16_f32 v120, v64, v65
  v_exp_f32 v68, v68
  v_exp_f32 v69, v69
  v_cvt_pk_bf16_f32 v121, v66, v67
  s_waitcnt lgkmcnt(0)
  v_mfma_f32_32x32x16_bf16 v[48:63], v[132:135], v[8:11], v[16:31]
  v_exp_f32 v70, v70
  v_exp_f32 v71, v71
  v_cvt_pk_bf16_f32 v122, v68, v69
  v_exp_f32 v72, v72
  v_exp_f32 v73, v73
  v_cvt_pk_bf16_f32 v123, v70, v71
  v_exp_f32 v74, v74
  v_exp_f32 v75, v75
  v_mfma_f32_32x32x16_bf16 v[96:111], v[136:139], v[120:123], v[96:111]
  v_cvt_pk_bf16_f32 v124, v72, v73
  v_exp_f32 v76, v76
  v_exp_f32 v77, v77
  v_cvt_pk_bf16_f32 v125, v74, v75
  v_exp_f32 v78, v78
  v_exp_f32 v79, v79
  v_cvt_pk_bf16_f32 v126, v76, v77
  v_cvt_pk_bf16_f32 v127, v78, v79
  v_exp_f32 v48, v48
  v_exp_f32 v49, v49
  v_mfma_f32_32x32x16_bf16 v[96:111], v[140:143], v[124:127], v[96:111]
  v_exp_f32 v50, v50
  v_exp_f32 v51, v51
  v_cvt_pk_bf16_f32 v112, v48, v49
  v_exp_f32 v52, v52
  v_exp_f32 v53, v53
  v_cvt_pk_bf16_f32 v113, v50, v51
  s_waitcnt vmcnt(8)
  s_barrier
  v_mfma_f32_32x32x16_bf16 v[64:79], v[132:135], v[12:15], v[32:47]
  ds_read_b128 v[128:131], v5 offset:49536
  ds_read_b128 v[136:139], v160 offset:50560
  ds_read_b128 v[140:143], v161 offset:51072
  v_exp_f32 v54, v54
  v_exp_f32 v55, v55
  v_cvt_pk_bf16_f32 v114, v52, v53
  v_exp_f32 v56, v56
  v_exp_f32 v57, v57
  v_cvt_pk_bf16_f32 v115, v54, v55
  v_exp_f32 v58, v58
  v_exp_f32 v59, v59
  v_mfma_f32_32x32x16_bf16 v[80:95], v[144:147], v[112:115], v[80:95]
  s_add_u32 m0, s67, 33024
  s_add_u32 s68, s66, 98304
  buffer_load_dwordx4 v5, s[48:51], s68 offen offset:0 lds
  v_cvt_pk_bf16_f32 v116, v56, v57
  v_exp_f32 v60, v60
  v_exp_f32 v61, v61
  v_cvt_pk_bf16_f32 v117, v58, v59
  v_exp_f32 v62, v62
  v_exp_f32 v63, v63
  v_cvt_pk_bf16_f32 v118, v60, v61
  v_cvt_pk_bf16_f32 v119, v62, v63
  v_exp_f32 v64, v64
  v_exp_f32 v65, v65
  v_mfma_f32_32x32x16_bf16 v[80:95], v[148:151], v[116:119], v[80:95]
  buffer_load_dwordx4 v5, s[48:51], s68 offen offset:1024 lds
  v_exp_f32 v66, v66
  v_exp_f32 v67, v67
  v_cvt_pk_bf16_f32 v120, v64, v65
  v_exp_f32 v68, v68
  v_exp_f32 v69, v69
  v_cvt_pk_bf16_f32 v121, v66, v67
  s_waitcnt lgkmcnt(0)
  v_mfma_f32_32x32x16_bf16 v[48:63], v[128:131], v[8:11], v[16:31]
  buffer_load_dwordx4 v5, s[48:51], s68 offen offset:2048 lds
  v_exp_f32 v70, v70
  v_exp_f32 v71, v71
  v_cvt_pk_bf16_f32 v122, v68, v69
  v_exp_f32 v72, v72
  v_exp_f32 v73, v73
  v_cvt_pk_bf16_f32 v123, v70, v71
  v_exp_f32 v74, v74
  v_exp_f32 v75, v75
  v_mfma_f32_32x32x16_bf16 v[96:111], v[144:147], v[120:123], v[96:111]
  buffer_load_dwordx4 v5, s[48:51], s68 offen offset:3072 lds
  v_cvt_pk_bf16_f32 v124, v72, v73
  v_exp_f32 v76, v76
  v_exp_f32 v77, v77
  v_cvt_pk_bf16_f32 v125, v74, v75
  v_exp_f32 v78, v78
  v_exp_f32 v79, v79
  v_cvt_pk_bf16_f32 v126, v76, v77
  v_cvt_pk_bf16_f32 v127, v78, v79
  v_exp_f32 v48, v48
  v_exp_f32 v49, v49
  v_mfma_f32_32x32x16_bf16 v[96:111], v[148:151], v[124:127], v[96:111]
  v_exp_f32 v50, v50
  v_exp_f32 v51, v51
  v_cvt_pk_bf16_f32 v112, v48, v49
  v_exp_f32 v52, v52
  v_exp_f32 v53, v53
  v_cvt_pk_bf16_f32 v113, v50, v51
  v_mfma_f32_32x32x16_bf16 v[64:79], v[128:131], v[12:15], v[32:47]
  ds_read_b128 v[132:135], v5 offset:51584
  ds_read_b128 v[144:147], v162 offset:52608
  ds_read_b128 v[148:151], v163 offset:53120
  v_exp_f32 v54, v54
  v_exp_f32 v55, v55
  v_cvt_pk_bf16_f32 v114, v52, v53
  v_exp_f32 v56, v56
  v_exp_f32 v57, v57
  v_cvt_pk_bf16_f32 v115, v54, v55
  v_exp_f32 v58, v58
  v_exp_f32 v59, v59
  v_mfma_f32_32x32x16_bf16 v[80:95], v[136:139], v[112:115], v[80:95]
  v_cvt_pk_bf16_f32 v116, v56, v57
  v_exp_f32 v60, v60
  v_exp_f32 v61, v61
  v_cvt_pk_bf16_f32 v117, v58, v59
  v_exp_f32 v62, v62
  v_exp_f32 v63, v63
  v_cvt_pk_bf16_f32 v118, v60, v61
  v_cvt_pk_bf16_f32 v119, v62, v63
  v_exp_f32 v64, v64
  v_exp_f32 v65, v65
  v_mfma_f32_32x32x16_bf16 v[80:95], v[140:143], v[116:119], v[80:95]
  v_exp_f32 v66, v66
  v_exp_f32 v67, v67
  v_cvt_pk_bf16_f32 v120, v64, v65
  v_exp_f32 v68, v68
  v_exp_f32 v69, v69
  v_cvt_pk_bf16_f32 v121, v66, v67
  s_waitcnt lgkmcnt(0)
  v_mfma_f32_32x32x16_bf16 v[48:63], v[132:135], v[8:11], v[16:31]
  v_exp_f32 v70, v70
  v_exp_f32 v71, v71
  v_cvt_pk_bf16_f32 v122, v68, v69
  v_exp_f32 v72, v72
  v_exp_f32 v73, v73
  v_cvt_pk_bf16_f32 v123, v70, v71
  v_exp_f32 v74, v74
  v_exp_f32 v75, v75
  v_mfma_f32_32x32x16_bf16 v[96:111], v[136:139], v[120:123], v[96:111]
  v_cvt_pk_bf16_f32 v124, v72, v73
  v_exp_f32 v76, v76
  v_exp_f32 v77, v77
  v_cvt_pk_bf16_f32 v125, v74, v75
  v_exp_f32 v78, v78
  v_exp_f32 v79, v79
  v_cvt_pk_bf16_f32 v126, v76, v77
  v_cvt_pk_bf16_f32 v127, v78, v79
  v_exp_f32 v48, v48
  v_exp_f32 v49, v49
  v_mfma_f32_32x32x16_bf16 v[96:111], v[140:143], v[124:127], v[96:111]
  v_exp_f32 v50, v50
  v_exp_f32 v51, v51
  v_cvt_pk_bf16_f32 v112, v48, v49
  v_exp_f32 v52, v52
  v_exp_f32 v53, v53
  v_cvt_pk_bf16_f32 v113, v50, v51
  v_mfma_f32_32x32x16_bf16 v[64:79], v[132:135], v[12:15], v[32:47]
  ds_read_b128 v[128:131], v5 offset:53664
  ds_read_b128 v[136:139], v160 offset:54688
  ds_read_b128 v[140:143], v161 offset:55200
  v_exp_f32 v54, v54
  v_exp_f32 v55, v55
  v_cvt_pk_bf16_f32 v114, v52, v53
  v_exp_f32 v56, v56
  v_exp_f32 v57, v57
  v_cvt_pk_bf16_f32 v115, v54, v55
  v_exp_f32 v58, v58
  v_exp_f32 v59, v59
  v_mfma_f32_32x32x16_bf16 v[80:95], v[144:147], v[112:115], v[80:95]
  v_cvt_pk_bf16_f32 v116, v56, v57
  v_exp_f32 v60, v60
  v_exp_f32 v61, v61
  v_cvt_pk_bf16_f32 v117, v58, v59
  v_exp_f32 v62, v62
  v_exp_f32 v63, v63
  v_cvt_pk_bf16_f32 v118, v60, v61
  v_cvt_pk_bf16_f32 v119, v62, v63
  v_exp_f32 v64, v64
  v_exp_f32 v65, v65
  v_mfma_f32_32x32x16_bf16 v[80:95], v[148:151], v[116:119], v[80:95]
  v_exp_f32 v66, v66
  v_exp_f32 v67, v67
  v_cvt_pk_bf16_f32 v120, v64, v65
  v_exp_f32 v68, v68
  v_exp_f32 v69, v69
  v_cvt_pk_bf16_f32 v121, v66, v67
  s_waitcnt lgkmcnt(0)
  v_mfma_f32_32x32x16_bf16 v[48:63], v[128:131], v[8:11], v[16:31]
  v_exp_f32 v70, v70
  v_exp_f32 v71, v71
  v_cvt_pk_bf16_f32 v122, v68, v69
  v_exp_f32 v72, v72
  v_exp_f32 v73, v73
  v_cvt_pk_bf16_f32 v123, v70, v71
  v_exp_f32 v74, v74
  v_exp_f32 v75, v75
  v_mfma_f32_32x32x16_bf16 v[96:111], v[144:147], v[120:123], v[96:111]
  v_cvt_pk_bf16_f32 v124, v72, v73
  v_exp_f32 v76, v76
  v_exp_f32 v77, v77
  v_cvt_pk_bf16_f32 v125, v74, v75
  v_exp_f32 v78, v78
  v_exp_f32 v79, v79
  v_cvt_pk_bf16_f32 v126, v76, v77
  v_cvt_pk_bf16_f32 v127, v78, v79
  v_exp_f32 v48, v48
  v_exp_f32 v49, v49
  v_mfma_f32_32x32x16_bf16 v[96:111], v[148:151], v[124:127], v[96:111]
  v_exp_f32 v50, v50
  v_exp_f32 v51, v51
  v_cvt_pk_bf16_f32 v112, v48, v49
  v_exp_f32 v52, v52
  v_exp_f32 v53, v53
  v_cvt_pk_bf16_f32 v113, v50, v51
  v_mfma_f32_32x32x16_bf16 v[64:79], v[128:131], v[12:15], v[32:47]
  ds_read_b128 v[132:135], v5 offset:55712
  ds_read_b128 v[144:147], v162 offset:56736
  ds_read_b128 v[148:151], v163 offset:57248
  v_exp_f32 v54, v54
  v_exp_f32 v55, v55
  v_cvt_pk_bf16_f32 v114, v52, v53
  v_exp_f32 v56, v56
  v_exp_f32 v57, v57
  v_cvt_pk_bf16_f32 v115, v54, v55
  v_exp_f32 v58, v58
  v_exp_f32 v59, v59
  v_mfma_f32_32x32x16_bf16 v[80:95], v[136:139], v[112:115], v[80:95]
  v_cvt_pk_bf16_f32 v116, v56, v57
  v_exp_f32 v60, v60
  v_exp_f32 v61, v61
  v_cvt_pk_bf16_f32 v117, v58, v59
  v_exp_f32 v62, v62
  v_exp_f32 v63, v63
  v_cvt_pk_bf16_f32 v118, v60, v61
  v_cvt_pk_bf16_f32 v119, v62, v63
  v_exp_f32 v64, v64
  v_exp_f32 v65, v65
  v_mfma_f32_32x32x16_bf16 v[80:95], v[140:143], v[116:119], v[80:95]
  v_exp_f32 v66, v66
  v_exp_f32 v67, v67
  v_cvt_pk_bf16_f32 v120, v64, v65
  v_exp_f32 v68, v68
  v_exp_f32 v69, v69
  v_cvt_pk_bf16_f32 v121, v66, v67
  s_waitcnt lgkmcnt(0)
  v_mfma_f32_32x32x16_bf16 v[48:63], v[132:135], v[8:11], v[16:31]
  v_exp_f32 v70, v70
  v_exp_f32 v71, v71
  v_cvt_pk_bf16_f32 v122, v68, v69
  v_exp_f32 v72, v72
  v_exp_f32 v73, v73
  v_cvt_pk_bf16_f32 v123, v70, v71
  v_exp_f32 v74, v74
  v_exp_f32 v75, v75
  v_mfma_f32_32x32x16_bf16 v[96:111], v[136:139], v[120:123], v[96:111]
  v_cvt_pk_bf16_f32 v124, v72, v73
  v_exp_f32 v76, v76
  v_exp_f32 v77, v77
  v_cvt_pk_bf16_f32 v125, v74, v75
  v_exp_f32 v78, v78
  v_exp_f32 v79, v79
  v_cvt_pk_bf16_f32 v126, v76, v77
  v_cvt_pk_bf16_f32 v127, v78, v79
  v_exp_f32 v48, v48
  v_exp_f32 v49, v49
  v_mfma_f32_32x32x16_bf16 v[96:111], v[140:143], v[124:127], v[96:111]
  v_exp_f32 v50, v50
  v_exp_f32 v51, v51
  v_cvt_pk_bf16_f32 v112, v48, v49
  v_exp_f32 v52, v52
  v_exp_f32 v53, v53
  v_cvt_pk_bf16_f32 v113, v50, v51
  v_mfma_f32_32x32x16_bf16 v[64:79], v[132:135], v[12:15], v[32:47]
  ds_read_b128 v[128:131], v5 offset:57792
  ds_read_b128 v[136:139], v160 offset:58816
  ds_read_b128 v[140:143], v161 offset:59328
  v_exp_f32 v54, v54
  v_exp_f32 v55, v55
  v_cvt_pk_bf16_f32 v114, v52, v53
  v_exp_f32 v56, v56
  v_exp_f32 v57, v57
  v_cvt_pk_bf16_f32 v115, v54, v55
  v_exp_f32 v58, v58
  v_exp_f32 v59, v59
  v_mfma_f32_32x32x16_bf16 v[80:95], v[144:147], v[112:115], v[80:95]
  v_cvt_pk_bf16_f32 v116, v56, v57
  v_exp_f32 v60, v60
  v_exp_f32 v61, v61
  v_cvt_pk_bf16_f32 v117, v58, v59
  v_exp_f32 v62, v62
  v_exp_f32 v63, v63
  v_cvt_pk_bf16_f32 v118, v60, v61
  v_cvt_pk_bf16_f32 v119, v62, v63
  v_exp_f32 v64, v64
  v_exp_f32 v65, v65
  v_mfma_f32_32x32x16_bf16 v[80:95], v[148:151], v[116:119], v[80:95]
  v_exp_f32 v66, v66
  v_exp_f32 v67, v67
  v_cvt_pk_bf16_f32 v120, v64, v65
  v_exp_f32 v68, v68
  v_exp_f32 v69, v69
  v_cvt_pk_bf16_f32 v121, v66, v67
  s_waitcnt lgkmcnt(0)
  v_mfma_f32_32x32x16_bf16 v[48:63], v[128:131], v[8:11], v[16:31]
  v_exp_f32 v70, v70
  v_exp_f32 v71, v71
  v_cvt_pk_bf16_f32 v122, v68, v69
  v_exp_f32 v72, v72
  v_exp_f32 v73, v73
  v_cvt_pk_bf16_f32 v123, v70, v71
  v_exp_f32 v74, v74
  v_exp_f32 v75, v75
  v_mfma_f32_32x32x16_bf16 v[96:111], v[144:147], v[120:123], v[96:111]
  v_cvt_pk_bf16_f32 v124, v72, v73
  v_exp_f32 v76, v76
  v_exp_f32 v77, v77
  v_cvt_pk_bf16_f32 v125, v74, v75
  v_exp_f32 v78, v78
  v_exp_f32 v79, v79
  v_cvt_pk_bf16_f32 v126, v76, v77
  v_cvt_pk_bf16_f32 v127, v78, v79
  v_exp_f32 v48, v48
  v_exp_f32 v49, v49
  v_mfma_f32_32x32x16_bf16 v[96:111], v[148:151], v[124:127], v[96:111]
  v_exp_f32 v50, v50
  v_exp_f32 v51, v51
  v_cvt_pk_bf16_f32 v112, v48, v49
  v_exp_f32 v52, v52
  v_exp_f32 v53, v53
  v_cvt_pk_bf16_f32 v113, v50, v51
  v_mfma_f32_32x32x16_bf16 v[64:79], v[128:131], v[12:15], v[32:47]
  ds_read_b128 v[132:135], v5 offset:59840
  ds_read_b128 v[144:147], v162 offset:60864
  ds_read_b128 v[148:151], v163 offset:61376
  v_exp_f32 v54, v54
  v_exp_f32 v55, v55
  v_cvt_pk_bf16_f32 v114, v52, v53
  v_exp_f32 v56, v56
  v_exp_f32 v57, v57
  v_cvt_pk_bf16_f32 v115, v54, v55
  v_exp_f32 v58, v58
  v_exp_f32 v59, v59
  v_mfma_f32_32x32x16_bf16 v[80:95], v[136:139], v[112:115], v[80:95]
  v_cvt_pk_bf16_f32 v116, v56, v57
  v_exp_f32 v60, v60
  v_exp_f32 v61, v61
  v_cvt_pk_bf16_f32 v117, v58, v59
  v_exp_f32 v62, v62
  v_exp_f32 v63, v63
  v_cvt_pk_bf16_f32 v118, v60, v61
  v_cvt_pk_bf16_f32 v119, v62, v63
  v_exp_f32 v64, v64
  v_exp_f32 v65, v65
  v_mfma_f32_32x32x16_bf16 v[80:95], v[140:143], v[116:119], v[80:95]
  v_exp_f32 v66, v66
  v_exp_f32 v67, v67
  v_cvt_pk_bf16_f32 v120, v64, v65
  v_exp_f32 v68, v68
  v_exp_f32 v69, v69
  v_cvt_pk_bf16_f32 v121, v66, v67
  s_waitcnt lgkmcnt(0)
  v_mfma_f32_32x32x16_bf16 v[48:63], v[132:135], v[8:11], v[16:31]
  v_exp_f32 v70, v70
  v_exp_f32 v71, v71
  v_cvt_pk_bf16_f32 v122, v68, v69
  v_exp_f32 v72, v72
  v_exp_f32 v73, v73
  v_cvt_pk_bf16_f32 v123, v70, v71
  v_exp_f32 v74, v74
  v_exp_f32 v75, v75
  v_mfma_f32_32x32x16_bf16 v[96:111], v[136:139], v[120:123], v[96:111]
  v_cvt_pk_bf16_f32 v124, v72, v73
  v_exp_f32 v76, v76
  v_exp_f32 v77, v77
  v_cvt_pk_bf16_f32 v125, v74, v75
  v_exp_f32 v78, v78
  v_exp_f32 v79, v79
  v_cvt_pk_bf16_f32 v126, v76, v77
  v_cvt_pk_bf16_f32 v127, v78, v79
  v_exp_f32 v48, v48
  v_exp_f32 v49, v49
  v_mfma_f32_32x32x16_bf16 v[96:111], v[140:143], v[124:127], v[96:111]
  v_exp_f32 v50, v50
  v_exp_f32 v51, v51
  v_cvt_pk_bf16_f32 v112, v48, v49
  v_exp_f32 v52, v52
  v_exp_f32 v53, v53
  v_cvt_pk_bf16_f32 v113, v50, v51
  v_mfma_f32_32x32x16_bf16 v[64:79], v[132:135], v[12:15], v[32:47]
  ds_read_b128 v[128:131], v5 offset:61920
  ds_read_b128 v[136:139], v160 offset:62944
  ds_read_b128 v[140:143], v161 offset:63456
  v_exp_f32 v54, v54
  v_exp_f32 v55, v55
  v_cvt_pk_bf16_f32 v114, v52, v53
  v_exp_f32 v56, v56
  v_exp_f32 v57, v57
  v_cvt_pk_bf16_f32 v115, v54, v55
  v_exp_f32 v58, v58
  v_exp_f32 v59, v59
  v_mfma_f32_32x32x16_bf16 v[80:95], v[144:147], v[112:115], v[80:95]
  v_cvt_pk_bf16_f32 v116, v56, v57
  v_exp_f32 v60, v60
  v_exp_f32 v61, v61
  v_cvt_pk_bf16_f32 v117, v58, v59
  v_exp_f32 v62, v62
  v_exp_f32 v63, v63
  v_cvt_pk_bf16_f32 v118, v60, v61
  v_cvt_pk_bf16_f32 v119, v62, v63
  v_exp_f32 v64, v64
  v_exp_f32 v65, v65
  v_mfma_f32_32x32x16_bf16 v[80:95], v[148:151], v[116:119], v[80:95]
  v_exp_f32 v66, v66
  v_exp_f32 v67, v67
  v_cvt_pk_bf16_f32 v120, v64, v65
  v_exp_f32 v68, v68
  v_exp_f32 v69, v69
  v_cvt_pk_bf16_f32 v121, v66, v67
  s_waitcnt lgkmcnt(0)
  v_mfma_f32_32x32x16_bf16 v[48:63], v[128:131], v[8:11], v[16:31]
  v_exp_f32 v70, v70
  v_exp_f32 v71, v71
  v_cvt_pk_bf16_f32 v122, v68, v69
  v_exp_f32 v72, v72
  v_exp_f32 v73, v73
  v_cvt_pk_bf16_f32 v123, v70, v71
  v_exp_f32 v74, v74
  v_exp_f32 v75, v75
  v_mfma_f32_32x32x16_bf16 v[96:111], v[144:147], v[120:123], v[96:111]
  v_cvt_pk_bf16_f32 v124, v72, v73
  v_exp_f32 v76, v76
  v_exp_f32 v77, v77
  v_cvt_pk_bf16_f32 v125, v74, v75
  v_exp_f32 v78, v78
  v_exp_f32 v79, v79
  v_cvt_pk_bf16_f32 v126, v76, v77
  v_cvt_pk_bf16_f32 v127, v78, v79
  v_exp_f32 v48, v48
  v_exp_f32 v49, v49
  v_mfma_f32_32x32x16_bf16 v[96:111], v[148:151], v[124:127], v[96:111]
  v_exp_f32 v50, v50
  v_exp_f32 v51, v51
  v_cvt_pk_bf16_f32 v112, v48, v49
  v_exp_f32 v52, v52
  v_exp_f32 v53, v53
  v_cvt_pk_bf16_f32 v113, v50, v51
  v_mfma_f32_32x32x16_bf16 v[64:79], v[128:131], v[12:15], v[32:47]
  ds_read_b128 v[132:135], v5 offset:63968
  ds_read_b128 v[144:147], v162 offset:64992
  ds_read_b128 v[148:151], v163 offset:65504
  v_exp_f32 v54, v54
  v_exp_f32 v55, v55
  v_cvt_pk_bf16_f32 v114, v52, v53
  v_exp_f32 v56, v56
  v_exp_f32 v57, v57
  v_cvt_pk_bf16_f32 v115, v54, v55
  v_exp_f32 v58, v58
  v_exp_f32 v59, v59
  v_mfma_f32_32x32x16_bf16 v[80:95], v[136:139], v[112:115], v[80:95]
  v_cvt_pk_bf16_f32 v116, v56, v57
  v_exp_f32 v60, v60
  v_exp_f32 v61, v61
  v_cvt_pk_bf16_f32 v117, v58, v59
  v_exp_f32 v62, v62
  v_exp_f32 v63, v63
  v_cvt_pk_bf16_f32 v118, v60, v61
  v_cvt_pk_bf16_f32 v119, v62, v63
  v_exp_f32 v64, v64
  v_exp_f32 v65, v65
  v_mfma_f32_32x32x16_bf16 v[80:95], v[140:143], v[116:119], v[80:95]
  v_exp_f32 v66, v66
  v_exp_f32 v67, v67
  v_cvt_pk_bf16_f32 v120, v64, v65
  v_exp_f32 v68, v68
  v_exp_f32 v69, v69
  v_cvt_pk_bf16_f32 v121, v66, v67
  s_waitcnt lgkmcnt(0)
  v_mfma_f32_32x32x16_bf16 v[48:63], v[132:135], v[8:11], v[16:31]
  v_exp_f32 v70, v70
  v_exp_f32 v71, v71
  v_cvt_pk_bf16_f32 v122, v68, v69
  v_exp_f32 v72, v72
  v_exp_f32 v73, v73
  v_cvt_pk_bf16_f32 v123, v70, v71
  v_exp_f32 v74, v74
  v_exp_f32 v75, v75
  v_mfma_f32_32x32x16_bf16 v[96:111], v[136:139], v[120:123], v[96:111]
  v_cvt_pk_bf16_f32 v124, v72, v73
  v_exp_f32 v76, v76
  v_exp_f32 v77, v77
  v_cvt_pk_bf16_f32 v125, v74, v75
  v_exp_f32 v78, v78
  v_exp_f32 v79, v79
  v_cvt_pk_bf16_f32 v126, v76, v77
  v_cvt_pk_bf16_f32 v127, v78, v79
  v_exp_f32 v48, v48
  v_exp_f32 v49, v49
  v_mfma_f32_32x32x16_bf16 v[96:111], v[140:143], v[124:127], v[96:111]
  v_exp_f32 v50, v50
  v_exp_f32 v51, v51
  v_cvt_pk_bf16_f32 v112, v48, v49
  v_exp_f32 v52, v52
  v_exp_f32 v53, v53
  v_cvt_pk_bf16_f32 v113, v50, v51
  s_waitcnt vmcnt(8)
  s_barrier
  v_mfma_f32_32x32x16_bf16 v[64:79], v[132:135], v[12:15], v[32:47]
  ds_read_b128 v[128:131], v5 offset:0
  ds_read_b128 v[136:139], v160 offset:1024
  ds_read_b128 v[140:143], v161 offset:1536
  v_exp_f32 v54, v54
  v_exp_f32 v55, v55
  v_cvt_pk_bf16_f32 v114, v52, v53
  v_exp_f32 v56, v56
  v_exp_f32 v57, v57
  v_cvt_pk_bf16_f32 v115, v54, v55
  v_exp_f32 v58, v58
  v_exp_f32 v59, v59
  v_mfma_f32_32x32x16_bf16 v[80:95], v[144:147], v[112:115], v[80:95]
  s_add_u32 m0, s67, 49536
  s_add_u32 s68, s66, 114688
  buffer_load_dwordx4 v5, s[48:51], s68 offen offset:0 lds
  v_cvt_pk_bf16_f32 v116, v56, v57
  v_exp_f32 v60, v60
  v_exp_f32 v61, v61
  v_cvt_pk_bf16_f32 v117, v58, v59
  v_exp_f32 v62, v62
  v_exp_f32 v63, v63
  v_cvt_pk_bf16_f32 v118, v60, v61
  v_cvt_pk_bf16_f32 v119, v62, v63
  v_exp_f32 v64, v64
  v_exp_f32 v65, v65
  v_mfma_f32_32x32x16_bf16 v[80:95], v[148:151], v[116:119], v[80:95]
  buffer_load_dwordx4 v5, s[48:51], s68 offen offset:1024 lds
  v_exp_f32 v66, v66
  v_exp_f32 v67, v67
  v_cvt_pk_bf16_f32 v120, v64, v65
  v_exp_f32 v68, v68
  v_exp_f32 v69, v69
  v_cvt_pk_bf16_f32 v121, v66, v67
  s_waitcnt lgkmcnt(0)
  v_mfma_f32_32x32x16_bf16 v[48:63], v[128:131], v[8:11], v[16:31]
  buffer_load_dwordx4 v5, s[48:51], s68 offen offset:2048 lds
  v_exp_f32 v70, v70
  v_exp_f32 v71, v71
  v_cvt_pk_bf16_f32 v122, v68, v69
  v_exp_f32 v72, v72
  v_exp_f32 v73, v73
  v_cvt_pk_bf16_f32 v123, v70, v71
  v_exp_f32 v74, v74
  v_exp_f32 v75, v75
  v_mfma_f32_32x32x16_bf16 v[96:111], v[144:147], v[120:123], v[96:111]
  buffer_load_dwordx4 v5, s[48:51], s68 offen offset:3072 lds
  v_cvt_pk_bf16_f32 v124, v72, v73
  v_exp_f32 v76, v76
  v_exp_f32 v77, v77
  v_cvt_pk_bf16_f32 v125, v74, v75
  v_exp_f32 v78, v78
  v_exp_f32 v79, v79
  v_cvt_pk_bf16_f32 v126, v76, v77
  v_cvt_pk_bf16_f32 v127, v78, v79
  v_exp_f32 v48, v48
  v_exp_f32 v49, v49
  v_mfma_f32_32x32x16_bf16 v[96:111], v[148:151], v[124:127], v[96:111]
  v_exp_f32 v50, v50
  v_exp_f32 v51, v51
  v_cvt_pk_bf16_f32 v112, v48, v49
  v_exp_f32 v52, v52
  v_exp_f32 v53, v53
  v_cvt_pk_bf16_f32 v113, v50, v51
  v_mfma_f32_32x32x16_bf16 v[64:79], v[128:131], v[12:15], v[32:47]
  ds_read_b128 v[132:135], v5 offset:2048
  ds_read_b128 v[144:147], v162 offset:3072
  ds_read_b128 v[148:151], v163 offset:3584
  v_exp_f32 v54, v54
  v_exp_f32 v55, v55
  v_cvt_pk_bf16_f32 v114, v52, v53
  v_exp_f32 v56, v56
  v_exp_f32 v57, v57
  v_cvt_pk_bf16_f32 v115, v54, v55
  v_exp_f32 v58, v58
  v_exp_f32 v59, v59
  v_mfma_f32_32x32x16_bf16 v[80:95], v[136:139], v[112:115], v[80:95]
  v_cvt_pk_bf16_f32 v116, v56, v57
  v_exp_f32 v60, v60
  v_exp_f32 v61, v61
  v_cvt_pk_bf16_f32 v117, v58, v59
  v_exp_f32 v62, v62
  v_exp_f32 v63, v63
  v_cvt_pk_bf16_f32 v118, v60, v61
  v_cvt_pk_bf16_f32 v119, v62, v63
  v_exp_f32 v64, v64
  v_exp_f32 v65, v65
  v_mfma_f32_32x32x16_bf16 v[80:95], v[140:143], v[116:119], v[80:95]
  v_exp_f32 v66, v66
  v_exp_f32 v67, v67
  v_cvt_pk_bf16_f32 v120, v64, v65
  v_exp_f32 v68, v68
  v_exp_f32 v69, v69
  v_cvt_pk_bf16_f32 v121, v66, v67
  s_waitcnt lgkmcnt(0)
  v_mfma_f32_32x32x16_bf16 v[48:63], v[132:135], v[8:11], v[16:31]
  v_exp_f32 v70, v70
  v_exp_f32 v71, v71
  v_cvt_pk_bf16_f32 v122, v68, v69
  v_exp_f32 v72, v72
  v_exp_f32 v73, v73
  v_cvt_pk_bf16_f32 v123, v70, v71
  v_exp_f32 v74, v74
  v_exp_f32 v75, v75
  v_mfma_f32_32x32x16_bf16 v[96:111], v[136:139], v[120:123], v[96:111]
  v_cvt_pk_bf16_f32 v124, v72, v73
  v_exp_f32 v76, v76
  v_exp_f32 v77, v77
  v_cvt_pk_bf16_f32 v125, v74, v75
  v_exp_f32 v78, v78
  v_exp_f32 v79, v79
  v_cvt_pk_bf16_f32 v126, v76, v77
  v_cvt_pk_bf16_f32 v127, v78, v79
  v_exp_f32 v48, v48
  v_exp_f32 v49, v49
  v_mfma_f32_32x32x16_bf16 v[96:111], v[140:143], v[124:127], v[96:111]
  v_exp_f32 v50, v50
  v_exp_f32 v51, v51
  v_cvt_pk_bf16_f32 v112, v48, v49
  v_exp_f32 v52, v52
  v_exp_f32 v53, v53
  v_cvt_pk_bf16_f32 v113, v50, v51
  v_mfma_f32_32x32x16_bf16 v[64:79], v[132:135], v[12:15], v[32:47]
  ds_read_b128 v[128:131], v5 offset:4128
  ds_read_b128 v[136:139], v160 offset:5152
  ds_read_b128 v[140:143], v161 offset:5664
  v_exp_f32 v54, v54
  v_exp_f32 v55, v55
  v_cvt_pk_bf16_f32 v114, v52, v53
  v_exp_f32 v56, v56
  v_exp_f32 v57, v57
  v_cvt_pk_bf16_f32 v115, v54, v55
  v_exp_f32 v58, v58
  v_exp_f32 v59, v59
  v_mfma_f32_32x32x16_bf16 v[80:95], v[144:147], v[112:115], v[80:95]
  v_cvt_pk_bf16_f32 v116, v56, v57
  v_exp_f32 v60, v60
  v_exp_f32 v61, v61
  v_cvt_pk_bf16_f32 v117, v58, v59
  v_exp_f32 v62, v62
  v_exp_f32 v63, v63
  v_cvt_pk_bf16_f32 v118, v60, v61
  v_cvt_pk_bf16_f32 v119, v62, v63
  v_exp_f32 v64, v64
  v_exp_f32 v65, v65
  v_mfma_f32_32x32x16_bf16 v[80:95], v[148:151], v[116:119], v[80:95]
  v_exp_f32 v66, v66
  v_exp_f32 v67, v67
  v_cvt_pk_bf16_f32 v120, v64, v65
  v_exp_f32 v68, v68
  v_exp_f32 v69, v69
  v_cvt_pk_bf16_f32 v121, v66, v67
  s_waitcnt lgkmcnt(0)
  v_mfma_f32_32x32x16_bf16 v[48:63], v[128:131], v[8:11], v[16:31]
  v_exp_f32 v70, v70
  v_exp_f32 v71, v71
  v_cvt_pk_bf16_f32 v122, v68, v69
  v_exp_f32 v72, v72
  v_exp_f32 v73, v73
  v_cvt_pk_bf16_f32 v123, v70, v71
  v_exp_f32 v74, v74
  v_exp_f32 v75, v75
  v_mfma_f32_32x32x16_bf16 v[96:111], v[144:147], v[120:123], v[96:111]
  v_cvt_pk_bf16_f32 v124, v72, v73
  v_exp_f32 v76, v76
  v_exp_f32 v77, v77
  v_cvt_pk_bf16_f32 v125, v74, v75
  v_exp_f32 v78, v78
  v_exp_f32 v79, v79
  v_cvt_pk_bf16_f32 v126, v76, v77
  v_cvt_pk_bf16_f32 v127, v78, v79
  v_exp_f32 v48, v48
  v_exp_f32 v49, v49
  v_mfma_f32_32x32x16_bf16 v[96:111], v[148:151], v[124:127], v[96:111]
  v_exp_f32 v50, v50
  v_exp_f32 v51, v51
  v_cvt_pk_bf16_f32 v112, v48, v49
  v_exp_f32 v52, v52
  v_exp_f32 v53, v53
  v_cvt_pk_bf16_f32 v113, v50, v51
  v_mfma_f32_32x32x16_bf16 v[64:79], v[128:131], v[12:15], v[32:47]
  ds_read_b128 v[132:135], v5 offset:6176
  ds_read_b128 v[144:147], v162 offset:7200
  ds_read_b128 v[148:151], v163 offset:7712
  v_exp_f32 v54, v54
  v_exp_f32 v55, v55
  v_cvt_pk_bf16_f32 v114, v52, v53
  v_exp_f32 v56, v56
  v_exp_f32 v57, v57
  v_cvt_pk_bf16_f32 v115, v54, v55
  v_exp_f32 v58, v58
  v_exp_f32 v59, v59
  v_mfma_f32_32x32x16_bf16 v[80:95], v[136:139], v[112:115], v[80:95]
  v_cvt_pk_bf16_f32 v116, v56, v57
  v_exp_f32 v60, v60
  v_exp_f32 v61, v61
  v_cvt_pk_bf16_f32 v117, v58, v59
  v_exp_f32 v62, v62
  v_exp_f32 v63, v63
  v_cvt_pk_bf16_f32 v118, v60, v61
  v_cvt_pk_bf16_f32 v119, v62, v63
  v_exp_f32 v64, v64
  v_exp_f32 v65, v65
  v_mfma_f32_32x32x16_bf16 v[80:95], v[140:143], v[116:119], v[80:95]
  v_exp_f32 v66, v66
  v_exp_f32 v67, v67
  v_cvt_pk_bf16_f32 v120, v64, v65
  v_exp_f32 v68, v68
  v_exp_f32 v69, v69
  v_cvt_pk_bf16_f32 v121, v66, v67
  s_waitcnt lgkmcnt(0)
  v_mfma_f32_32x32x16_bf16 v[48:63], v[132:135], v[8:11], v[16:31]
  v_exp_f32 v70, v70
  v_exp_f32 v71, v71
  v_cvt_pk_bf16_f32 v122, v68, v69
  v_exp_f32 v72, v72
  v_exp_f32 v73, v73
  v_cvt_pk_bf16_f32 v123, v70, v71
  v_exp_f32 v74, v74
  v_exp_f32 v75, v75
  v_mfma_f32_32x32x16_bf16 v[96:111], v[136:139], v[120:123], v[96:111]
  v_cvt_pk_bf16_f32 v124, v72, v73
  v_exp_f32 v76, v76
  v_exp_f32 v77, v77
  v_cvt_pk_bf16_f32 v125, v74, v75
  v_exp_f32 v78, v78
  v_exp_f32 v79, v79
  v_cvt_pk_bf16_f32 v126, v76, v77
  v_cvt_pk_bf16_f32 v127, v78, v79
  v_exp_f32 v48, v48
  v_exp_f32 v49, v49
  v_mfma_f32_32x32x16_bf16 v[96:111], v[140:143], v[124:127], v[96:111]
  v_exp_f32 v50, v50
  v_exp_f32 v51, v51
  v_cvt_pk_bf16_f32 v112, v48, v49
  v_exp_f32 v52, v52
  v_exp_f32 v53, v53
  v_cvt_pk_bf16_f32 v113, v50, v51
  v_mfma_f32_32x32x16_bf16 v[64:79], v[132:135], v[12:15], v[32:47]
  ds_read_b128 v[128:131], v5 offset:8256
  ds_read_b128 v[136:139], v160 offset:9280
  ds_read_b128 v[140:143], v161 offset:9792
  v_exp_f32 v54, v54
  v_exp_f32 v55, v55
  v_cvt_pk_bf16_f32 v114, v52, v53
  v_exp_f32 v56, v56
  v_exp_f32 v57, v57
  v_cvt_pk_bf16_f32 v115, v54, v55
  v_exp_f32 v58, v58
  v_exp_f32 v59, v59
  v_mfma_f32_32x32x16_bf16 v[80:95], v[144:147], v[112:115], v[80:95]
  v_cvt_pk_bf16_f32 v116, v56, v57
  v_exp_f32 v60, v60
  v_exp_f32 v61, v61
  v_cvt_pk_bf16_f32 v117, v58, v59
  v_exp_f32 v62, v62
  v_exp_f32 v63, v63
  v_cvt_pk_bf16_f32 v118, v60, v61
  v_cvt_pk_bf16_f32 v119, v62, v63
  v_exp_f32 v64, v64
  v_exp_f32 v65, v65
  v_mfma_f32_32x32x16_bf16 v[80:95], v[148:151], v[116:119], v[80:95]
  v_exp_f32 v66, v66
  v_exp_f32 v67, v67
  v_cvt_pk_bf16_f32 v120, v64, v65
  v_exp_f32 v68, v68
  v_exp_f32 v69, v69
  v_cvt_pk_bf16_f32 v121, v66, v67
  s_waitcnt lgkmcnt(0)
  v_mfma_f32_32x32x16_bf16 v[48:63], v[128:131], v[8:11], v[16:31]
  v_exp_f32 v70, v70
  v_exp_f32 v71, v71
  v_cvt_pk_bf16_f32 v122, v68, v69
  v_exp_f32 v72, v72
  v_exp_f32 v73, v73
  v_cvt_pk_bf16_f32 v123, v70, v71
  v_exp_f32 v74, v74
  v_exp_f32 v75, v75
  v_mfma_f32_32x32x16_bf16 v[96:111], v[144:147], v[120:123], v[96:111]
  v_cvt_pk_bf16_f32 v124, v72, v73
  v_exp_f32 v76, v76
  v_exp_f32 v77, v77
  v_cvt_pk_bf16_f32 v125, v74, v75
  v_exp_f32 v78, v78
  v_exp_f32 v79, v79
  v_cvt_pk_bf16_f32 v126, v76, v77
  v_cvt_pk_bf16_f32 v127, v78, v79
  v_exp_f32 v48, v48
  v_exp_f32 v49, v49
  v_mfma_f32_32x32x16_bf16 v[96:111], v[148:151], v[124:127], v[96:111]
  v_exp_f32 v50, v50
  v_exp_f32 v51, v51
  v_cvt_pk_bf16_f32 v112, v48, v49
  v_exp_f32 v52, v52
  v_exp_f32 v53, v53
  v_cvt_pk_bf16_f32 v113, v50, v51
  v_mfma_f32_32x32x16_bf16 v[64:79], v[128:131], v[12:15], v[32:47]
  ds_read_b128 v[132:135], v5 offset:10304
  ds_read_b128 v[144:147], v162 offset:11328
  ds_read_b128 v[148:151], v163 offset:11840
  v_exp_f32 v54, v54
  v_exp_f32 v55, v55
  v_cvt_pk_bf16_f32 v114, v52, v53
  v_exp_f32 v56, v56
  v_exp_f32 v57, v57
  v_cvt_pk_bf16_f32 v115, v54, v55
  v_exp_f32 v58, v58
  v_exp_f32 v59, v59
  v_mfma_f32_32x32x16_bf16 v[80:95], v[136:139], v[112:115], v[80:95]
  v_cvt_pk_bf16_f32 v116, v56, v57
  v_exp_f32 v60, v60
  v_exp_f32 v61, v61
  v_cvt_pk_bf16_f32 v117, v58, v59
  v_exp_f32 v62, v62
  v_exp_f32 v63, v63
  v_cvt_pk_bf16_f32 v118, v60, v61
  v_cvt_pk_bf16_f32 v119, v62, v63
  v_exp_f32 v64, v64
  v_exp_f32 v65, v65
  v_mfma_f32_32x32x16_bf16 v[80:95], v[140:143], v[116:119], v[80:95]
  v_exp_f32 v66, v66
  v_exp_f32 v67, v67
  v_cvt_pk_bf16_f32 v120, v64, v65
  v_exp_f32 v68, v68
  v_exp_f32 v69, v69
  v_cvt_pk_bf16_f32 v121, v66, v67
  s_waitcnt lgkmcnt(0)
  v_mfma_f32_32x32x16_bf16 v[48:63], v[132:135], v[8:11], v[16:31]
  v_exp_f32 v70, v70
  v_exp_f32 v71, v71
  v_cvt_pk_bf16_f32 v122, v68, v69
  v_exp_f32 v72, v72
  v_exp_f32 v73, v73
  v_cvt_pk_bf16_f32 v123, v70, v71
  v_exp_f32 v74, v74
  v_exp_f32 v75, v75
  v_mfma_f32_32x32x16_bf16 v[96:111], v[136:139], v[120:123], v[96:111]
  v_cvt_pk_bf16_f32 v124, v72, v73
  v_exp_f32 v76, v76
  v_exp_f32 v77, v77
  v_cvt_pk_bf16_f32 v125, v74, v75
  v_exp_f32 v78, v78
  v_exp_f32 v79, v79
  v_cvt_pk_bf16_f32 v126, v76, v77
  v_cvt_pk_bf16_f32 v127, v78, v79
  v_exp_f32 v48, v48
  v_exp_f32 v49, v49
  v_mfma_f32_32x32x16_bf16 v[96:111], v[140:143], v[124:127], v[96:111]
  v_exp_f32 v50, v50
  v_exp_f32 v51, v51
  v_cvt_pk_bf16_f32 v112, v48, v49
  v_exp_f32 v52, v52
  v_exp_f32 v53, v53
  v_cvt_pk_bf16_f32 v113, v50, v51
  v_mfma_f32_32x32x16_bf16 v[64:79], v[132:135], v[12:15], v[32:47]
  ds_read_b128 v[128:131], v5 offset:12384
  ds_read_b128 v[136:139], v160 offset:13408
  ds_read_b128 v[140:143], v161 offset:13920
  v_exp_f32 v54, v54
  v_exp_f32 v55, v55
  v_cvt_pk_bf16_f32 v114, v52, v53
  v_exp_f32 v56, v56
  v_exp_f32 v57, v57
  v_cvt_pk_bf16_f32 v115, v54, v55
  v_exp_f32 v58, v58
  v_exp_f32 v59, v59
  v_mfma_f32_32x32x16_bf16 v[80:95], v[144:147], v[112:115], v[80:95]
  v_cvt_pk_bf16_f32 v116, v56, v57
  v_exp_f32 v60, v60
  v_exp_f32 v61, v61
  v_cvt_pk_bf16_f32 v117, v58, v59
  v_exp_f32 v62, v62
  v_exp_f32 v63, v63
  v_cvt_pk_bf16_f32 v118, v60, v61
  v_cvt_pk_bf16_f32 v119, v62, v63
  v_exp_f32 v64, v64
  v_exp_f32 v65, v65
  v_mfma_f32_32x32x16_bf16 v[80:95], v[148:151], v[116:119], v[80:95]
  v_exp_f32 v66, v66
  v_exp_f32 v67, v67
  v_cvt_pk_bf16_f32 v120, v64, v65
  v_exp_f32 v68, v68
  v_exp_f32 v69, v69
  v_cvt_pk_bf16_f32 v121, v66, v67
  s_waitcnt lgkmcnt(0)
  v_mfma_f32_32x32x16_bf16 v[48:63], v[128:131], v[8:11], v[16:31]
  v_exp_f32 v70, v70
  v_exp_f32 v71, v71
  v_cvt_pk_bf16_f32 v122, v68, v69
  v_exp_f32 v72, v72
  v_exp_f32 v73, v73
  v_cvt_pk_bf16_f32 v123, v70, v71
  v_exp_f32 v74, v74
  v_exp_f32 v75, v75
  v_mfma_f32_32x32x16_bf16 v[96:111], v[144:147], v[120:123], v[96:111]
  v_cvt_pk_bf16_f32 v124, v72, v73
  v_exp_f32 v76, v76
  v_exp_f32 v77, v77
  v_cvt_pk_bf16_f32 v125, v74, v75
  v_exp_f32 v78, v78
  v_exp_f32 v79, v79
  v_cvt_pk_bf16_f32 v126, v76, v77
  v_cvt_pk_bf16_f32 v127, v78, v79
  v_exp_f32 v48, v48
  v_exp_f32 v49, v49
  v_mfma_f32_32x32x16_bf16 v[96:111], v[148:151], v[124:127], v[96:111]
  v_exp_f32 v50, v50
  v_exp_f32 v51, v51
  v_cvt_pk_bf16_f32 v112, v48, v49
  v_exp_f32 v52, v52
  v_exp_f32 v53, v53
  v_cvt_pk_bf16_f32 v113, v50, v51
  v_mfma_f32_32x32x16_bf16 v[64:79], v[128:131], v[12:15], v[32:47]
  ds_read_b128 v[132:135], v5 offset:14432
  ds_read_b128 v[144:147], v162 offset:15456
  ds_read_b128 v[148:151], v163 offset:15968
  v_exp_f32 v54, v54
  v_exp_f32 v55, v55
  v_cvt_pk_bf16_f32 v114, v52, v53
  v_exp_f32 v56, v56
  v_exp_f32 v57, v57
  v_cvt_pk_bf16_f32 v115, v54, v55
  v_exp_f32 v58, v58
  v_exp_f32 v59, v59
  v_mfma_f32_32x32x16_bf16 v[80:95], v[136:139], v[112:115], v[80:95]
  v_cvt_pk_bf16_f32 v116, v56, v57
  v_exp_f32 v60, v60
  v_exp_f32 v61, v61
  v_cvt_pk_bf16_f32 v117, v58, v59
  v_exp_f32 v62, v62
  v_exp_f32 v63, v63
  v_cvt_pk_bf16_f32 v118, v60, v61
  v_cvt_pk_bf16_f32 v119, v62, v63
  v_exp_f32 v64, v64
  v_exp_f32 v65, v65
  v_mfma_f32_32x32x16_bf16 v[80:95], v[140:143], v[116:119], v[80:95]
  v_exp_f32 v66, v66
  v_exp_f32 v67, v67
  v_cvt_pk_bf16_f32 v120, v64, v65
  v_exp_f32 v68, v68
  v_exp_f32 v69, v69
  v_cvt_pk_bf16_f32 v121, v66, v67
  s_waitcnt lgkmcnt(0)
  v_mfma_f32_32x32x16_bf16 v[48:63], v[132:135], v[8:11], v[16:31]
  v_exp_f32 v70, v70
  v_exp_f32 v71, v71
  v_cvt_pk_bf16_f32 v122, v68, v69
  v_exp_f32 v72, v72
  v_exp_f32 v73, v73
  v_cvt_pk_bf16_f32 v123, v70, v71
  v_exp_f32 v74, v74
  v_exp_f32 v75, v75
  v_mfma_f32_32x32x16_bf16 v[96:111], v[136:139], v[120:123], v[96:111]
  v_cvt_pk_bf16_f32 v124, v72, v73
  v_exp_f32 v76, v76
  v_exp_f32 v77, v77
  v_cvt_pk_bf16_f32 v125, v74, v75
  v_exp_f32 v78, v78
  v_exp_f32 v79, v79
  v_cvt_pk_bf16_f32 v126, v76, v77
  v_cvt_pk_bf16_f32 v127, v78, v79
  v_exp_f32 v48, v48
  v_exp_f32 v49, v49
  v_mfma_f32_32x32x16_bf16 v[96:111], v[140:143], v[124:127], v[96:111]
  v_exp_f32 v50, v50
  v_exp_f32 v51, v51
  v_cvt_pk_bf16_f32 v112, v48, v49
  v_exp_f32 v52, v52
  v_exp_f32 v53, v53
  v_cvt_pk_bf16_f32 v113, v50, v51
  s_waitcnt vmcnt(8)
  s_barrier
  v_mfma_f32_32x32x16_bf16 v[64:79], v[132:135], v[12:15], v[32:47]
  ds_read_b128 v[128:131], v5 offset:16512
  ds_read_b128 v[136:139], v160 offset:17536
  ds_read_b128 v[140:143], v161 offset:18048
  v_exp_f32 v54, v54
  v_exp_f32 v55, v55
  v_cvt_pk_bf16_f32 v114, v52, v53
  v_exp_f32 v56, v56
  v_exp_f32 v57, v57
  v_cvt_pk_bf16_f32 v115, v54, v55
  v_exp_f32 v58, v58
  v_exp_f32 v59, v59
  v_mfma_f32_32x32x16_bf16 v[80:95], v[144:147], v[112:115], v[80:95]
  v_cvt_pk_bf16_f32 v116, v56, v57
  v_exp_f32 v60, v60
  v_exp_f32 v61, v61
  v_cvt_pk_bf16_f32 v117, v58, v59
  v_exp_f32 v62, v62
  v_exp_f32 v63, v63
  v_cvt_pk_bf16_f32 v118, v60, v61
  v_cvt_pk_bf16_f32 v119, v62, v63
  v_exp_f32 v64, v64
  v_exp_f32 v65, v65
  v_mfma_f32_32x32x16_bf16 v[80:95], v[148:151], v[116:119], v[80:95]
  v_exp_f32 v66, v66
  v_exp_f32 v67, v67
  v_cvt_pk_bf16_f32 v120, v64, v65
  v_exp_f32 v68, v68
  v_exp_f32 v69, v69
  v_cvt_pk_bf16_f32 v121, v66, v67
  s_waitcnt lgkmcnt(0)
  v_mfma_f32_32x32x16_bf16 v[48:63], v[128:131], v[8:11], v[16:31]
  v_exp_f32 v70, v70
  v_exp_f32 v71, v71
  v_cvt_pk_bf16_f32 v122, v68, v69
  v_exp_f32 v72, v72
  v_exp_f32 v73, v73
  v_cvt_pk_bf16_f32 v123, v70, v71
  v_exp_f32 v74, v74
  v_exp_f32 v75, v75
  v_mfma_f32_32x32x16_bf16 v[96:111], v[144:147], v[120:123], v[96:111]
  v_cvt_pk_bf16_f32 v124, v72, v73
  v_exp_f32 v76, v76
  v_exp_f32 v77, v77
  v_cvt_pk_bf16_f32 v125, v74, v75
  v_exp_f32 v78, v78
  v_exp_f32 v79, v79
  v_cvt_pk_bf16_f32 v126, v76, v77
  v_cvt_pk_bf16_f32 v127, v78, v79
  v_exp_f32 v48, v48
  v_exp_f32 v49, v49
  v_mfma_f32_32x32x16_bf16 v[96:111], v[148:151], v[124:127], v[96:111]
  v_exp_f32 v50, v50
  v_exp_f32 v51, v51
  v_cvt_pk_bf16_f32 v112, v48, v49
  v_exp_f32 v52, v52
  v_exp_f32 v53, v53
  v_cvt_pk_bf16_f32 v113, v50, v51
  v_mfma_f32_32x32x16_bf16 v[64:79], v[128:131], v[12:15], v[32:47]
  ds_read_b128 v[132:135], v5 offset:18560
  ds_read_b128 v[144:147], v162 offset:19584
  ds_read_b128 v[148:151], v163 offset:20096
  v_exp_f32 v54, v54
  v_exp_f32 v55, v55
  v_cvt_pk_bf16_f32 v114, v52, v53
  v_exp_f32 v56, v56
  v_exp_f32 v57, v57
  v_cvt_pk_bf16_f32 v115, v54, v55
  v_exp_f32 v58, v58
  v_exp_f32 v59, v59
  v_mfma_f32_32x32x16_bf16 v[80:95], v[136:139], v[112:115], v[80:95]
  v_cvt_pk_bf16_f32 v116, v56, v57
  v_exp_f32 v60, v60
  v_exp_f32 v61, v61
  v_cvt_pk_bf16_f32 v117, v58, v59
  v_exp_f32 v62, v62
  v_exp_f32 v63, v63
  v_cvt_pk_bf16_f32 v118, v60, v61
  v_cvt_pk_bf16_f32 v119, v62, v63
  v_exp_f32 v64, v64
  v_exp_f32 v65, v65
  v_mfma_f32_32x32x16_bf16 v[80:95], v[140:143], v[116:119], v[80:95]
  v_exp_f32 v66, v66
  v_exp_f32 v67, v67
  v_cvt_pk_bf16_f32 v120, v64, v65
  v_exp_f32 v68, v68
  v_exp_f32 v69, v69
  v_cvt_pk_bf16_f32 v121, v66, v67
  s_waitcnt lgkmcnt(0)
  v_mfma_f32_32x32x16_bf16 v[48:63], v[132:135], v[8:11], v[16:31]
  v_exp_f32 v70, v70
  v_exp_f32 v71, v71
  v_cvt_pk_bf16_f32 v122, v68, v69
  v_exp_f32 v72, v72
  v_exp_f32 v73, v73
  v_cvt_pk_bf16_f32 v123, v70, v71
  v_exp_f32 v74, v74
  v_exp_f32 v75, v75
  v_mfma_f32_32x32x16_bf16 v[96:111], v[136:139], v[120:123], v[96:111]
  v_cvt_pk_bf16_f32 v124, v72, v73
  v_exp_f32 v76, v76
  v_exp_f32 v77, v77
  v_cvt_pk_bf16_f32 v125, v74, v75
  v_exp_f32 v78, v78
  v_exp_f32 v79, v79
  v_cvt_pk_bf16_f32 v126, v76, v77
  v_cvt_pk_bf16_f32 v127, v78, v79
  v_exp_f32 v48, v48
  v_exp_f32 v49, v49
  v_mfma_f32_32x32x16_bf16 v[96:111], v[140:143], v[124:127], v[96:111]
  v_exp_f32 v50, v50
  v_exp_f32 v51, v51
  v_cvt_pk_bf16_f32 v112, v48, v49
  v_exp_f32 v52, v52
  v_exp_f32 v53, v53
  v_cvt_pk_bf16_f32 v113, v50, v51
  v_mfma_f32_32x32x16_bf16 v[64:79], v[132:135], v[12:15], v[32:47]
  ds_read_b128 v[128:131], v5 offset:20640
  ds_read_b128 v[136:139], v160 offset:21664
  ds_read_b128 v[140:143], v161 offset:22176
  v_exp_f32 v54, v54
  v_exp_f32 v55, v55
  v_cvt_pk_bf16_f32 v114, v52, v53
  v_exp_f32 v56, v56
  v_exp_f32 v57, v57
  v_cvt_pk_bf16_f32 v115, v54, v55
  v_exp_f32 v58, v58
  v_exp_f32 v59, v59
  v_mfma_f32_32x32x16_bf16 v[80:95], v[144:147], v[112:115], v[80:95]
  v_cvt_pk_bf16_f32 v116, v56, v57
  v_exp_f32 v60, v60
  v_exp_f32 v61, v61
  v_cvt_pk_bf16_f32 v117, v58, v59
  v_exp_f32 v62, v62
  v_exp_f32 v63, v63
  v_cvt_pk_bf16_f32 v118, v60, v61
  v_cvt_pk_bf16_f32 v119, v62, v63
  v_exp_f32 v64, v64
  v_exp_f32 v65, v65
  v_mfma_f32_32x32x16_bf16 v[80:95], v[148:151], v[116:119], v[80:95]
  v_exp_f32 v66, v66
  v_exp_f32 v67, v67
  v_cvt_pk_bf16_f32 v120, v64, v65
  v_exp_f32 v68, v68
  v_exp_f32 v69, v69
  v_cvt_pk_bf16_f32 v121, v66, v67
  s_waitcnt lgkmcnt(0)
  v_mfma_f32_32x32x16_bf16 v[48:63], v[128:131], v[8:11], v[16:31]
  v_exp_f32 v70, v70
  v_exp_f32 v71, v71
  v_cvt_pk_bf16_f32 v122, v68, v69
  v_exp_f32 v72, v72
  v_exp_f32 v73, v73
  v_cvt_pk_bf16_f32 v123, v70, v71
  v_exp_f32 v74, v74
  v_exp_f32 v75, v75
  v_mfma_f32_32x32x16_bf16 v[96:111], v[144:147], v[120:123], v[96:111]
  v_cvt_pk_bf16_f32 v124, v72, v73
  v_exp_f32 v76, v76
  v_exp_f32 v77, v77
  v_cvt_pk_bf16_f32 v125, v74, v75
  v_exp_f32 v78, v78
  v_exp_f32 v79, v79
  v_cvt_pk_bf16_f32 v126, v76, v77
  v_cvt_pk_bf16_f32 v127, v78, v79
  v_exp_f32 v48, v48
  v_exp_f32 v49, v49
  v_mfma_f32_32x32x16_bf16 v[96:111], v[148:151], v[124:127], v[96:111]
  v_exp_f32 v50, v50
  v_exp_f32 v51, v51
  v_cvt_pk_bf16_f32 v112, v48, v49
  v_exp_f32 v52, v52
  v_exp_f32 v53, v53
  v_cvt_pk_bf16_f32 v113, v50, v51
  v_mfma_f32_32x32x16_bf16 v[64:79], v[128:131], v[12:15], v[32:47]
  ds_read_b128 v[132:135], v5 offset:22688
  ds_read_b128 v[144:147], v162 offset:23712
  ds_read_b128 v[148:151], v163 offset:24224
  v_exp_f32 v54, v54
  v_exp_f32 v55, v55
  v_cvt_pk_bf16_f32 v114, v52, v53
  v_exp_f32 v56, v56
  v_exp_f32 v57, v57
  v_cvt_pk_bf16_f32 v115, v54, v55
  v_exp_f32 v58, v58
  v_exp_f32 v59, v59
  v_mfma_f32_32x32x16_bf16 v[80:95], v[136:139], v[112:115], v[80:95]
  v_cvt_pk_bf16_f32 v116, v56, v57
  v_exp_f32 v60, v60
  v_exp_f32 v61, v61
  v_cvt_pk_bf16_f32 v117, v58, v59
  v_exp_f32 v62, v62
  v_exp_f32 v63, v63
  v_cvt_pk_bf16_f32 v118, v60, v61
  v_cvt_pk_bf16_f32 v119, v62, v63
  v_exp_f32 v64, v64
  v_exp_f32 v65, v65
  v_mfma_f32_32x32x16_bf16 v[80:95], v[140:143], v[116:119], v[80:95]
  v_exp_f32 v66, v66
  v_exp_f32 v67, v67
  v_cvt_pk_bf16_f32 v120, v64, v65
  v_exp_f32 v68, v68
  v_exp_f32 v69, v69
  v_cvt_pk_bf16_f32 v121, v66, v67
  s_waitcnt lgkmcnt(0)
  v_mfma_f32_32x32x16_bf16 v[48:63], v[132:135], v[8:11], v[16:31]
  v_exp_f32 v70, v70
  v_exp_f32 v71, v71
  v_cvt_pk_bf16_f32 v122, v68, v69
  v_exp_f32 v72, v72
  v_exp_f32 v73, v73
  v_cvt_pk_bf16_f32 v123, v70, v71
  v_exp_f32 v74, v74
  v_exp_f32 v75, v75
  v_mfma_f32_32x32x16_bf16 v[96:111], v[136:139], v[120:123], v[96:111]
  v_cvt_pk_bf16_f32 v124, v72, v73
  v_exp_f32 v76, v76
  v_exp_f32 v77, v77
  v_cvt_pk_bf16_f32 v125, v74, v75
  v_exp_f32 v78, v78
  v_exp_f32 v79, v79
  v_cvt_pk_bf16_f32 v126, v76, v77
  v_cvt_pk_bf16_f32 v127, v78, v79
  v_exp_f32 v48, v48
  v_exp_f32 v49, v49
  v_mfma_f32_32x32x16_bf16 v[96:111], v[140:143], v[124:127], v[96:111]
  v_exp_f32 v50, v50
  v_exp_f32 v51, v51
  v_cvt_pk_bf16_f32 v112, v48, v49
  v_exp_f32 v52, v52
  v_exp_f32 v53, v53
  v_cvt_pk_bf16_f32 v113, v50, v51
  v_mfma_f32_32x32x16_bf16 v[64:79], v[132:135], v[12:15], v[32:47]
  ds_read_b128 v[128:131], v5 offset:24768
  ds_read_b128 v[136:139], v160 offset:25792
  ds_read_b128 v[140:143], v161 offset:26304
  v_exp_f32 v54, v54
  v_exp_f32 v55, v55
  v_cvt_pk_bf16_f32 v114, v52, v53
  v_exp_f32 v56, v56
  v_exp_f32 v57, v57
  v_cvt_pk_bf16_f32 v115, v54, v55
  v_exp_f32 v58, v58
  v_exp_f32 v59, v59
  v_mfma_f32_32x32x16_bf16 v[80:95], v[144:147], v[112:115], v[80:95]
  v_cvt_pk_bf16_f32 v116, v56, v57
  v_exp_f32 v60, v60
  v_exp_f32 v61, v61
  v_cvt_pk_bf16_f32 v117, v58, v59
  v_exp_f32 v62, v62
  v_exp_f32 v63, v63
  v_cvt_pk_bf16_f32 v118, v60, v61
  v_cvt_pk_bf16_f32 v119, v62, v63
  v_exp_f32 v64, v64
  v_exp_f32 v65, v65
  v_mfma_f32_32x32x16_bf16 v[80:95], v[148:151], v[116:119], v[80:95]
  v_exp_f32 v66, v66
  v_exp_f32 v67, v67
  v_cvt_pk_bf16_f32 v120, v64, v65
  v_exp_f32 v68, v68
  v_exp_f32 v69, v69
  v_cvt_pk_bf16_f32 v121, v66, v67
  s_waitcnt lgkmcnt(0)
  v_mfma_f32_32x32x16_bf16 v[48:63], v[128:131], v[8:11], v[16:31]
  v_exp_f32 v70, v70
  v_exp_f32 v71, v71
  v_cvt_pk_bf16_f32 v122, v68, v69
  v_exp_f32 v72, v72
  v_exp_f32 v73, v73
  v_cvt_pk_bf16_f32 v123, v70, v71
  v_exp_f32 v74, v74
  v_exp_f32 v75, v75
  v_mfma_f32_32x32x16_bf16 v[96:111], v[144:147], v[120:123], v[96:111]
  v_cvt_pk_bf16_f32 v124, v72, v73
  v_exp_f32 v76, v76
  v_exp_f32 v77, v77
  v_cvt_pk_bf16_f32 v125, v74, v75
  v_exp_f32 v78, v78
  v_exp_f32 v79, v79
  v_cvt_pk_bf16_f32 v126, v76, v77
  v_cvt_pk_bf16_f32 v127, v78, v79
  v_exp_f32 v48, v48
  v_exp_f32 v49, v49
  v_mfma_f32_32x32x16_bf16 v[96:111], v[148:151], v[124:127], v[96:111]
  v_exp_f32 v50, v50
  v_exp_f32 v51, v51
  v_cvt_pk_bf16_f32 v112, v48, v49
  v_exp_f32 v52, v52
  v_exp_f32 v53, v53
  v_cvt_pk_bf16_f32 v113, v50, v51
  v_mfma_f32_32x32x16_bf16 v[64:79], v[128:131], v[12:15], v[32:47]
  ds_read_b128 v[132:135], v5 offset:26816
  ds_read_b128 v[144:147], v162 offset:27840
  ds_read_b128 v[148:151], v163 offset:28352
  v_exp_f32 v54, v54
  v_exp_f32 v55, v55
  v_cvt_pk_bf16_f32 v114, v52, v53
  v_exp_f32 v56, v56
  v_exp_f32 v57, v57
  v_cvt_pk_bf16_f32 v115, v54, v55
  v_exp_f32 v58, v58
  v_exp_f32 v59, v59
  v_mfma_f32_32x32x16_bf16 v[80:95], v[136:139], v[112:115], v[80:95]
  v_cvt_pk_bf16_f32 v116, v56, v57
  v_exp_f32 v60, v60
  v_exp_f32 v61, v61
  v_cvt_pk_bf16_f32 v117, v58, v59
  v_exp_f32 v62, v62
  v_exp_f32 v63, v63
  v_cvt_pk_bf16_f32 v118, v60, v61
  v_cvt_pk_bf16_f32 v119, v62, v63
  v_exp_f32 v64, v64
  v_exp_f32 v65, v65
  v_mfma_f32_32x32x16_bf16 v[80:95], v[140:143], v[116:119], v[80:95]
  v_exp_f32 v66, v66
  v_exp_f32 v67, v67
  v_cvt_pk_bf16_f32 v120, v64, v65
  v_exp_f32 v68, v68
  v_exp_f32 v69, v69
  v_cvt_pk_bf16_f32 v121, v66, v67
  s_waitcnt lgkmcnt(0)
  v_mfma_f32_32x32x16_bf16 v[48:63], v[132:135], v[8:11], v[16:31]
  v_exp_f32 v70, v70
  v_exp_f32 v71, v71
  v_cvt_pk_bf16_f32 v122, v68, v69
  v_exp_f32 v72, v72
  v_exp_f32 v73, v73
  v_cvt_pk_bf16_f32 v123, v70, v71
  v_exp_f32 v74, v74
  v_exp_f32 v75, v75
  v_mfma_f32_32x32x16_bf16 v[96:111], v[136:139], v[120:123], v[96:111]
  v_cvt_pk_bf16_f32 v124, v72, v73
  v_exp_f32 v76, v76
  v_exp_f32 v77, v77
  v_cvt_pk_bf16_f32 v125, v74, v75
  v_exp_f32 v78, v78
  v_exp_f32 v79, v79
  v_cvt_pk_bf16_f32 v126, v76, v77
  v_cvt_pk_bf16_f32 v127, v78, v79
  v_exp_f32 v48, v48
  v_exp_f32 v49, v49
  v_mfma_f32_32x32x16_bf16 v[96:111], v[140:143], v[124:127], v[96:111]
  v_exp_f32 v50, v50
  v_exp_f32 v51, v51
  v_cvt_pk_bf16_f32 v112, v48, v49
  v_exp_f32 v52, v52
  v_exp_f32 v53, v53
  v_cvt_pk_bf16_f32 v113, v50, v51
  v_mfma_f32_32x32x16_bf16 v[64:79], v[132:135], v[12:15], v[32:47]
  ds_read_b128 v[128:131], v5 offset:28896
  ds_read_b128 v[136:139], v160 offset:29920
  ds_read_b128 v[140:143], v161 offset:30432
  v_exp_f32 v54, v54
  v_exp_f32 v55, v55
  v_cvt_pk_bf16_f32 v114, v52, v53
  v_exp_f32 v56, v56
  v_exp_f32 v57, v57
  v_cvt_pk_bf16_f32 v115, v54, v55
  v_exp_f32 v58, v58
  v_exp_f32 v59, v59
  v_mfma_f32_32x32x16_bf16 v[80:95], v[144:147], v[112:115], v[80:95]
  v_cvt_pk_bf16_f32 v116, v56, v57
  v_exp_f32 v60, v60
  v_exp_f32 v61, v61
  v_cvt_pk_bf16_f32 v117, v58, v59
  v_exp_f32 v62, v62
  v_exp_f32 v63, v63
  v_cvt_pk_bf16_f32 v118, v60, v61
  v_cvt_pk_bf16_f32 v119, v62, v63
  v_exp_f32 v64, v64
  v_exp_f32 v65, v65
  v_mfma_f32_32x32x16_bf16 v[80:95], v[148:151], v[116:119], v[80:95]
  v_exp_f32 v66, v66
  v_exp_f32 v67, v67
  v_cvt_pk_bf16_f32 v120, v64, v65
  v_exp_f32 v68, v68
  v_exp_f32 v69, v69
  v_cvt_pk_bf16_f32 v121, v66, v67
  s_waitcnt lgkmcnt(0)
  v_mfma_f32_32x32x16_bf16 v[48:63], v[128:131], v[8:11], v[16:31]
  v_exp_f32 v70, v70
  v_exp_f32 v71, v71
  v_cvt_pk_bf16_f32 v122, v68, v69
  v_exp_f32 v72, v72
  v_exp_f32 v73, v73
  v_cvt_pk_bf16_f32 v123, v70, v71
  v_exp_f32 v74, v74
  v_exp_f32 v75, v75
  v_mfma_f32_32x32x16_bf16 v[96:111], v[144:147], v[120:123], v[96:111]
  v_cvt_pk_bf16_f32 v124, v72, v73
  v_exp_f32 v76, v76
  v_exp_f32 v77, v77
  v_cvt_pk_bf16_f32 v125, v74, v75
  v_exp_f32 v78, v78
  v_exp_f32 v79, v79
  v_cvt_pk_bf16_f32 v126, v76, v77
  v_cvt_pk_bf16_f32 v127, v78, v79
  v_exp_f32 v48, v48
  v_exp_f32 v49, v49
  v_mfma_f32_32x32x16_bf16 v[96:111], v[148:151], v[124:127], v[96:111]
  v_exp_f32 v50, v50
  v_exp_f32 v51, v51
  v_cvt_pk_bf16_f32 v112, v48, v49
  v_exp_f32 v52, v52
  v_exp_f32 v53, v53
  v_cvt_pk_bf16_f32 v113, v50, v51
  v_mfma_f32_32x32x16_bf16 v[64:79], v[128:131], v[12:15], v[32:47]
  ds_read_b128 v[132:135], v5 offset:30944
  ds_read_b128 v[144:147], v162 offset:31968
  ds_read_b128 v[148:151], v163 offset:32480
  v_exp_f32 v54, v54
  v_exp_f32 v55, v55
  v_cvt_pk_bf16_f32 v114, v52, v53
  v_exp_f32 v56, v56
  v_exp_f32 v57, v57
  v_cvt_pk_bf16_f32 v115, v54, v55
  v_exp_f32 v58, v58
  v_exp_f32 v59, v59
  v_mfma_f32_32x32x16_bf16 v[80:95], v[136:139], v[112:115], v[80:95]
  v_cvt_pk_bf16_f32 v116, v56, v57
  v_exp_f32 v60, v60
  v_exp_f32 v61, v61
  v_cvt_pk_bf16_f32 v117, v58, v59
  v_exp_f32 v62, v62
  v_exp_f32 v63, v63
  v_cvt_pk_bf16_f32 v118, v60, v61
  v_cvt_pk_bf16_f32 v119, v62, v63
  v_exp_f32 v64, v64
  v_exp_f32 v65, v65
  v_mfma_f32_32x32x16_bf16 v[80:95], v[140:143], v[116:119], v[80:95]
  v_exp_f32 v66, v66
  v_exp_f32 v67, v67
  v_cvt_pk_bf16_f32 v120, v64, v65
  v_exp_f32 v68, v68
  v_exp_f32 v69, v69
  v_cvt_pk_bf16_f32 v121, v66, v67
  s_waitcnt lgkmcnt(0)
  v_mfma_f32_32x32x16_bf16 v[48:63], v[132:135], v[8:11], v[16:31]
  v_exp_f32 v70, v70
  v_exp_f32 v71, v71
  v_cvt_pk_bf16_f32 v122, v68, v69
  v_exp_f32 v72, v72
  v_exp_f32 v73, v73
  v_cvt_pk_bf16_f32 v123, v70, v71
  v_exp_f32 v74, v74
  v_exp_f32 v75, v75
  v_mfma_f32_32x32x16_bf16 v[96:111], v[136:139], v[120:123], v[96:111]
  v_cvt_pk_bf16_f32 v124, v72, v73
  v_exp_f32 v76, v76
  v_exp_f32 v77, v77
  v_cvt_pk_bf16_f32 v125, v74, v75
  v_exp_f32 v78, v78
  v_exp_f32 v79, v79
  v_cvt_pk_bf16_f32 v126, v76, v77
  v_cvt_pk_bf16_f32 v127, v78, v79
  v_exp_f32 v48, v48
  v_exp_f32 v49, v49
  v_mfma_f32_32x32x16_bf16 v[96:111], v[140:143], v[124:127], v[96:111]
  v_exp_f32 v50, v50
  v_exp_f32 v51, v51
  v_cvt_pk_bf16_f32 v112, v48, v49
  v_exp_f32 v52, v52
  v_exp_f32 v53, v53
  v_cvt_pk_bf16_f32 v113, v50, v51
  s_waitcnt vmcnt(4)
  s_barrier
  v_mfma_f32_32x32x16_bf16 v[64:79], v[132:135], v[12:15], v[32:47]
  ds_read_b128 v[128:131], v5 offset:33024
  ds_read_b128 v[136:139], v160 offset:34048
  ds_read_b128 v[140:143], v161 offset:34560
  v_exp_f32 v54, v54
  v_exp_f32 v55, v55
  v_cvt_pk_bf16_f32 v114, v52, v53
  v_exp_f32 v56, v56
  v_exp_f32 v57, v57
  v_cvt_pk_bf16_f32 v115, v54, v55
  v_exp_f32 v58, v58
  v_exp_f32 v59, v59
  v_mfma_f32_32x32x16_bf16 v[80:95], v[144:147], v[112:115], v[80:95]
  v_cvt_pk_bf16_f32 v116, v56, v57
  v_exp_f32 v60, v60
  v_exp_f32 v61, v61
  v_cvt_pk_bf16_f32 v117, v58, v59
  v_exp_f32 v62, v62
  v_exp_f32 v63, v63
  v_cvt_pk_bf16_f32 v118, v60, v61
  v_cvt_pk_bf16_f32 v119, v62, v63
  v_exp_f32 v64, v64
  v_exp_f32 v65, v65
  v_mfma_f32_32x32x16_bf16 v[80:95], v[148:151], v[116:119], v[80:95]
  v_exp_f32 v66, v66
  v_exp_f32 v67, v67
  v_cvt_pk_bf16_f32 v120, v64, v65
  v_exp_f32 v68, v68
  v_exp_f32 v69, v69
  v_cvt_pk_bf16_f32 v121, v66, v67
  s_waitcnt lgkmcnt(0)
  v_mfma_f32_32x32x16_bf16 v[48:63], v[128:131], v[8:11], v[16:31]
  v_exp_f32 v70, v70
  v_exp_f32 v71, v71
  v_cvt_pk_bf16_f32 v122, v68, v69
  v_exp_f32 v72, v72
  v_exp_f32 v73, v73
  v_cvt_pk_bf16_f32 v123, v70, v71
  v_exp_f32 v74, v74
  v_exp_f32 v75, v75
  v_mfma_f32_32x32x16_bf16 v[96:111], v[144:147], v[120:123], v[96:111]
  v_cvt_pk_bf16_f32 v124, v72, v73
  v_exp_f32 v76, v76
  v_exp_f32 v77, v77
  v_cvt_pk_bf16_f32 v125, v74, v75
  v_exp_f32 v78, v78
  v_exp_f32 v79, v79
  v_cvt_pk_bf16_f32 v126, v76, v77
  v_cvt_pk_bf16_f32 v127, v78, v79
  v_exp_f32 v48, v48
  v_exp_f32 v49, v49
  v_mfma_f32_32x32x16_bf16 v[96:111], v[148:151], v[124:127], v[96:111]
  v_exp_f32 v50, v50
  v_exp_f32 v51, v51
  v_cvt_pk_bf16_f32 v112, v48, v49
  v_exp_f32 v52, v52
  v_exp_f32 v53, v53
  v_cvt_pk_bf16_f32 v113, v50, v51
  v_mfma_f32_32x32x16_bf16 v[64:79], v[128:131], v[12:15], v[32:47]
  ds_read_b128 v[132:135], v5 offset:35072
  ds_read_b128 v[144:147], v162 offset:36096
  ds_read_b128 v[148:151], v163 offset:36608
  v_exp_f32 v54, v54
  v_exp_f32 v55, v55
  v_cvt_pk_bf16_f32 v114, v52, v53
  v_exp_f32 v56, v56
  v_exp_f32 v57, v57
  v_cvt_pk_bf16_f32 v115, v54, v55
  v_exp_f32 v58, v58
  v_exp_f32 v59, v59
  v_mfma_f32_32x32x16_bf16 v[80:95], v[136:139], v[112:115], v[80:95]
  v_cvt_pk_bf16_f32 v116, v56, v57
  v_exp_f32 v60, v60
  v_exp_f32 v61, v61
  v_cvt_pk_bf16_f32 v117, v58, v59
  v_exp_f32 v62, v62
  v_exp_f32 v63, v63
  v_cvt_pk_bf16_f32 v118, v60, v61
  v_cvt_pk_bf16_f32 v119, v62, v63
  v_exp_f32 v64, v64
  v_exp_f32 v65, v65
  v_mfma_f32_32x32x16_bf16 v[80:95], v[140:143], v[116:119], v[80:95]
  v_exp_f32 v66, v66
  v_exp_f32 v67, v67
  v_cvt_pk_bf16_f32 v120, v64, v65
  v_exp_f32 v68, v68
  v_exp_f32 v69, v69
  v_cvt_pk_bf16_f32 v121, v66, v67
  s_waitcnt lgkmcnt(0)
  v_mfma_f32_32x32x16_bf16 v[48:63], v[132:135], v[8:11], v[16:31]
  v_exp_f32 v70, v70
  v_exp_f32 v71, v71
  v_cvt_pk_bf16_f32 v122, v68, v69
  v_exp_f32 v72, v72
  v_exp_f32 v73, v73
  v_cvt_pk_bf16_f32 v123, v70, v71
  v_exp_f32 v74, v74
  v_exp_f32 v75, v75
  v_mfma_f32_32x32x16_bf16 v[96:111], v[136:139], v[120:123], v[96:111]
  v_cvt_pk_bf16_f32 v124, v72, v73
  v_exp_f32 v76, v76
  v_exp_f32 v77, v77
  v_cvt_pk_bf16_f32 v125, v74, v75
  v_exp_f32 v78, v78
  v_exp_f32 v79, v79
  v_cvt_pk_bf16_f32 v126, v76, v77
  v_cvt_pk_bf16_f32 v127, v78, v79
  v_exp_f32 v48, v48
  v_exp_f32 v49, v49
  v_mfma_f32_32x32x16_bf16 v[96:111], v[140:143], v[124:127], v[96:111]
  v_exp_f32 v50, v50
  v_exp_f32 v51, v51
  v_cvt_pk_bf16_f32 v112, v48, v49
  v_exp_f32 v52, v52
  v_exp_f32 v53, v53
  v_cvt_pk_bf16_f32 v113, v50, v51
  v_mfma_f32_32x32x16_bf16 v[64:79], v[132:135], v[12:15], v[32:47]
  ds_read_b128 v[128:131], v5 offset:37152
  ds_read_b128 v[136:139], v160 offset:38176
  ds_read_b128 v[140:143], v161 offset:38688
  v_exp_f32 v54, v54
  v_exp_f32 v55, v55
  v_cvt_pk_bf16_f32 v114, v52, v53
  v_exp_f32 v56, v56
  v_exp_f32 v57, v57
  v_cvt_pk_bf16_f32 v115, v54, v55
  v_exp_f32 v58, v58
  v_exp_f32 v59, v59
  v_mfma_f32_32x32x16_bf16 v[80:95], v[144:147], v[112:115], v[80:95]
  v_cvt_pk_bf16_f32 v116, v56, v57
  v_exp_f32 v60, v60
  v_exp_f32 v61, v61
  v_cvt_pk_bf16_f32 v117, v58, v59
  v_exp_f32 v62, v62
  v_exp_f32 v63, v63
  v_cvt_pk_bf16_f32 v118, v60, v61
  v_cvt_pk_bf16_f32 v119, v62, v63
  v_exp_f32 v64, v64
  v_exp_f32 v65, v65
  v_mfma_f32_32x32x16_bf16 v[80:95], v[148:151], v[116:119], v[80:95]
  v_exp_f32 v66, v66
  v_exp_f32 v67, v67
  v_cvt_pk_bf16_f32 v120, v64, v65
  v_exp_f32 v68, v68
  v_exp_f32 v69, v69
  v_cvt_pk_bf16_f32 v121, v66, v67
  s_waitcnt lgkmcnt(0)
  v_mfma_f32_32x32x16_bf16 v[48:63], v[128:131], v[8:11], v[16:31]
  v_exp_f32 v70, v70
  v_exp_f32 v71, v71
  v_cvt_pk_bf16_f32 v122, v68, v69
  v_exp_f32 v72, v72
  v_exp_f32 v73, v73
  v_cvt_pk_bf16_f32 v123, v70, v71
  v_exp_f32 v74, v74
  v_exp_f32 v75, v75
  v_mfma_f32_32x32x16_bf16 v[96:111], v[144:147], v[120:123], v[96:111]
  v_cvt_pk_bf16_f32 v124, v72, v73
  v_exp_f32 v76, v76
  v_exp_f32 v77, v77
  v_cvt_pk_bf16_f32 v125, v74, v75
  v_exp_f32 v78, v78
  v_exp_f32 v79, v79
  v_cvt_pk_bf16_f32 v126, v76, v77
  v_cvt_pk_bf16_f32 v127, v78, v79
  v_exp_f32 v48, v48
  v_exp_f32 v49, v49
  v_mfma_f32_32x32x16_bf16 v[96:111], v[148:151], v[124:127], v[96:111]
  v_exp_f32 v50, v50
  v_exp_f32 v51, v51
  v_cvt_pk_bf16_f32 v112, v48, v49
  v_exp_f32 v52, v52
  v_exp_f32 v53, v53
  v_cvt_pk_bf16_f32 v113, v50, v51
  v_mfma_f32_32x32x16_bf16 v[64:79], v[128:131], v[12:15], v[32:47]
  ds_read_b128 v[132:135], v5 offset:39200
  ds_read_b128 v[144:147], v162 offset:40224
  ds_read_b128 v[148:151], v163 offset:40736
  v_exp_f32 v54, v54
  v_exp_f32 v55, v55
  v_cvt_pk_bf16_f32 v114, v52, v53
  v_exp_f32 v56, v56
  v_exp_f32 v57, v57
  v_cvt_pk_bf16_f32 v115, v54, v55
  v_exp_f32 v58, v58
  v_exp_f32 v59, v59
  v_mfma_f32_32x32x16_bf16 v[80:95], v[136:139], v[112:115], v[80:95]
  v_cvt_pk_bf16_f32 v116, v56, v57
  v_exp_f32 v60, v60
  v_exp_f32 v61, v61
  v_cvt_pk_bf16_f32 v117, v58, v59
  v_exp_f32 v62, v62
  v_exp_f32 v63, v63
  v_cvt_pk_bf16_f32 v118, v60, v61
  v_cvt_pk_bf16_f32 v119, v62, v63
  v_exp_f32 v64, v64
  v_exp_f32 v65, v65
  v_mfma_f32_32x32x16_bf16 v[80:95], v[140:143], v[116:119], v[80:95]
  v_exp_f32 v66, v66
  v_exp_f32 v67, v67
  v_cvt_pk_bf16_f32 v120, v64, v65
  v_exp_f32 v68, v68
  v_exp_f32 v69, v69
  v_cvt_pk_bf16_f32 v121, v66, v67
  s_waitcnt lgkmcnt(0)
  v_mfma_f32_32x32x16_bf16 v[48:63], v[132:135], v[8:11], v[16:31]
  v_exp_f32 v70, v70
  v_exp_f32 v71, v71
  v_cvt_pk_bf16_f32 v122, v68, v69
  v_exp_f32 v72, v72
  v_exp_f32 v73, v73
  v_cvt_pk_bf16_f32 v123, v70, v71
  v_exp_f32 v74, v74
  v_exp_f32 v75, v75
  v_mfma_f32_32x32x16_bf16 v[96:111], v[136:139], v[120:123], v[96:111]
  v_cvt_pk_bf16_f32 v124, v72, v73
  v_exp_f32 v76, v76
  v_exp_f32 v77, v77
  v_cvt_pk_bf16_f32 v125, v74, v75
  v_exp_f32 v78, v78
  v_exp_f32 v79, v79
  v_cvt_pk_bf16_f32 v126, v76, v77
  v_cvt_pk_bf16_f32 v127, v78, v79
  v_exp_f32 v48, v48
  v_exp_f32 v49, v49
  v_mfma_f32_32x32x16_bf16 v[96:111], v[140:143], v[124:127], v[96:111]
  v_exp_f32 v50, v50
  v_exp_f32 v51, v51
  v_cvt_pk_bf16_f32 v112, v48, v49
  v_exp_f32 v52, v52
  v_exp_f32 v53, v53
  v_cvt_pk_bf16_f32 v113, v50, v51
  v_mfma_f32_32x32x16_bf16 v[64:79], v[132:135], v[12:15], v[32:47]
  ds_read_b128 v[128:131], v5 offset:41280
  ds_read_b128 v[136:139], v160 offset:42304
  ds_read_b128 v[140:143], v161 offset:42816
  v_exp_f32 v54, v54
  v_exp_f32 v55, v55
  v_cvt_pk_bf16_f32 v114, v52, v53
  v_exp_f32 v56, v56
  v_exp_f32 v57, v57
  v_cvt_pk_bf16_f32 v115, v54, v55
  v_exp_f32 v58, v58
  v_exp_f32 v59, v59
  v_mfma_f32_32x32x16_bf16 v[80:95], v[144:147], v[112:115], v[80:95]
  v_cvt_pk_bf16_f32 v116, v56, v57
  v_exp_f32 v60, v60
  v_exp_f32 v61, v61
  v_cvt_pk_bf16_f32 v117, v58, v59
  v_exp_f32 v62, v62
  v_exp_f32 v63, v63
  v_cvt_pk_bf16_f32 v118, v60, v61
  v_cvt_pk_bf16_f32 v119, v62, v63
  v_exp_f32 v64, v64
  v_exp_f32 v65, v65
  v_mfma_f32_32x32x16_bf16 v[80:95], v[148:151], v[116:119], v[80:95]
  v_exp_f32 v66, v66
  v_exp_f32 v67, v67
  v_cvt_pk_bf16_f32 v120, v64, v65
  v_exp_f32 v68, v68
  v_exp_f32 v69, v69
  v_cvt_pk_bf16_f32 v121, v66, v67
  s_waitcnt lgkmcnt(0)
  v_mfma_f32_32x32x16_bf16 v[48:63], v[128:131], v[8:11], v[16:31]
  v_exp_f32 v70, v70
  v_exp_f32 v71, v71
  v_cvt_pk_bf16_f32 v122, v68, v69
  v_exp_f32 v72, v72
  v_exp_f32 v73, v73
  v_cvt_pk_bf16_f32 v123, v70, v71
  v_exp_f32 v74, v74
  v_exp_f32 v75, v75
  v_mfma_f32_32x32x16_bf16 v[96:111], v[144:147], v[120:123], v[96:111]
  v_cvt_pk_bf16_f32 v124, v72, v73
  v_exp_f32 v76, v76
  v_exp_f32 v77, v77
  v_cvt_pk_bf16_f32 v125, v74, v75
  v_exp_f32 v78, v78
  v_exp_f32 v79, v79
  v_cvt_pk_bf16_f32 v126, v76, v77
  v_cvt_pk_bf16_f32 v127, v78, v79
  v_exp_f32 v48, v48
  v_exp_f32 v49, v49
  v_mfma_f32_32x32x16_bf16 v[96:111], v[148:151], v[124:127], v[96:111]
  v_exp_f32 v50, v50
  v_exp_f32 v51, v51
  v_cvt_pk_bf16_f32 v112, v48, v49
  v_exp_f32 v52, v52
  v_exp_f32 v53, v53
  v_cvt_pk_bf16_f32 v113, v50, v51
  v_mfma_f32_32x32x16_bf16 v[64:79], v[128:131], v[12:15], v[32:47]
  ds_read_b128 v[132:135], v5 offset:43328
  ds_read_b128 v[144:147], v162 offset:44352
  ds_read_b128 v[148:151], v163 offset:44864
  v_exp_f32 v54, v54
  v_exp_f32 v55, v55
  v_cvt_pk_bf16_f32 v114, v52, v53
  v_exp_f32 v56, v56
  v_exp_f32 v57, v57
  v_cvt_pk_bf16_f32 v115, v54, v55
  v_exp_f32 v58, v58
  v_exp_f32 v59, v59
  v_mfma_f32_32x32x16_bf16 v[80:95], v[136:139], v[112:115], v[80:95]
  v_cvt_pk_bf16_f32 v116, v56, v57
  v_exp_f32 v60, v60
  v_exp_f32 v61, v61
  v_cvt_pk_bf16_f32 v117, v58, v59
  v_exp_f32 v62, v62
  v_exp_f32 v63, v63
  v_cvt_pk_bf16_f32 v118, v60, v61
  v_cvt_pk_bf16_f32 v119, v62, v63
  v_exp_f32 v64, v64
  v_exp_f32 v65, v65
  v_mfma_f32_32x32x16_bf16 v[80:95], v[140:143], v[116:119], v[80:95]
  v_exp_f32 v66, v66
  v_exp_f32 v67, v67
  v_cvt_pk_bf16_f32 v120, v64, v65
  v_exp_f32 v68, v68
  v_exp_f32 v69, v69
  v_cvt_pk_bf16_f32 v121, v66, v67
  s_waitcnt lgkmcnt(0)
  v_mfma_f32_32x32x16_bf16 v[48:63], v[132:135], v[8:11], v[16:31]
  v_exp_f32 v70, v70
  v_exp_f32 v71, v71
  v_cvt_pk_bf16_f32 v122, v68, v69
  v_exp_f32 v72, v72
  v_exp_f32 v73, v73
  v_cvt_pk_bf16_f32 v123, v70, v71
  v_exp_f32 v74, v74
  v_exp_f32 v75, v75
  v_mfma_f32_32x32x16_bf16 v[96:111], v[136:139], v[120:123], v[96:111]
  v_cvt_pk_bf16_f32 v124, v72, v73
  v_exp_f32 v76, v76
  v_exp_f32 v77, v77
  v_cvt_pk_bf16_f32 v125, v74, v75
  v_exp_f32 v78, v78
  v_exp_f32 v79, v79
  v_cvt_pk_bf16_f32 v126, v76, v77
  v_cvt_pk_bf16_f32 v127, v78, v79
  v_exp_f32 v48, v48
  v_exp_f32 v49, v49
  v_mfma_f32_32x32x16_bf16 v[96:111], v[140:143], v[124:127], v[96:111]
  v_exp_f32 v50, v50
  v_exp_f32 v51, v51
  v_cvt_pk_bf16_f32 v112, v48, v49
  v_exp_f32 v52, v52
  v_exp_f32 v53, v53
  v_cvt_pk_bf16_f32 v113, v50, v51
  v_mfma_f32_32x32x16_bf16 v[64:79], v[132:135], v[12:15], v[32:47]
  ds_read_b128 v[128:131], v5 offset:45408
  ds_read_b128 v[136:139], v160 offset:46432
  ds_read_b128 v[140:143], v161 offset:46944
  v_exp_f32 v54, v54
  v_exp_f32 v55, v55
  v_cvt_pk_bf16_f32 v114, v52, v53
  v_exp_f32 v56, v56
  v_exp_f32 v57, v57
  v_cvt_pk_bf16_f32 v115, v54, v55
  v_exp_f32 v58, v58
  v_exp_f32 v59, v59
  v_mfma_f32_32x32x16_bf16 v[80:95], v[144:147], v[112:115], v[80:95]
  v_cvt_pk_bf16_f32 v116, v56, v57
  v_exp_f32 v60, v60
  v_exp_f32 v61, v61
  v_cvt_pk_bf16_f32 v117, v58, v59
  v_exp_f32 v62, v62
  v_exp_f32 v63, v63
  v_cvt_pk_bf16_f32 v118, v60, v61
  v_cvt_pk_bf16_f32 v119, v62, v63
  v_exp_f32 v64, v64
  v_exp_f32 v65, v65
  v_mfma_f32_32x32x16_bf16 v[80:95], v[148:151], v[116:119], v[80:95]
  v_exp_f32 v66, v66
  v_exp_f32 v67, v67
  v_cvt_pk_bf16_f32 v120, v64, v65
  v_exp_f32 v68, v68
  v_exp_f32 v69, v69
  v_cvt_pk_bf16_f32 v121, v66, v67
  s_waitcnt lgkmcnt(0)
  v_mfma_f32_32x32x16_bf16 v[48:63], v[128:131], v[8:11], v[16:31]
  v_exp_f32 v70, v70
  v_exp_f32 v71, v71
  v_cvt_pk_bf16_f32 v122, v68, v69
  v_exp_f32 v72, v72
  v_exp_f32 v73, v73
  v_cvt_pk_bf16_f32 v123, v70, v71
  v_exp_f32 v74, v74
  v_exp_f32 v75, v75
  v_mfma_f32_32x32x16_bf16 v[96:111], v[144:147], v[120:123], v[96:111]
  v_cvt_pk_bf16_f32 v124, v72, v73
  v_exp_f32 v76, v76
  v_exp_f32 v77, v77
  v_cvt_pk_bf16_f32 v125, v74, v75
  v_exp_f32 v78, v78
  v_exp_f32 v79, v79
  v_cvt_pk_bf16_f32 v126, v76, v77
  v_cvt_pk_bf16_f32 v127, v78, v79
  v_exp_f32 v48, v48
  v_exp_f32 v49, v49
  v_mfma_f32_32x32x16_bf16 v[96:111], v[148:151], v[124:127], v[96:111]
  v_exp_f32 v50, v50
  v_exp_f32 v51, v51
  v_cvt_pk_bf16_f32 v112, v48, v49
  v_exp_f32 v52, v52
  v_exp_f32 v53, v53
  v_cvt_pk_bf16_f32 v113, v50, v51
  v_mfma_f32_32x32x16_bf16 v[64:79], v[128:131], v[12:15], v[32:47]
  ds_read_b128 v[132:135], v5 offset:47456
  ds_read_b128 v[144:147], v162 offset:48480
  ds_read_b128 v[148:151], v163 offset:48992
  v_exp_f32 v54, v54
  v_exp_f32 v55, v55
  v_cvt_pk_bf16_f32 v114, v52, v53
  v_exp_f32 v56, v56
  v_exp_f32 v57, v57
  v_cvt_pk_bf16_f32 v115, v54, v55
  v_exp_f32 v58, v58
  v_exp_f32 v59, v59
  v_mfma_f32_32x32x16_bf16 v[80:95], v[136:139], v[112:115], v[80:95]
  v_cvt_pk_bf16_f32 v116, v56, v57
  v_exp_f32 v60, v60
  v_exp_f32 v61, v61
  v_cvt_pk_bf16_f32 v117, v58, v59
  v_exp_f32 v62, v62
  v_exp_f32 v63, v63
  v_cvt_pk_bf16_f32 v118, v60, v61
  v_cvt_pk_bf16_f32 v119, v62, v63
  v_exp_f32 v64, v64
  v_exp_f32 v65, v65
  v_mfma_f32_32x32x16_bf16 v[80:95], v[140:143], v[116:119], v[80:95]
  v_exp_f32 v66, v66
  v_exp_f32 v67, v67
  v_cvt_pk_bf16_f32 v120, v64, v65
  v_exp_f32 v68, v68
  v_exp_f32 v69, v69
  v_cvt_pk_bf16_f32 v121, v66, v67
  s_waitcnt lgkmcnt(0)
  v_mfma_f32_32x32x16_bf16 v[48:63], v[132:135], v[8:11], v[16:31]
  v_exp_f32 v70, v70
  v_exp_f32 v71, v71
  v_cvt_pk_bf16_f32 v122, v68, v69
  v_exp_f32 v72, v72
  v_exp_f32 v73, v73
  v_cvt_pk_bf16_f32 v123, v70, v71
  v_exp_f32 v74, v74
  v_exp_f32 v75, v75
  v_mfma_f32_32x32x16_bf16 v[96:111], v[136:139], v[120:123], v[96:111]
  v_cvt_pk_bf16_f32 v124, v72, v73
  v_exp_f32 v76, v76
  v_exp_f32 v77, v77
  v_cvt_pk_bf16_f32 v125, v74, v75
  v_exp_f32 v78, v78
  v_exp_f32 v79, v79
  v_cvt_pk_bf16_f32 v126, v76, v77
  v_cvt_pk_bf16_f32 v127, v78, v79
  v_exp_f32 v48, v48
  v_exp_f32 v49, v49
  v_mfma_f32_32x32x16_bf16 v[96:111], v[140:143], v[124:127], v[96:111]
  v_exp_f32 v50, v50
  v_exp_f32 v51, v51
  v_cvt_pk_bf16_f32 v112, v48, v49
  v_exp_f32 v52, v52
  v_exp_f32 v53, v53
  v_cvt_pk_bf16_f32 v113, v50, v51
  s_waitcnt vmcnt(0)
  s_barrier
  v_mfma_f32_32x32x16_bf16 v[64:79], v[132:135], v[12:15], v[32:47]
  ds_read_b128 v[128:131], v5 offset:49536
  ds_read_b128 v[136:139], v160 offset:50560
  ds_read_b128 v[140:143], v161 offset:51072
  v_exp_f32 v54, v54
  v_exp_f32 v55, v55
  v_cvt_pk_bf16_f32 v114, v52, v53
  v_exp_f32 v56, v56
  v_exp_f32 v57, v57
  v_cvt_pk_bf16_f32 v115, v54, v55
  v_exp_f32 v58, v58
  v_exp_f32 v59, v59
  v_mfma_f32_32x32x16_bf16 v[80:95], v[144:147], v[112:115], v[80:95]
  v_cvt_pk_bf16_f32 v116, v56, v57
  v_exp_f32 v60, v60
  v_exp_f32 v61, v61
  v_cvt_pk_bf16_f32 v117, v58, v59
  v_exp_f32 v62, v62
  v_exp_f32 v63, v63
  v_cvt_pk_bf16_f32 v118, v60, v61
  v_cvt_pk_bf16_f32 v119, v62, v63
  v_exp_f32 v64, v64
  v_exp_f32 v65, v65
  v_mfma_f32_32x32x16_bf16 v[80:95], v[148:151], v[116:119], v[80:95]
  v_exp_f32 v66, v66
  v_exp_f32 v67, v67
  v_cvt_pk_bf16_f32 v120, v64, v65
  v_exp_f32 v68, v68
  v_exp_f32 v69, v69
  v_cvt_pk_bf16_f32 v121, v66, v67
  s_waitcnt lgkmcnt(0)
  v_mfma_f32_32x32x16_bf16 v[48:63], v[128:131], v[8:11], v[16:31]
  v_exp_f32 v70, v70
  v_exp_f32 v71, v71
  v_cvt_pk_bf16_f32 v122, v68, v69
  v_exp_f32 v72, v72
  v_exp_f32 v73, v73
  v_cvt_pk_bf16_f32 v123, v70, v71
  v_exp_f32 v74, v74
  v_exp_f32 v75, v75
  v_mfma_f32_32x32x16_bf16 v[96:111], v[144:147], v[120:123], v[96:111]
  v_cvt_pk_bf16_f32 v124, v72, v73
  v_exp_f32 v76, v76
  v_exp_f32 v77, v77
  v_cvt_pk_bf16_f32 v125, v74, v75
  v_exp_f32 v78, v78
  v_exp_f32 v79, v79
  v_cvt_pk_bf16_f32 v126, v76, v77
  v_cvt_pk_bf16_f32 v127, v78, v79
  v_exp_f32 v48, v48
  v_exp_f32 v49, v49
  v_mfma_f32_32x32x16_bf16 v[96:111], v[148:151], v[124:127], v[96:111]
  v_exp_f32 v50, v50
  v_exp_f32 v51, v51
  v_cvt_pk_bf16_f32 v112, v48, v49
  v_exp_f32 v52, v52
  v_exp_f32 v53, v53
  v_cvt_pk_bf16_f32 v113, v50, v51
  v_mfma_f32_32x32x16_bf16 v[64:79], v[128:131], v[12:15], v[32:47]
  ds_read_b128 v[132:135], v5 offset:51584
  ds_read_b128 v[144:147], v162 offset:52608
  ds_read_b128 v[148:151], v163 offset:53120
  v_exp_f32 v54, v54
  v_exp_f32 v55, v55
  v_cvt_pk_bf16_f32 v114, v52, v53
  v_exp_f32 v56, v56
  v_exp_f32 v57, v57
  v_cvt_pk_bf16_f32 v115, v54, v55
  v_exp_f32 v58, v58
  v_exp_f32 v59, v59
  v_mfma_f32_32x32x16_bf16 v[80:95], v[136:139], v[112:115], v[80:95]
  v_cvt_pk_bf16_f32 v116, v56, v57
  v_exp_f32 v60, v60
  v_exp_f32 v61, v61
  v_cvt_pk_bf16_f32 v117, v58, v59
  v_exp_f32 v62, v62
  v_exp_f32 v63, v63
  v_cvt_pk_bf16_f32 v118, v60, v61
  v_cvt_pk_bf16_f32 v119, v62, v63
  v_exp_f32 v64, v64
  v_exp_f32 v65, v65
  v_mfma_f32_32x32x16_bf16 v[80:95], v[140:143], v[116:119], v[80:95]
  v_exp_f32 v66, v66
  v_exp_f32 v67, v67
  v_cvt_pk_bf16_f32 v120, v64, v65
  v_exp_f32 v68, v68
  v_exp_f32 v69, v69
  v_cvt_pk_bf16_f32 v121, v66, v67
  s_waitcnt lgkmcnt(0)
  v_mfma_f32_32x32x16_bf16 v[48:63], v[132:135], v[8:11], v[16:31]
  v_exp_f32 v70, v70
  v_exp_f32 v71, v71
  v_cvt_pk_bf16_f32 v122, v68, v69
  v_exp_f32 v72, v72
  v_exp_f32 v73, v73
  v_cvt_pk_bf16_f32 v123, v70, v71
  v_exp_f32 v74, v74
  v_exp_f32 v75, v75
  v_mfma_f32_32x32x16_bf16 v[96:111], v[136:139], v[120:123], v[96:111]
  v_cvt_pk_bf16_f32 v124, v72, v73
  v_exp_f32 v76, v76
  v_exp_f32 v77, v77
  v_cvt_pk_bf16_f32 v125, v74, v75
  v_exp_f32 v78, v78
  v_exp_f32 v79, v79
  v_cvt_pk_bf16_f32 v126, v76, v77
  v_cvt_pk_bf16_f32 v127, v78, v79
  v_exp_f32 v48, v48
  v_exp_f32 v49, v49
  v_mfma_f32_32x32x16_bf16 v[96:111], v[140:143], v[124:127], v[96:111]
  v_exp_f32 v50, v50
  v_exp_f32 v51, v51
  v_cvt_pk_bf16_f32 v112, v48, v49
  v_exp_f32 v52, v52
  v_exp_f32 v53, v53
  v_cvt_pk_bf16_f32 v113, v50, v51
  v_mfma_f32_32x32x16_bf16 v[64:79], v[132:135], v[12:15], v[32:47]
  ds_read_b128 v[128:131], v5 offset:53664
  ds_read_b128 v[136:139], v160 offset:54688
  ds_read_b128 v[140:143], v161 offset:55200
  v_exp_f32 v54, v54
  v_exp_f32 v55, v55
  v_cvt_pk_bf16_f32 v114, v52, v53
  v_exp_f32 v56, v56
  v_exp_f32 v57, v57
  v_cvt_pk_bf16_f32 v115, v54, v55
  v_exp_f32 v58, v58
  v_exp_f32 v59, v59
  v_mfma_f32_32x32x16_bf16 v[80:95], v[144:147], v[112:115], v[80:95]
  v_cvt_pk_bf16_f32 v116, v56, v57
  v_exp_f32 v60, v60
  v_exp_f32 v61, v61
  v_cvt_pk_bf16_f32 v117, v58, v59
  v_exp_f32 v62, v62
  v_exp_f32 v63, v63
  v_cvt_pk_bf16_f32 v118, v60, v61
  v_cvt_pk_bf16_f32 v119, v62, v63
  v_exp_f32 v64, v64
  v_exp_f32 v65, v65
  v_mfma_f32_32x32x16_bf16 v[80:95], v[148:151], v[116:119], v[80:95]
  v_exp_f32 v66, v66
  v_exp_f32 v67, v67
  v_cvt_pk_bf16_f32 v120, v64, v65
  v_exp_f32 v68, v68
  v_exp_f32 v69, v69
  v_cvt_pk_bf16_f32 v121, v66, v67
  s_waitcnt lgkmcnt(0)
  v_mfma_f32_32x32x16_bf16 v[48:63], v[128:131], v[8:11], v[16:31]
  v_exp_f32 v70, v70
  v_exp_f32 v71, v71
  v_cvt_pk_bf16_f32 v122, v68, v69
  v_exp_f32 v72, v72
  v_exp_f32 v73, v73
  v_cvt_pk_bf16_f32 v123, v70, v71
  v_exp_f32 v74, v74
  v_exp_f32 v75, v75
  v_mfma_f32_32x32x16_bf16 v[96:111], v[144:147], v[120:123], v[96:111]
  v_cvt_pk_bf16_f32 v124, v72, v73
  v_exp_f32 v76, v76
  v_exp_f32 v77, v77
  v_cvt_pk_bf16_f32 v125, v74, v75
  v_exp_f32 v78, v78
  v_exp_f32 v79, v79
  v_cvt_pk_bf16_f32 v126, v76, v77
  v_cvt_pk_bf16_f32 v127, v78, v79
  v_exp_f32 v48, v48
  v_exp_f32 v49, v49
  v_mfma_f32_32x32x16_bf16 v[96:111], v[148:151], v[124:127], v[96:111]
  v_exp_f32 v50, v50
  v_exp_f32 v51, v51
  v_cvt_pk_bf16_f32 v112, v48, v49
  v_exp_f32 v52, v52
  v_exp_f32 v53, v53
  v_cvt_pk_bf16_f32 v113, v50, v51
  v_mfma_f32_32x32x16_bf16 v[64:79], v[128:131], v[12:15], v[32:47]
  ds_read_b128 v[132:135], v5 offset:55712
  ds_read_b128 v[144:147], v162 offset:56736
  ds_read_b128 v[148:151], v163 offset:57248
  v_exp_f32 v54, v54
  v_exp_f32 v55, v55
  v_cvt_pk_bf16_f32 v114, v52, v53
  v_exp_f32 v56, v56
  v_exp_f32 v57, v57
  v_cvt_pk_bf16_f32 v115, v54, v55
  v_exp_f32 v58, v58
  v_exp_f32 v59, v59
  v_mfma_f32_32x32x16_bf16 v[80:95], v[136:139], v[112:115], v[80:95]
  v_cvt_pk_bf16_f32 v116, v56, v57
  v_exp_f32 v60, v60
  v_exp_f32 v61, v61
  v_cvt_pk_bf16_f32 v117, v58, v59
  v_exp_f32 v62, v62
  v_exp_f32 v63, v63
  v_cvt_pk_bf16_f32 v118, v60, v61
  v_cvt_pk_bf16_f32 v119, v62, v63
  v_exp_f32 v64, v64
  v_exp_f32 v65, v65
  v_mfma_f32_32x32x16_bf16 v[80:95], v[140:143], v[116:119], v[80:95]
  v_exp_f32 v66, v66
  v_exp_f32 v67, v67
  v_cvt_pk_bf16_f32 v120, v64, v65
  v_exp_f32 v68, v68
  v_exp_f32 v69, v69
  v_cvt_pk_bf16_f32 v121, v66, v67
  s_waitcnt lgkmcnt(0)
  v_mfma_f32_32x32x16_bf16 v[48:63], v[132:135], v[8:11], v[16:31]
  v_exp_f32 v70, v70
  v_exp_f32 v71, v71
  v_cvt_pk_bf16_f32 v122, v68, v69
  v_exp_f32 v72, v72
  v_exp_f32 v73, v73
  v_cvt_pk_bf16_f32 v123, v70, v71
  v_exp_f32 v74, v74
  v_exp_f32 v75, v75
  v_mfma_f32_32x32x16_bf16 v[96:111], v[136:139], v[120:123], v[96:111]
  v_cvt_pk_bf16_f32 v124, v72, v73
  v_exp_f32 v76, v76
  v_exp_f32 v77, v77
  v_cvt_pk_bf16_f32 v125, v74, v75
  v_exp_f32 v78, v78
  v_exp_f32 v79, v79
  v_cvt_pk_bf16_f32 v126, v76, v77
  v_cvt_pk_bf16_f32 v127, v78, v79
  v_exp_f32 v48, v48
  v_exp_f32 v49, v49
  v_mfma_f32_32x32x16_bf16 v[96:111], v[140:143], v[124:127], v[96:111]
  v_exp_f32 v50, v50
  v_exp_f32 v51, v51
  v_cvt_pk_bf16_f32 v112, v48, v49
  v_exp_f32 v52, v52
  v_exp_f32 v53, v53
  v_cvt_pk_bf16_f32 v113, v50, v51
  v_mfma_f32_32x32x16_bf16 v[64:79], v[132:135], v[12:15], v[32:47]
  ds_read_b128 v[128:131], v5 offset:57792
  ds_read_b128 v[136:139], v160 offset:58816
  ds_read_b128 v[140:143], v161 offset:59328
  v_exp_f32 v54, v54
  v_exp_f32 v55, v55
  v_cvt_pk_bf16_f32 v114, v52, v53
  v_exp_f32 v56, v56
  v_exp_f32 v57, v57
  v_cvt_pk_bf16_f32 v115, v54, v55
  v_exp_f32 v58, v58
  v_exp_f32 v59, v59
  v_mfma_f32_32x32x16_bf16 v[80:95], v[144:147], v[112:115], v[80:95]
  v_cvt_pk_bf16_f32 v116, v56, v57
  v_exp_f32 v60, v60
  v_exp_f32 v61, v61
  v_cvt_pk_bf16_f32 v117, v58, v59
  v_exp_f32 v62, v62
  v_exp_f32 v63, v63
  v_cvt_pk_bf16_f32 v118, v60, v61
  v_cvt_pk_bf16_f32 v119, v62, v63
  v_exp_f32 v64, v64
  v_exp_f32 v65, v65
  v_mfma_f32_32x32x16_bf16 v[80:95], v[148:151], v[116:119], v[80:95]
  v_exp_f32 v66, v66
  v_exp_f32 v67, v67
  v_cvt_pk_bf16_f32 v120, v64, v65
  v_exp_f32 v68, v68
  v_exp_f32 v69, v69
  v_cvt_pk_bf16_f32 v121, v66, v67
  s_waitcnt lgkmcnt(0)
  v_mfma_f32_32x32x16_bf16 v[48:63], v[128:131], v[8:11], v[16:31]
  v_exp_f32 v70, v70
  v_exp_f32 v71, v71
  v_cvt_pk_bf16_f32 v122, v68, v69
  v_exp_f32 v72, v72
  v_exp_f32 v73, v73
  v_cvt_pk_bf16_f32 v123, v70, v71
  v_exp_f32 v74, v74
  v_exp_f32 v75, v75
  v_mfma_f32_32x32x16_bf16 v[96:111], v[144:147], v[120:123], v[96:111]
  v_cvt_pk_bf16_f32 v124, v72, v73
  v_exp_f32 v76, v76
  v_exp_f32 v77, v77
  v_cvt_pk_bf16_f32 v125, v74, v75
  v_exp_f32 v78, v78
  v_exp_f32 v79, v79
  v_cvt_pk_bf16_f32 v126, v76, v77
  v_cvt_pk_bf16_f32 v127, v78, v79
  v_exp_f32 v48, v48
  v_exp_f32 v49, v49
  v_mfma_f32_32x32x16_bf16 v[96:111], v[148:151], v[124:127], v[96:111]
  v_exp_f32 v50, v50
  v_exp_f32 v51, v51
  v_cvt_pk_bf16_f32 v112, v48, v49
  v_exp_f32 v52, v52
  v_exp_f32 v53, v53
  v_cvt_pk_bf16_f32 v113, v50, v51
  v_mfma_f32_32x32x16_bf16 v[64:79], v[128:131], v[12:15], v[32:47]
  ds_read_b128 v[132:135], v5 offset:59840
  ds_read_b128 v[144:147], v162 offset:60864
  ds_read_b128 v[148:151], v163 offset:61376
  v_exp_f32 v54, v54
  v_exp_f32 v55, v55
  v_cvt_pk_bf16_f32 v114, v52, v53
  v_exp_f32 v56, v56
  v_exp_f32 v57, v57
  v_cvt_pk_bf16_f32 v115, v54, v55
  v_exp_f32 v58, v58
  v_exp_f32 v59, v59
  v_mfma_f32_32x32x16_bf16 v[80:95], v[136:139], v[112:115], v[80:95]
  v_cvt_pk_bf16_f32 v116, v56, v57
  v_exp_f32 v60, v60
  v_exp_f32 v61, v61
  v_cvt_pk_bf16_f32 v117, v58, v59
  v_exp_f32 v62, v62
  v_exp_f32 v63, v63
  v_cvt_pk_bf16_f32 v118, v60, v61
  v_cvt_pk_bf16_f32 v119, v62, v63
  v_exp_f32 v64, v64
  v_exp_f32 v65, v65
  v_mfma_f32_32x32x16_bf16 v[80:95], v[140:143], v[116:119], v[80:95]
  v_exp_f32 v66, v66
  v_exp_f32 v67, v67
  v_cvt_pk_bf16_f32 v120, v64, v65
  v_exp_f32 v68, v68
  v_exp_f32 v69, v69
  v_cvt_pk_bf16_f32 v121, v66, v67
  s_waitcnt lgkmcnt(0)
  v_mfma_f32_32x32x16_bf16 v[48:63], v[132:135], v[8:11], v[16:31]
  v_exp_f32 v70, v70
  v_exp_f32 v71, v71
  v_cvt_pk_bf16_f32 v122, v68, v69
  v_exp_f32 v72, v72
  v_exp_f32 v73, v73
  v_cvt_pk_bf16_f32 v123, v70, v71
  v_exp_f32 v74, v74
  v_exp_f32 v75, v75
  v_mfma_f32_32x32x16_bf16 v[96:111], v[136:139], v[120:123], v[96:111]
  v_cvt_pk_bf16_f32 v124, v72, v73
  v_exp_f32 v76, v76
  v_exp_f32 v77, v77
  v_cvt_pk_bf16_f32 v125, v74, v75
  v_exp_f32 v78, v78
  v_exp_f32 v79, v79
  v_cvt_pk_bf16_f32 v126, v76, v77
  v_cvt_pk_bf16_f32 v127, v78, v79
  v_exp_f32 v48, v48
  v_exp_f32 v49, v49
  v_mfma_f32_32x32x16_bf16 v[96:111], v[140:143], v[124:127], v[96:111]
  v_exp_f32 v50, v50
  v_exp_f32 v51, v51
  v_cvt_pk_bf16_f32 v112, v48, v49
  v_exp_f32 v52, v52
  v_exp_f32 v53, v53
  v_cvt_pk_bf16_f32 v113, v50, v51
  v_mfma_f32_32x32x16_bf16 v[64:79], v[132:135], v[12:15], v[32:47]
  ds_read_b128 v[128:131], v5 offset:61920
  ds_read_b128 v[136:139], v160 offset:62944
  ds_read_b128 v[140:143], v161 offset:63456
  v_exp_f32 v54, v54
  v_exp_f32 v55, v55
  v_cvt_pk_bf16_f32 v114, v52, v53
  v_exp_f32 v56, v56
  v_exp_f32 v57, v57
  v_cvt_pk_bf16_f32 v115, v54, v55
  v_exp_f32 v58, v58
  v_exp_f32 v59, v59
  v_mfma_f32_32x32x16_bf16 v[80:95], v[144:147], v[112:115], v[80:95]
  v_cvt_pk_bf16_f32 v116, v56, v57
  v_exp_f32 v60, v60
  v_exp_f32 v61, v61
  v_cvt_pk_bf16_f32 v117, v58, v59
  v_exp_f32 v62, v62
  v_exp_f32 v63, v63
  v_cvt_pk_bf16_f32 v118, v60, v61
  v_cvt_pk_bf16_f32 v119, v62, v63
  v_exp_f32 v64, v64
  v_exp_f32 v65, v65
  v_mfma_f32_32x32x16_bf16 v[80:95], v[148:151], v[116:119], v[80:95]
  v_exp_f32 v66, v66
  v_exp_f32 v67, v67
  v_cvt_pk_bf16_f32 v120, v64, v65
  v_exp_f32 v68, v68
  v_exp_f32 v69, v69
  v_cvt_pk_bf16_f32 v121, v66, v67
  s_waitcnt lgkmcnt(0)
  v_mfma_f32_32x32x16_bf16 v[48:63], v[128:131], v[8:11], v[16:31]
  v_exp_f32 v70, v70
  v_exp_f32 v71, v71
  v_cvt_pk_bf16_f32 v122, v68, v69
  v_exp_f32 v72, v72
  v_exp_f32 v73, v73
  v_cvt_pk_bf16_f32 v123, v70, v71
  v_exp_f32 v74, v74
  v_exp_f32 v75, v75
  v_mfma_f32_32x32x16_bf16 v[96:111], v[144:147], v[120:123], v[96:111]
  v_cvt_pk_bf16_f32 v124, v72, v73
  v_exp_f32 v76, v76
  v_exp_f32 v77, v77
  v_cvt_pk_bf16_f32 v125, v74, v75
  v_exp_f32 v78, v78
  v_exp_f32 v79, v79
  v_cvt_pk_bf16_f32 v126, v76, v77
  v_cvt_pk_bf16_f32 v127, v78, v79
  v_exp_f32 v48, v48
  v_exp_f32 v49, v49
  v_mfma_f32_32x32x16_bf16 v[96:111], v[148:151], v[124:127], v[96:111]
  v_exp_f32 v50, v50
  v_exp_f32 v51, v51
  v_cvt_pk_bf16_f32 v112, v48, v49
  v_exp_f32 v52, v52
  v_exp_f32 v53, v53
  v_cvt_pk_bf16_f32 v113, v50, v51
  v_mfma_f32_32x32x16_bf16 v[64:79], v[128:131], v[12:15], v[32:47]
  ds_read_b128 v[132:135], v5 offset:63968
  ds_read_b128 v[144:147], v162 offset:64992
  ds_read_b128 v[148:151], v163 offset:65504
  v_exp_f32 v54, v54
  v_exp_f32 v55, v55
  v_cvt_pk_bf16_f32 v114, v52, v53
  v_exp_f32 v56, v56
  v_exp_f32 v57, v57
  v_cvt_pk_bf16_f32 v115, v54, v55
  v_exp_f32 v58, v58
  v_exp_f32 v59, v59
  v_mfma_f32_32x32x16_bf16 v[80:95], v[136:139], v[112:115], v[80:95]
  v_cvt_pk_bf16_f32 v116, v56, v57
  v_exp_f32 v60, v60
  v_exp_f32 v61, v61
  v_cvt_pk_bf16_f32 v117, v58, v59
  v_exp_f32 v62, v62
  v_exp_f32 v63, v63
  v_cvt_pk_bf16_f32 v118, v60, v61
  v_cvt_pk_bf16_f32 v119, v62, v63
  v_exp_f32 v64, v64
  v_exp_f32 v65, v65
  v_mfma_f32_32x32x16_bf16 v[80:95], v[140:143], v[116:119], v[80:95]
  v_exp_f32 v66, v66
  v_exp_f32 v67, v67
  v_cvt_pk_bf16_f32 v120, v64, v65
  v_exp_f32 v68, v68
  v_exp_f32 v69, v69
  v_cvt_pk_bf16_f32 v121, v66, v67
  s_waitcnt lgkmcnt(0)
  v_mfma_f32_32x32x16_bf16 v[48:63], v[132:135], v[8:11], v[16:31]
  v_exp_f32 v70, v70
  v_exp_f32 v71, v71
  v_cvt_pk_bf16_f32 v122, v68, v69
  v_exp_f32 v72, v72
  v_exp_f32 v73, v73
  v_cvt_pk_bf16_f32 v123, v70, v71
  v_exp_f32 v74, v74
  v_exp_f32 v75, v75
  v_mfma_f32_32x32x16_bf16 v[96:111], v[136:139], v[120:123], v[96:111]
  v_cvt_pk_bf16_f32 v124, v72, v73
  v_exp_f32 v76, v76
  v_exp_f32 v77, v77
  v_cvt_pk_bf16_f32 v125, v74, v75
  v_exp_f32 v78, v78
  v_exp_f32 v79, v79
  v_cvt_pk_bf16_f32 v126, v76, v77
  v_cvt_pk_bf16_f32 v127, v78, v79
  v_exp_f32 v48, v48
  v_exp_f32 v49, v49
  v_mfma_f32_32x32x16_bf16 v[96:111], v[140:143], v[124:127], v[96:111]
  v_exp_f32 v50, v50
  v_exp_f32 v51, v51
  v_cvt_pk_bf16_f32 v112, v48, v49
  v_exp_f32 v52, v52
  v_exp_f32 v53, v53
  v_cvt_pk_bf16_f32 v113, v50, v51
  v_mfma_f32_32x32x16_bf16 v[64:79], v[132:135], v[12:15], v[32:47]
  v_exp_f32 v54, v54
  v_exp_f32 v55, v55
  v_cvt_pk_bf16_f32 v114, v52, v53
  v_exp_f32 v56, v56
  v_exp_f32 v57, v57
  v_cvt_pk_bf16_f32 v115, v54, v55
  v_exp_f32 v58, v58
  v_exp_f32 v59, v59
  v_mfma_f32_32x32x16_bf16 v[80:95], v[144:147], v[112:115], v[80:95]
  v_cvt_pk_bf16_f32 v116, v56, v57
  v_exp_f32 v60, v60
  v_exp_f32 v61, v61
  v_cvt_pk_bf16_f32 v117, v58, v59
  v_exp_f32 v62, v62
  v_exp_f32 v63, v63
  v_cvt_pk_bf16_f32 v118, v60, v61
  v_cvt_pk_bf16_f32 v119, v62, v63
  v_exp_f32 v64, v64
  v_exp_f32 v65, v65
  v_mfma_f32_32x32x16_bf16 v[80:95], v[148:151], v[116:119], v[80:95]
  v_exp_f32 v66, v66
  v_exp_f32 v67, v67
  v_cvt_pk_bf16_f32 v120, v64, v65
  v_exp_f32 v68, v68
  v_exp_f32 v69, v69
  v_cvt_pk_bf16_f32 v121, v66, v67
  v_exp_f32 v70, v70
  v_exp_f32 v71, v71
  v_cvt_pk_bf16_f32 v122, v68, v69
  v_exp_f32 v72, v72
  v_exp_f32 v73, v73
  v_cvt_pk_bf16_f32 v123, v70, v71
  v_exp_f32 v74, v74
  v_exp_f32 v75, v75
  v_mfma_f32_32x32x16_bf16 v[96:111], v[144:147], v[120:123], v[96:111]
  v_cvt_pk_bf16_f32 v124, v72, v73
  v_exp_f32 v76, v76
  v_exp_f32 v77, v77
  v_cvt_pk_bf16_f32 v125, v74, v75
  v_exp_f32 v78, v78
  v_exp_f32 v79, v79
  v_cvt_pk_bf16_f32 v126, v76, v77
  v_cvt_pk_bf16_f32 v127, v78, v79
  s_nop 1
  v_mfma_f32_32x32x16_bf16 v[96:111], v[148:151], v[124:127], v[96:111]
  s_setprio 3
  s_nop 7
  s_nop 7
  v_mov_b32 v157, 0x2b800000
  v_cmp_nge_f32 vcc, v88, v157
  s_nop 3
  s_cmp_eq_u64 vcc, 0
  s_cbranch_scc1 k2_mix_kernel_A_ok0
  s_lshl_b32 s72, s64, 11
  s_add_u32 s72, s72, 2097152
  v_mov_b32 v157, 0xff61b1e6
  s_mov_b32 s73, 0
k2_mix_kernel_A_mx0:
  s_add_u32 s68, s72, s73
  buffer_load_dwordx4 v[128:131], v5, s[48:51], s68 offen
  s_waitcnt vmcnt(0)
  v_mfma_f32_32x32x16_bf16 v[48:63], v[128:131], v[8:11], 0
  s_nop 11
  v_max3_f32 v157, v157, v48, v49
  v_max3_f32 v157, v157, v50, v51
  v_max3_f32 v157, v157, v52, v53
  v_max3_f32 v157, v157, v54, v55
  v_max3_f32 v157, v157, v56, v57
  v_max3_f32 v157, v157, v58, v59
  v_max3_f32 v157, v157, v60, v61
  v_max3_f32 v157, v157, v62, v63
  s_add_u32 s73, s73, 2048
  s_cmp_lt_u32 s73, 131072
  s_cbranch_scc1 k2_mix_kernel_A_mx0
  v_mov_b32 v158, v157
  s_nop 1
  v_permlane32_swap_b32 v157, v158
  v_max_f32 v157, v157, v158
  v_sub_f32 v157, 0, v157
  v_mov_b32 v16, v157
  v_mov_b32 v17, v157
  v_mov_b32 v18, v157
  v_mov_b32 v19, v157
  v_mov_b32 v20, v157
  v_mov_b32 v21, v157
  v_mov_b32 v22, v157
  v_mov_b32 v23, v157
  v_mov_b32 v24, v157
  v_mov_b32 v25, v157
  v_mov_b32 v26, v157
  v_mov_b32 v27, v157
  v_mov_b32 v28, v157
  v_mov_b32 v29, v157
  v_mov_b32 v30, v157
  v_mov_b32 v31, v157
  v_mov_b32 v80, 0
  v_mov_b32 v81, 0
  v_mov_b32 v82, 0
  v_mov_b32 v83, 0
  v_mov_b32 v84, 0
  v_mov_b32 v85, 0
  v_mov_b32 v86, 0
  v_mov_b32 v87, 0
  v_mov_b32 v88, 0
  v_mov_b32 v89, 0
  v_mov_b32 v90, 0
  v_mov_b32 v91, 0
  v_mov_b32 v92, 0
  v_mov_b32 v93, 0
  v_mov_b32 v94, 0
  v_mov_b32 v95, 0
  s_mov_b32 s73, 0
k2_mix_kernel_A_sl0:
  s_add_u32 s68, s72, s73
  buffer_load_dwordx4 v[128:131], v5, s[48:51], s68 offen
  s_mov_b64 exec, s[70:71]
  buffer_load_dwordx4 v[136:139], v6, s[48:51], s68 offen offset:1024
  buffer_load_dwordx4 v[140:143], v6, s[48:51], s68 offen offset:1536
  s_mov_b64 exec, -1
  s_waitcnt vmcnt(0)
  v_mfma_f32_32x32x16_bf16 v[48:63], v[128:131], v[8:11], v[16:31]
  s_nop 11
  v_exp_f32 v48, v48
  v_exp_f32 v49, v49
  v_exp_f32 v50, v50
  v_exp_f32 v51, v51
  v_exp_f32 v52, v52
  v_exp_f32 v53, v53
  v_exp_f32 v54, v54
  v_exp_f32 v55, v55
  v_exp_f32 v56, v56
  v_exp_f32 v57, v57
  v_exp_f32 v58, v58
  v_exp_f32 v59, v59
  v_exp_f32 v60, v60
  v_exp_f32 v61, v61
  v_exp_f32 v62, v62
  v_exp_f32 v63, v63
  v_cvt_pk_bf16_f32 v112, v48, v49
  v_cvt_pk_bf16_f32 v113, v50, v51
  v_cvt_pk_bf16_f32 v114, v52, v53
  v_cvt_pk_bf16_f32 v115, v54, v55
  v_cvt_pk_bf16_f32 v116, v56, v57
  v_cvt_pk_bf16_f32 v117, v58, v59
  v_cvt_pk_bf16_f32 v118, v60, v61
  v_cvt_pk_bf16_f32 v119, v62, v63
  v_mfma_f32_32x32x16_bf16 v[80:95], v[136:139], v[112:115], v[80:95]
  s_nop 0
  v_mfma_f32_32x32x16_bf16 v[80:95], v[140:143], v[116:119], v[80:95]
  s_add_u32 s73, s73, 2048
  s_cmp_lt_u32 s73, 131072
  s_nop 7
  s_cbranch_scc1 k2_mix_kernel_A_sl0
  s_nop 7
  s_nop 7
k2_mix_kernel_A_ok0:
  v_mov_b32 v157, 0x2b800000
  v_cmp_nge_f32 vcc, v104, v157
  s_nop 3
  s_cmp_eq_u64 vcc, 0
  s_cbranch_scc1 k2_mix_kernel_A_ok1
  s_lshl_b32 s72, s64, 11
  s_add_u32 s72, s72, 2097152
  v_mov_b32 v157, 0xff61b1e6
  s_mov_b32 s73, 0
k2_mix_kernel_A_mx1:
  s_add_u32 s68, s72, s73
  buffer_load_dwordx4 v[128:131], v5, s[48:51], s68 offen
  s_waitcnt vmcnt(0)
  v_mfma_f32_32x32x16_bf16 v[48:63], v[128:131], v[12:15], 0
  s_nop 11
  v_max3_f32 v157, v157, v48, v49
  v_max3_f32 v157, v157, v50, v51
  v_max3_f32 v157, v157, v52, v53
  v_max3_f32 v157, v157, v54, v55
  v_max3_f32 v157, v157, v56, v57
  v_max3_f32 v157, v157, v58, v59
  v_max3_f32 v157, v157, v60, v61
  v_max3_f32 v157, v157, v62, v63
  s_add_u32 s73, s73, 2048
  s_cmp_lt_u32 s73, 131072
  s_cbranch_scc1 k2_mix_kernel_A_mx1
  v_mov_b32 v158, v157
  s_nop 1
  v_permlane32_swap_b32 v157, v158
  v_max_f32 v157, v157, v158
  v_sub_f32 v157, 0, v157
  v_mov_b32 v32, v157
  v_mov_b32 v33, v157
  v_mov_b32 v34, v157
  v_mov_b32 v35, v157
  v_mov_b32 v36, v157
  v_mov_b32 v37, v157
  v_mov_b32 v38, v157
  v_mov_b32 v39, v157
  v_mov_b32 v40, v157
  v_mov_b32 v41, v157
  v_mov_b32 v42, v157
  v_mov_b32 v43, v157
  v_mov_b32 v44, v157
  v_mov_b32 v45, v157
  v_mov_b32 v46, v157
  v_mov_b32 v47, v157
  v_mov_b32 v96, 0
  v_mov_b32 v97, 0
  v_mov_b32 v98, 0
  v_mov_b32 v99, 0
  v_mov_b32 v100, 0
  v_mov_b32 v101, 0
  v_mov_b32 v102, 0
  v_mov_b32 v103, 0
  v_mov_b32 v104, 0
  v_mov_b32 v105, 0
  v_mov_b32 v106, 0
  v_mov_b32 v107, 0
  v_mov_b32 v108, 0
  v_mov_b32 v109, 0
  v_mov_b32 v110, 0
  v_mov_b32 v111, 0
  s_mov_b32 s73, 0
k2_mix_kernel_A_sl1:
  s_add_u32 s68, s72, s73
  buffer_load_dwordx4 v[128:131], v5, s[48:51], s68 offen
  s_mov_b64 exec, s[70:71]
  buffer_load_dwordx4 v[136:139], v6, s[48:51], s68 offen offset:1024
  buffer_load_dwordx4 v[140:143], v6, s[48:51], s68 offen offset:1536
  s_mov_b64 exec, -1
  s_waitcnt vmcnt(0)
  v_mfma_f32_32x32x16_bf16 v[48:63], v[128:131], v[12:15], v[32:47]
  s_nop 11
  v_exp_f32 v48, v48
  v_exp_f32 v49, v49
  v_exp_f32 v50, v50
  v_exp_f32 v51, v51
  v_exp_f32 v52, v52
  v_exp_f32 v53, v53
  v_exp_f32 v54, v54
  v_exp_f32 v55, v55
  v_exp_f32 v56, v56
  v_exp_f32 v57, v57
  v_exp_f32 v58, v58
  v_exp_f32 v59, v59
  v_exp_f32 v60, v60
  v_exp_f32 v61, v61
  v_exp_f32 v62, v62
  v_exp_f32 v63, v63
  v_cvt_pk_bf16_f32 v112, v48, v49
  v_cvt_pk_bf16_f32 v113, v50, v51
  v_cvt_pk_bf16_f32 v114, v52, v53
  v_cvt_pk_bf16_f32 v115, v54, v55
  v_cvt_pk_bf16_f32 v116, v56, v57
  v_cvt_pk_bf16_f32 v117, v58, v59
  v_cvt_pk_bf16_f32 v118, v60, v61
  v_cvt_pk_bf16_f32 v119, v62, v63
  v_mfma_f32_32x32x16_bf16 v[96:111], v[136:139], v[112:115], v[96:111]
  s_nop 0
  v_mfma_f32_32x32x16_bf16 v[96:111], v[140:143], v[116:119], v[96:111]
  s_add_u32 s73, s73, 2048
  s_cmp_lt_u32 s73, 131072
  s_nop 7
  s_cbranch_scc1 k2_mix_kernel_A_sl1
  s_nop 7
  s_nop 7
k2_mix_kernel_A_ok1:
  v_rcp_f32 v157, v88
  s_nop 0
  v_mul_f32 v157, v157, v153
  v_mul_f32 v80, v80, v157
  v_mul_f32 v81, v81, v157
  v_mul_f32 v82, v82, v157
  v_mul_f32 v83, v83, v157
  v_mul_f32 v84, v84, v157
  v_mul_f32 v85, v85, v157
  v_mul_f32 v86, v86, v157
  v_mul_f32 v87, v87, v157
  v_cvt_pk_bf16_f32 v112, v80, v81
  v_cvt_pk_bf16_f32 v113, v82, v83
  v_cvt_pk_bf16_f32 v114, v84, v85
  v_cvt_pk_bf16_f32 v115, v86, v87
  s_lshl_b32 s65, s63, 5
  s_add_u32 s65, s65, s61
  s_lshl_b32 s65, s65, 10
  s_add_u32 s65, s65, 14680064
  buffer_store_dwordx4 v[112:115], v5, s[48:51], s65 offen sc0 sc1
  v_rcp_f32 v157, v104
  s_nop 0
  v_mul_f32 v157, v157, v154
  v_mul_f32 v96, v96, v157
  v_mul_f32 v97, v97, v157
  v_mul_f32 v98, v98, v157
  v_mul_f32 v99, v99, v157
  v_mul_f32 v100, v100, v157
  v_mul_f32 v101, v101, v157
  v_mul_f32 v102, v102, v157
  v_mul_f32 v103, v103, v157
  v_cvt_pk_bf16_f32 v120, v96, v97
  v_cvt_pk_bf16_f32 v121, v98, v99
  v_cvt_pk_bf16_f32 v122, v100, v101
  v_cvt_pk_bf16_f32 v123, v102, v103
  s_add_u32 s65, s65, 0x8000
  buffer_store_dwordx4 v[120:123], v5, s[48:51], s65 offen sc0 sc1
  s_lshl_b32 s59, s62, 7
  s_add_u32 s59, s59, 20989952
  s_waitcnt vmcnt(0)
  s_barrier
  s_cmp_lg_u32 s60, 0
  s_cbranch_scc1 k2_mix_kernel_SA_nosig
  v_mov_b32 v6, 0
  v_mov_b32 v7, 1
  s_mov_b64 exec, 1
  buffer_atomic_add v7, v6, s[48:51], s59 offen sc1
  s_mov_b64 exec, -1
k2_mix_kernel_SA_nosig:
  s_endpgm
k2_mix_kernel_G:
  s_sub_u32 s56, s2, 0x100
  s_waitcnt lgkmcnt(0)
  s_setprio 2
  v_and_b32 v1, 63, v0
  v_lshrrev_b32 v2, 6, v0
  s_nop 0
  v_readfirstlane_b32 s60, v2
  v_and_b32 v3, 31, v1
  v_lshrrev_b32 v4, 5, v1
  v_lshlrev_b32 v5, 4, v1
  s_and_b32 s61, s56, 7
  s_lshl_b32 s61, s61, 1
  s_lshr_b32 s62, s56, 3
  s_and_b32 s63, s62, 1
  s_add_u32 s61, s61, s63
  s_lshr_b32 s59, s56, 4
  s_bitcmp1_b32 s60, 0
  s_cselect_b32 s40, s26, s24
  s_cselect_b32 s41, s27, s25
  s_mov_b32 s42, 1409024
  s_mov_b32 s43, 0x20000
  s_mov_b32 s48, s34
  s_mov_b32 s49, s35
  s_mov_b32 s50, 0x1600000
  s_mov_b32 s51, 0x20000
  s_mov_b32 s44, s16
  s_mov_b32 s45, s17
  s_mov_b32 s46, 0x200000
  s_mov_b32 s47, 0x20000
  s_cmp_lt_u32 s59, 11
  s_cbranch_scc0 k2_mix_kernel_U_up2
  s_mul_i32 s62, s59, 3
  s_lshl_b32 s63, s61, 2
  s_add_u32 s63, s63, s60
  v_lshrrev_b32 v6, 3, v1
  s_lshl_b32 s68, s63, 5
  v_add_u32 v6, s68, v6
  v_lshlrev_b32 v6, 10, v6
  v_and_b32 v7, 7, v1
  v_lshrrev_b32 v11, 4, v1
  v_xor_b32 v7, v7, v11
  v_xor_b32 v12, 4, v7
  v_lshlrev_b32 v7, 4, v7
  v_lshlrev_b32 v12, 4, v12
  v_add_u32 v14, v6, v7
  v_add_u32 v15, v6, v12
  v_add_u32 v15, 0x2000, v15
  s_lshl_b32 s67, s60, 12
  s_add_u32 s67, s67, 49152
  v_add_u32 v6, 0, v1
  v_mul_u32_u24 v7, 43691, v6
  v_lshrrev_b32 v7, 19, v7
  v_mul_u32_u24 v11, 12, v7
  v_sub_u32 v11, v6, v11
  v_mul_u32_u24 v7, 2752, v7
  v_lshlrev_b32 v11, 4, v11
  v_add_u32 v8, v7, v11
  v_add_u32 v6, 64, v1
  v_mul_u32_u24 v7, 43691, v6
  v_lshrrev_b32 v7, 19, v7
  v_mul_u32_u24 v11, 12, v7
  v_sub_u32 v11, v6, v11
  v_mul_u32_u24 v7, 2752, v7
  v_lshlrev_b32 v11, 4, v11
  v_add_u32 v9, v7, v11
  v_add_u32 v6, 128, v1
  v_mul_u32_u24 v7, 43691, v6
  v_lshrrev_b32 v7, 19, v7
  v_mul_u32_u24 v11, 12, v7
  v_sub_u32 v11, v6, v11
  v_mul_u32_u24 v7, 2752, v7
  v_lshlrev_b32 v11, 4, v11
  v_add_u32 v10, v7, v11
  s_lshr_b32 s64, s60, 1
  s_mul_i32 s64, s64, 44032
  s_lshl_b32 s65, s62, 6
  s_add_u32 s64, s64, s65
  s_mul_i32 s65, s60, 3072
  s_add_u32 m0, s65, 0
  s_add_u32 s66, s64, 0
  buffer_load_dwordx4 v8, s[40:43], s66 offen lds
  s_add_u32 m0, s65, 1024
  s_add_u32 s66, s64, 0
  buffer_load_dwordx4 v9, s[40:43], s66 offen lds
  s_add_u32 m0, s65, 2048
  s_add_u32 s66, s64, 0
  buffer_load_dwordx4 v10, s[40:43], s66 offen lds
  s_add_u32 m0, s67, 0
  s_mov_b32 s66, 0
  buffer_load_dwordx4 v14, s[44:47], s66 offen lds
  s_add_u32 m0, s67, 1024
  s_mov_b32 s66, 0
  buffer_load_dwordx4 v15, s[44:47], s66 offen lds
  s_add_u32 m0, s67, 2048
  s_mov_b32 s66, 16384
  buffer_load_dwordx4 v14, s[44:47], s66 offen lds
  s_add_u32 m0, s67, 3072
  s_mov_b32 s66, 16384
  buffer_load_dwordx4 v15, s[44:47], s66 offen lds
  s_add_u32 m0, s65, 12288
  s_add_u32 s66, s64, 88064
  buffer_load_dwordx4 v8, s[40:43], s66 offen lds
  s_add_u32 m0, s65, 13312
  s_add_u32 s66, s64, 88064
  buffer_load_dwordx4 v9, s[40:43], s66 offen lds
  s_add_u32 m0, s65, 14336
  s_add_u32 s66, s64, 88064
  buffer_load_dwordx4 v10, s[40:43], s66 offen lds
  s_add_u32 m0, s65, 24576
  s_add_u32 s66, s64, 176128
  buffer_load_dwordx4 v8, s[40:43], s66 offen lds
  s_add_u32 m0, s65, 25600
  s_add_u32 s66, s64, 176128
  buffer_load_dwordx4 v9, s[40:43], s66 offen lds
  s_add_u32 m0, s65, 26624
  s_add_u32 s66, s64, 176128
  buffer_load_dwordx4 v10, s[40:43], s66 offen lds
  s_add_u32 m0, s67, 16384
  s_mov_b32 s66, 128
  buffer_load_dwordx4 v14, s[44:47], s66 offen lds
  s_add_u32 m0, s67, 17408
  s_mov_b32 s66, 128
  buffer_load_dwordx4 v15, s[44:47], s66 offen lds
  s_add_u32 m0, s67, 18432
  s_mov_b32 s66, 16512
  buffer_load_dwordx4 v14, s[44:47], s66 offen lds
  s_add_u32 m0, s67, 19456
  s_mov_b32 s66, 16512
  buffer_load_dwordx4 v15, s[44:47], s66 offen lds
  s_add_u32 m0, s65, 36864
  s_add_u32 s66, s64, 264192
  buffer_load_dwordx4 v8, s[40:43], s66 offen lds
  s_add_u32 m0, s65, 37888
  s_add_u32 s66, s64, 264192
  buffer_load_dwordx4 v9, s[40:43], s66 offen lds
  s_add_u32 m0, s65, 38912
  s_add_u32 s66, s64, 264192
  buffer_load_dwordx4 v10, s[40:43], s66 offen lds
  v_lshrrev_b32 v6, 4, v1
  v_lshrrev_b32 v7, 1, v6
  v_lshlrev_b32 v7, 3, v7
  v_and_b32 v11, 15, v1
  v_lshrrev_b32 v12, 2, v11
  v_add_u32 v7, v7, v12
  v_mul_u32_u24 v7, 192, v7
  v_and_b32 v12, 1, v6
  v_lshlrev_b32 v12, 5, v12
  v_add_u32 v7, v7, v12
  v_and_b32 v12, 3, v11
  v_lshlrev_b32 v12, 3, v12
  v_add_u32 v7, v7, v12
  v_lshrrev_b32 v11, 1, v3
  v_and_b32 v11, 7, v11
  v_lshlrev_b32 v12, 7, v3
  v_add_u32 v12, s67, v12
  v_add_u32 v6, 0, v4
  v_xor_b32 v6, v6, v11
  v_lshlrev_b32 v6, 4, v6
  v_add_u32 v168, v12, v6
  v_add_u32 v6, 2, v4
  v_xor_b32 v6, v6, v11
  v_lshlrev_b32 v6, 4, v6
  v_add_u32 v169, v12, v6
  v_add_u32 v6, 4, v4
  v_xor_b32 v6, v6, v11
  v_lshlrev_b32 v6, 4, v6
  v_add_u32 v170, v12, v6
  v_add_u32 v6, 6, v4
  v_xor_b32 v6, v6, v11
  v_lshlrev_b32 v6, 4, v6
  v_add_u32 v171, v12, v6
  s_setprio 1
  s_waitcnt vmcnt(13) lgkmcnt(0)
  s_barrier
  ds_read_b128 v[112:115], v168 offset:0
  ds_read_b64_tr_b16 v[116:117], v7 offset:0
  ds_read_b64_tr_b16 v[118:119], v7 offset:768
  ds_read_b64_tr_b16 v[120:121], v7 offset:64
  ds_read_b64_tr_b16 v[122:123], v7 offset:832
  ds_read_b64_tr_b16 v[124:125], v7 offset:128
  ds_read_b64_tr_b16 v[126:127], v7 offset:896
  ds_read_b64_tr_b16 v[128:129], v7 offset:3072
  ds_read_b64_tr_b16 v[130:131], v7 offset:3840
  ds_read_b64_tr_b16 v[132:133], v7 offset:3136
  ds_read_b64_tr_b16 v[134:135], v7 offset:3904
  ds_read_b64_tr_b16 v[136:137], v7 offset:3200
  ds_read_b64_tr_b16 v[138:139], v7 offset:3968
  s_waitcnt lgkmcnt(0)
  ds_read_b128 v[140:143], v169 offset:0
  ds_read_b64_tr_b16 v[144:145], v7 offset:6144
  ds_read_b64_tr_b16 v[146:147], v7 offset:6912
  ds_read_b64_tr_b16 v[148:149], v7 offset:6208
  ds_read_b64_tr_b16 v[150:151], v7 offset:6976
  ds_read_b64_tr_b16 v[152:153], v7 offset:6272
  ds_read_b64_tr_b16 v[154:155], v7 offset:7040
  ds_read_b64_tr_b16 v[156:157], v7 offset:9216
  ds_read_b64_tr_b16 v[158:159], v7 offset:9984
  ds_read_b64_tr_b16 v[160:161], v7 offset:9280
  ds_read_b64_tr_b16 v[162:163], v7 offset:10048
  ds_read_b64_tr_b16 v[164:165], v7 offset:9344
  ds_read_b64_tr_b16 v[166:167], v7 offset:10112
  v_mfma_f32_32x32x16_bf16 v[16:31], v[116:119], v[112:115], 0
  v_mfma_f32_32x32x16_bf16 v[32:47], v[120:123], v[112:115], 0
  v_mfma_f32_32x32x16_bf16 v[48:63], v[124:127], v[112:115], 0
  v_mfma_f32_32x32x16_bf16 v[64:79], v[128:131], v[112:115], 0
  v_mfma_f32_32x32x16_bf16 v[80:95], v[132:135], v[112:115], 0
  v_mfma_f32_32x32x16_bf16 v[96:111], v[136:139], v[112:115], 0
  s_waitcnt vmcnt(10) lgkmcnt(0)
  s_barrier
  ds_read_b128 v[112:115], v170 offset:0
  ds_read_b64_tr_b16 v[116:117], v7 offset:12288
  ds_read_b64_tr_b16 v[118:119], v7 offset:13056
  ds_read_b64_tr_b16 v[120:121], v7 offset:12352
  ds_read_b64_tr_b16 v[122:123], v7 offset:13120
  ds_read_b64_tr_b16 v[124:125], v7 offset:12416
  ds_read_b64_tr_b16 v[126:127], v7 offset:13184
  ds_read_b64_tr_b16 v[128:129], v7 offset:15360
  ds_read_b64_tr_b16 v[130:131], v7 offset:16128
  ds_read_b64_tr_b16 v[132:133], v7 offset:15424
  ds_read_b64_tr_b16 v[134:135], v7 offset:16192
  ds_read_b64_tr_b16 v[136:137], v7 offset:15488
  ds_read_b64_tr_b16 v[138:139], v7 offset:16256
  v_mfma_f32_32x32x16_bf16 v[16:31], v[144:147], v[140:143], v[16:31]
  v_mfma_f32_32x32x16_bf16 v[32:47], v[148:151], v[140:143], v[32:47]
  v_mfma_f32_32x32x16_bf16 v[48:63], v[152:155], v[140:143], v[48:63]
  v_mfma_f32_32x32x16_bf16 v[64:79], v[156:159], v[140:143], v[64:79]
  v_mfma_f32_32x32x16_bf16 v[80:95], v[160:163], v[140:143], v[80:95]
  v_mfma_f32_32x32x16_bf16 v[96:111], v[164:167], v[140:143], v[96:111]
  s_add_u32 m0, s65, 0
  s_add_u32 s66, s64, 352256
  buffer_load_dwordx4 v8, s[40:43], s66 offen lds
  s_add_u32 m0, s65, 1024
  s_add_u32 s66, s64, 352256
  buffer_load_dwordx4 v9, s[40:43], s66 offen lds
  s_add_u32 m0, s65, 2048
  s_add_u32 s66, s64, 352256
  buffer_load_dwordx4 v10, s[40:43], s66 offen lds
  s_waitcnt lgkmcnt(0)
  ds_read_b128 v[140:143], v171 offset:0
  ds_read_b64_tr_b16 v[144:145], v7 offset:18432
  ds_read_b64_tr_b16 v[146:147], v7 offset:19200
  ds_read_b64_tr_b16 v[148:149], v7 offset:18496
  ds_read_b64_tr_b16 v[150:151], v7 offset:19264
  ds_read_b64_tr_b16 v[152:153], v7 offset:18560
  ds_read_b64_tr_b16 v[154:155], v7 offset:19328
  ds_read_b64_tr_b16 v[156:157], v7 offset:21504
  ds_read_b64_tr_b16 v[158:159], v7 offset:22272
  ds_read_b64_tr_b16 v[160:161], v7 offset:21568
  ds_read_b64_tr_b16 v[162:163], v7 offset:22336
  ds_read_b64_tr_b16 v[164:165], v7 offset:21632
  ds_read_b64_tr_b16 v[166:167], v7 offset:22400
  v_mfma_f32_32x32x16_bf16 v[16:31], v[116:119], v[112:115], v[16:31]
  v_mfma_f32_32x32x16_bf16 v[32:47], v[120:123], v[112:115], v[32:47]
  v_mfma_f32_32x32x16_bf16 v[48:63], v[124:127], v[112:115], v[48:63]
  v_mfma_f32_32x32x16_bf16 v[64:79], v[128:131], v[112:115], v[64:79]
  v_mfma_f32_32x32x16_bf16 v[80:95], v[132:135], v[112:115], v[80:95]
  v_mfma_f32_32x32x16_bf16 v[96:111], v[136:139], v[112:115], v[96:111]
  s_waitcnt vmcnt(6) lgkmcnt(0)
  s_barrier
  ds_read_b128 v[112:115], v168 offset:16384
  ds_read_b64_tr_b16 v[116:117], v7 offset:24576
  ds_read_b64_tr_b16 v[118:119], v7 offset:25344
  ds_read_b64_tr_b16 v[120:121], v7 offset:24640
  ds_read_b64_tr_b16 v[122:123], v7 offset:25408
  ds_read_b64_tr_b16 v[124:125], v7 offset:24704
  ds_read_b64_tr_b16 v[126:127], v7 offset:25472
  ds_read_b64_tr_b16 v[128:129], v7 offset:27648
  ds_read_b64_tr_b16 v[130:131], v7 offset:28416
  ds_read_b64_tr_b16 v[132:133], v7 offset:27712
  ds_read_b64_tr_b16 v[134:135], v7 offset:28480
  ds_read_b64_tr_b16 v[136:137], v7 offset:27776
  ds_read_b64_tr_b16 v[138:139], v7 offset:28544
  v_mfma_f32_32x32x16_bf16 v[16:31], v[144:147], v[140:143], v[16:31]
  v_mfma_f32_32x32x16_bf16 v[32:47], v[148:151], v[140:143], v[32:47]
  v_mfma_f32_32x32x16_bf16 v[48:63], v[152:155], v[140:143], v[48:63]
  v_mfma_f32_32x32x16_bf16 v[64:79], v[156:159], v[140:143], v[64:79]
  v_mfma_f32_32x32x16_bf16 v[80:95], v[160:163], v[140:143], v[80:95]
  v_mfma_f32_32x32x16_bf16 v[96:111], v[164:167], v[140:143], v[96:111]
  s_add_u32 m0, s65, 12288
  s_add_u32 s66, s64, 440320
  buffer_load_dwordx4 v8, s[40:43], s66 offen lds
  s_add_u32 m0, s65, 13312
  s_add_u32 s66, s64, 440320
  buffer_load_dwordx4 v9, s[40:43], s66 offen lds
  s_add_u32 m0, s65, 14336
  s_add_u32 s66, s64, 440320
  buffer_load_dwordx4 v10, s[40:43], s66 offen lds
  s_add_u32 m0, s67, 0
  s_mov_b32 s66, 256
  buffer_load_dwordx4 v14, s[44:47], s66 offen lds
  s_add_u32 m0, s67, 1024
  s_mov_b32 s66, 256
  buffer_load_dwordx4 v15, s[44:47], s66 offen lds
  s_add_u32 m0, s67, 2048
  s_mov_b32 s66, 16640
  buffer_load_dwordx4 v14, s[44:47], s66 offen lds
  s_add_u32 m0, s67, 3072
  s_mov_b32 s66, 16640
  buffer_load_dwordx4 v15, s[44:47], s66 offen lds
  s_waitcnt lgkmcnt(0)
  ds_read_b128 v[140:143], v169 offset:16384
  ds_read_b64_tr_b16 v[144:145], v7 offset:30720
  ds_read_b64_tr_b16 v[146:147], v7 offset:31488
  ds_read_b64_tr_b16 v[148:149], v7 offset:30784
  ds_read_b64_tr_b16 v[150:151], v7 offset:31552
  ds_read_b64_tr_b16 v[152:153], v7 offset:30848
  ds_read_b64_tr_b16 v[154:155], v7 offset:31616
  ds_read_b64_tr_b16 v[156:157], v7 offset:33792
  ds_read_b64_tr_b16 v[158:159], v7 offset:34560
  ds_read_b64_tr_b16 v[160:161], v7 offset:33856
  ds_read_b64_tr_b16 v[162:163], v7 offset:34624
  ds_read_b64_tr_b16 v[164:165], v7 offset:33920
  ds_read_b64_tr_b16 v[166:167], v7 offset:34688
  v_mfma_f32_32x32x16_bf16 v[16:31], v[116:119], v[112:115], v[16:31]
  v_mfma_f32_32x32x16_bf16 v[32:47], v[120:123], v[112:115], v[32:47]
  v_mfma_f32_32x32x16_bf16 v[48:63], v[124:127], v[112:115], v[48:63]
  v_mfma_f32_32x32x16_bf16 v[64:79], v[128:131], v[112:115], v[64:79]
  v_mfma_f32_32x32x16_bf16 v[80:95], v[132:135], v[112:115], v[80:95]
  v_mfma_f32_32x32x16_bf16 v[96:111], v[136:139], v[112:115], v[96:111]
  s_waitcnt vmcnt(10) lgkmcnt(0)
  s_barrier
  ds_read_b128 v[112:115], v170 offset:16384
  ds_read_b64_tr_b16 v[116:117], v7 offset:36864
  ds_read_b64_tr_b16 v[118:119], v7 offset:37632
  ds_read_b64_tr_b16 v[120:121], v7 offset:36928
  ds_read_b64_tr_b16 v[122:123], v7 offset:37696
  ds_read_b64_tr_b16 v[124:125], v7 offset:36992
  ds_read_b64_tr_b16 v[126:127], v7 offset:37760
  ds_read_b64_tr_b16 v[128:129], v7 offset:39936
  ds_read_b64_tr_b16 v[130:131], v7 offset:40704
  ds_read_b64_tr_b16 v[132:133], v7 offset:40000
  ds_read_b64_tr_b16 v[134:135], v7 offset:40768
  ds_read_b64_tr_b16 v[136:137], v7 offset:40064
  ds_read_b64_tr_b16 v[138:139], v7 offset:40832
  v_mfma_f32_32x32x16_bf16 v[16:31], v[144:147], v[140:143], v[16:31]
  v_mfma_f32_32x32x16_bf16 v[32:47], v[148:151], v[140:143], v[32:47]
  v_mfma_f32_32x32x16_bf16 v[48:63], v[152:155], v[140:143], v[48:63]
  v_mfma_f32_32x32x16_bf16 v[64:79], v[156:159], v[140:143], v[64:79]
  v_mfma_f32_32x32x16_bf16 v[80:95], v[160:163], v[140:143], v[80:95]
  v_mfma_f32_32x32x16_bf16 v[96:111], v[164:167], v[140:143], v[96:111]
  s_add_u32 m0, s65, 24576
  s_add_u32 s66, s64, 528384
  buffer_load_dwordx4 v8, s[40:43], s66 offen lds
  s_add_u32 m0, s65, 25600
  s_add_u32 s66, s64, 528384
  buffer_load_dwordx4 v9, s[40:43], s66 offen lds
  s_add_u32 m0, s65, 26624
  s_add_u32 s66, s64, 528384
  buffer_load_dwordx4 v10, s[40:43], s66 offen lds
  s_waitcnt lgkmcnt(0)
  ds_read_b128 v[140:143], v171 offset:16384
  ds_read_b64_tr_b16 v[144:145], v7 offset:43008
  ds_read_b64_tr_b16 v[146:147], v7 offset:43776
  ds_read_b64_tr_b16 v[148:149], v7 offset:43072
  ds_read_b64_tr_b16 v[150:151], v7 offset:43840
  ds_read_b64_tr_b16 v[152:153], v7 offset:43136
  ds_read_b64_tr_b16 v[154:155], v7 offset:43904
  ds_read_b64_tr_b16 v[156:157], v7 offset:46080
  ds_read_b64_tr_b16 v[158:159], v7 offset:46848
  ds_read_b64_tr_b16 v[160:161], v7 offset:46144
  ds_read_b64_tr_b16 v[162:163], v7 offset:46912
  ds_read_b64_tr_b16 v[164:165], v7 offset:46208
  ds_read_b64_tr_b16 v[166:167], v7 offset:46976
  v_mfma_f32_32x32x16_bf16 v[16:31], v[116:119], v[112:115], v[16:31]
  v_mfma_f32_32x32x16_bf16 v[32:47], v[120:123], v[112:115], v[32:47]
  v_mfma_f32_32x32x16_bf16 v[48:63], v[124:127], v[112:115], v[48:63]
  v_mfma_f32_32x32x16_bf16 v[64:79], v[128:131], v[112:115], v[64:79]
  v_mfma_f32_32x32x16_bf16 v[80:95], v[132:135], v[112:115], v[80:95]
  v_mfma_f32_32x32x16_bf16 v[96:111], v[136:139], v[112:115], v[96:111]
  s_waitcnt vmcnt(3) lgkmcnt(0)
  s_barrier
  ds_read_b128 v[112:115], v168 offset:0
  ds_read_b64_tr_b16 v[116:117], v7 offset:0
  ds_read_b64_tr_b16 v[118:119], v7 offset:768
  ds_read_b64_tr_b16 v[120:121], v7 offset:64
  ds_read_b64_tr_b16 v[122:123], v7 offset:832
  ds_read_b64_tr_b16 v[124:125], v7 offset:128
  ds_read_b64_tr_b16 v[126:127], v7 offset:896
  ds_read_b64_tr_b16 v[128:129], v7 offset:3072
  ds_read_b64_tr_b16 v[130:131], v7 offset:3840
  ds_read_b64_tr_b16 v[132:133], v7 offset:3136
  ds_read_b64_tr_b16 v[134:135], v7 offset:3904
  ds_read_b64_tr_b16 v[136:137], v7 offset:3200
  ds_read_b64_tr_b16 v[138:139], v7 offset:3968
  v_mfma_f32_32x32x16_bf16 v[16:31], v[144:147], v[140:143], v[16:31]
  v_mfma_f32_32x32x16_bf16 v[32:47], v[148:151], v[140:143], v[32:47]
  v_mfma_f32_32x32x16_bf16 v[48:63], v[152:155], v[140:143], v[48:63]
  v_mfma_f32_32x32x16_bf16 v[64:79], v[156:159], v[140:143], v[64:79]
  v_mfma_f32_32x32x16_bf16 v[80:95], v[160:163], v[140:143], v[80:95]
  v_mfma_f32_32x32x16_bf16 v[96:111], v[164:167], v[140:143], v[96:111]
  s_add_u32 m0, s65, 36864
  s_add_u32 s66, s64, 616448
  buffer_load_dwordx4 v8, s[40:43], s66 offen lds
  s_add_u32 m0, s65, 37888
  s_add_u32 s66, s64, 616448
  buffer_load_dwordx4 v9, s[40:43], s66 offen lds
  s_add_u32 m0, s65, 38912
  s_add_u32 s66, s64, 616448
  buffer_load_dwordx4 v10, s[40:43], s66 offen lds
  s_add_u32 m0, s67, 16384
  s_mov_b32 s66, 384
  buffer_load_dwordx4 v14, s[44:47], s66 offen lds
  s_add_u32 m0, s67, 17408
  s_mov_b32 s66, 384
  buffer_load_dwordx4 v15, s[44:47], s66 offen lds
  s_add_u32 m0, s67, 18432
  s_mov_b32 s66, 16768
  buffer_load_dwordx4 v14, s[44:47], s66 offen lds
  s_add_u32 m0, s67, 19456
  s_mov_b32 s66, 16768
  buffer_load_dwordx4 v15, s[44:47], s66 offen lds
  s_waitcnt lgkmcnt(0)
  ds_read_b128 v[140:143], v169 offset:0
  ds_read_b64_tr_b16 v[144:145], v7 offset:6144
  ds_read_b64_tr_b16 v[146:147], v7 offset:6912
  ds_read_b64_tr_b16 v[148:149], v7 offset:6208
  ds_read_b64_tr_b16 v[150:151], v7 offset:6976
  ds_read_b64_tr_b16 v[152:153], v7 offset:6272
  ds_read_b64_tr_b16 v[154:155], v7 offset:7040
  ds_read_b64_tr_b16 v[156:157], v7 offset:9216
  ds_read_b64_tr_b16 v[158:159], v7 offset:9984
  ds_read_b64_tr_b16 v[160:161], v7 offset:9280
  ds_read_b64_tr_b16 v[162:163], v7 offset:10048
  ds_read_b64_tr_b16 v[164:165], v7 offset:9344
  ds_read_b64_tr_b16 v[166:167], v7 offset:10112
  v_mfma_f32_32x32x16_bf16 v[16:31], v[116:119], v[112:115], v[16:31]
  v_mfma_f32_32x32x16_bf16 v[32:47], v[120:123], v[112:115], v[32:47]
  v_mfma_f32_32x32x16_bf16 v[48:63], v[124:127], v[112:115], v[48:63]
  v_mfma_f32_32x32x16_bf16 v[64:79], v[128:131], v[112:115], v[64:79]
  v_mfma_f32_32x32x16_bf16 v[80:95], v[132:135], v[112:115], v[80:95]
  v_mfma_f32_32x32x16_bf16 v[96:111], v[136:139], v[112:115], v[96:111]
  s_waitcnt vmcnt(10) lgkmcnt(0)
  s_barrier
  ds_read_b128 v[112:115], v170 offset:0
  ds_read_b64_tr_b16 v[116:117], v7 offset:12288
  ds_read_b64_tr_b16 v[118:119], v7 offset:13056
  ds_read_b64_tr_b16 v[120:121], v7 offset:12352
  ds_read_b64_tr_b16 v[122:123], v7 offset:13120
  ds_read_b64_tr_b16 v[124:125], v7 offset:12416
  ds_read_b64_tr_b16 v[126:127], v7 offset:13184
  ds_read_b64_tr_b16 v[128:129], v7 offset:15360
  ds_read_b64_tr_b16 v[130:131], v7 offset:16128
  ds_read_b64_tr_b16 v[132:133], v7 offset:15424
  ds_read_b64_tr_b16 v[134:135], v7 offset:16192
  ds_read_b64_tr_b16 v[136:137], v7 offset:15488
  ds_read_b64_tr_b16 v[138:139], v7 offset:16256
  v_mfma_f32_32x32x16_bf16 v[16:31], v[144:147], v[140:143], v[16:31]
  v_mfma_f32_32x32x16_bf16 v[32:47], v[148:151], v[140:143], v[32:47]
  v_mfma_f32_32x32x16_bf16 v[48:63], v[152:155], v[140:143], v[48:63]
  v_mfma_f32_32x32x16_bf16 v[64:79], v[156:159], v[140:143], v[64:79]
  v_mfma_f32_32x32x16_bf16 v[80:95], v[160:163], v[140:143], v[80:95]
  v_mfma_f32_32x32x16_bf16 v[96:111], v[164:167], v[140:143], v[96:111]
  s_add_u32 m0, s65, 0
  s_add_u32 s66, s64, 704512
  buffer_load_dwordx4 v8, s[40:43], s66 offen lds
  s_add_u32 m0, s65, 1024
  s_add_u32 s66, s64, 704512
  buffer_load_dwordx4 v9, s[40:43], s66 offen lds
  s_add_u32 m0, s65, 2048
  s_add_u32 s66, s64, 704512
  buffer_load_dwordx4 v10, s[40:43], s66 offen lds
  s_waitcnt lgkmcnt(0)
  ds_read_b128 v[140:143], v171 offset:0
  ds_read_b64_tr_b16 v[144:145], v7 offset:18432
  ds_read_b64_tr_b16 v[146:147], v7 offset:19200
  ds_read_b64_tr_b16 v[148:149], v7 offset:18496
  ds_read_b64_tr_b16 v[150:151], v7 offset:19264
  ds_read_b64_tr_b16 v[152:153], v7 offset:18560
  ds_read_b64_tr_b16 v[154:155], v7 offset:19328
  ds_read_b64_tr_b16 v[156:157], v7 offset:21504
  ds_read_b64_tr_b16 v[158:159], v7 offset:22272
  ds_read_b64_tr_b16 v[160:161], v7 offset:21568
  ds_read_b64_tr_b16 v[162:163], v7 offset:22336
  ds_read_b64_tr_b16 v[164:165], v7 offset:21632
  ds_read_b64_tr_b16 v[166:167], v7 offset:22400
  v_mfma_f32_32x32x16_bf16 v[16:31], v[116:119], v[112:115], v[16:31]
  v_mfma_f32_32x32x16_bf16 v[32:47], v[120:123], v[112:115], v[32:47]
  v_mfma_f32_32x32x16_bf16 v[48:63], v[124:127], v[112:115], v[48:63]
  v_mfma_f32_32x32x16_bf16 v[64:79], v[128:131], v[112:115], v[64:79]
  v_mfma_f32_32x32x16_bf16 v[80:95], v[132:135], v[112:115], v[80:95]
  v_mfma_f32_32x32x16_bf16 v[96:111], v[136:139], v[112:115], v[96:111]
  s_waitcnt vmcnt(3) lgkmcnt(0)
  s_barrier
  ds_read_b128 v[112:115], v168 offset:16384
  ds_read_b64_tr_b16 v[116:117], v7 offset:24576
  ds_read_b64_tr_b16 v[118:119], v7 offset:25344
  ds_read_b64_tr_b16 v[120:121], v7 offset:24640
  ds_read_b64_tr_b16 v[122:123], v7 offset:25408
  ds_read_b64_tr_b16 v[124:125], v7 offset:24704
  ds_read_b64_tr_b16 v[126:127], v7 offset:25472
  ds_read_b64_tr_b16 v[128:129], v7 offset:27648
  ds_read_b64_tr_b16 v[130:131], v7 offset:28416
  ds_read_b64_tr_b16 v[132:133], v7 offset:27712
  ds_read_b64_tr_b16 v[134:135], v7 offset:28480
  ds_read_b64_tr_b16 v[136:137], v7 offset:27776
  ds_read_b64_tr_b16 v[138:139], v7 offset:28544
  v_mfma_f32_32x32x16_bf16 v[16:31], v[144:147], v[140:143], v[16:31]
  v_mfma_f32_32x32x16_bf16 v[32:47], v[148:151], v[140:143], v[32:47]
  v_mfma_f32_32x32x16_bf16 v[48:63], v[152:155], v[140:143], v[48:63]
  v_mfma_f32_32x32x16_bf16 v[64:79], v[156:159], v[140:143], v[64:79]
  v_mfma_f32_32x32x16_bf16 v[80:95], v[160:163], v[140:143], v[80:95]
  v_mfma_f32_32x32x16_bf16 v[96:111], v[164:167], v[140:143], v[96:111]
  s_add_u32 m0, s65, 12288
  s_add_u32 s66, s64, 792576
  buffer_load_dwordx4 v8, s[40:43], s66 offen lds
  s_add_u32 m0, s65, 13312
  s_add_u32 s66, s64, 792576
  buffer_load_dwordx4 v9, s[40:43], s66 offen lds
  s_add_u32 m0, s65, 14336
  s_add_u32 s66, s64, 792576
  buffer_load_dwordx4 v10, s[40:43], s66 offen lds
  s_add_u32 m0, s67, 0
  s_mov_b32 s66, 512
  buffer_load_dwordx4 v14, s[44:47], s66 offen lds
  s_add_u32 m0, s67, 1024
  s_mov_b32 s66, 512
  buffer_load_dwordx4 v15, s[44:47], s66 offen lds
  s_add_u32 m0, s67, 2048
  s_mov_b32 s66, 16896
  buffer_load_dwordx4 v14, s[44:47], s66 offen lds
  s_add_u32 m0, s67, 3072
  s_mov_b32 s66, 16896
  buffer_load_dwordx4 v15, s[44:47], s66 offen lds
  s_waitcnt lgkmcnt(0)
  ds_read_b128 v[140:143], v169 offset:16384
  ds_read_b64_tr_b16 v[144:145], v7 offset:30720
  ds_read_b64_tr_b16 v[146:147], v7 offset:31488
  ds_read_b64_tr_b16 v[148:149], v7 offset:30784
  ds_read_b64_tr_b16 v[150:151], v7 offset:31552
  ds_read_b64_tr_b16 v[152:153], v7 offset:30848
  ds_read_b64_tr_b16 v[154:155], v7 offset:31616
  ds_read_b64_tr_b16 v[156:157], v7 offset:33792
  ds_read_b64_tr_b16 v[158:159], v7 offset:34560
  ds_read_b64_tr_b16 v[160:161], v7 offset:33856
  ds_read_b64_tr_b16 v[162:163], v7 offset:34624
  ds_read_b64_tr_b16 v[164:165], v7 offset:33920
  ds_read_b64_tr_b16 v[166:167], v7 offset:34688
  v_mfma_f32_32x32x16_bf16 v[16:31], v[116:119], v[112:115], v[16:31]
  v_mfma_f32_32x32x16_bf16 v[32:47], v[120:123], v[112:115], v[32:47]
  v_mfma_f32_32x32x16_bf16 v[48:63], v[124:127], v[112:115], v[48:63]
  v_mfma_f32_32x32x16_bf16 v[64:79], v[128:131], v[112:115], v[64:79]
  v_mfma_f32_32x32x16_bf16 v[80:95], v[132:135], v[112:115], v[80:95]
  v_mfma_f32_32x32x16_bf16 v[96:111], v[136:139], v[112:115], v[96:111]
  s_waitcnt vmcnt(10) lgkmcnt(0)
  s_barrier
  ds_read_b128 v[112:115], v170 offset:16384
  ds_read_b64_tr_b16 v[116:117], v7 offset:36864
  ds_read_b64_tr_b16 v[118:119], v7 offset:37632
  ds_read_b64_tr_b16 v[120:121], v7 offset:36928
  ds_read_b64_tr_b16 v[122:123], v7 offset:37696
  ds_read_b64_tr_b16 v[124:125], v7 offset:36992
  ds_read_b64_tr_b16 v[126:127], v7 offset:37760
  ds_read_b64_tr_b16 v[128:129], v7 offset:39936
  ds_read_b64_tr_b16 v[130:131], v7 offset:40704
  ds_read_b64_tr_b16 v[132:133], v7 offset:40000
  ds_read_b64_tr_b16 v[134:135], v7 offset:40768
  ds_read_b64_tr_b16 v[136:137], v7 offset:40064
  ds_read_b64_tr_b16 v[138:139], v7 offset:40832
  v_mfma_f32_32x32x16_bf16 v[16:31], v[144:147], v[140:143], v[16:31]
  v_mfma_f32_32x32x16_bf16 v[32:47], v[148:151], v[140:143], v[32:47]
  v_mfma_f32_32x32x16_bf16 v[48:63], v[152:155], v[140:143], v[48:63]
  v_mfma_f32_32x32x16_bf16 v[64:79], v[156:159], v[140:143], v[64:79]
  v_mfma_f32_32x32x16_bf16 v[80:95], v[160:163], v[140:143], v[80:95]
  v_mfma_f32_32x32x16_bf16 v[96:111], v[164:167], v[140:143], v[96:111]
  s_add_u32 m0, s65, 24576
  s_add_u32 s66, s64, 880640
  buffer_load_dwordx4 v8, s[40:43], s66 offen lds
  s_add_u32 m0, s65, 25600
  s_add_u32 s66, s64, 880640
  buffer_load_dwordx4 v9, s[40:43], s66 offen lds
  s_add_u32 m0, s65, 26624
  s_add_u32 s66, s64, 880640
  buffer_load_dwordx4 v10, s[40:43], s66 offen lds
  s_waitcnt lgkmcnt(0)
  ds_read_b128 v[140:143], v171 offset:16384
  ds_read_b64_tr_b16 v[144:145], v7 offset:43008
  ds_read_b64_tr_b16 v[146:147], v7 offset:43776
  ds_read_b64_tr_b16 v[148:149], v7 offset:43072
  ds_read_b64_tr_b16 v[150:151], v7 offset:43840
  ds_read_b64_tr_b16 v[152:153], v7 offset:43136
  ds_read_b64_tr_b16 v[154:155], v7 offset:43904
  ds_read_b64_tr_b16 v[156:157], v7 offset:46080
  ds_read_b64_tr_b16 v[158:159], v7 offset:46848
  ds_read_b64_tr_b16 v[160:161], v7 offset:46144
  ds_read_b64_tr_b16 v[162:163], v7 offset:46912
  ds_read_b64_tr_b16 v[164:165], v7 offset:46208
  ds_read_b64_tr_b16 v[166:167], v7 offset:46976
  v_mfma_f32_32x32x16_bf16 v[16:31], v[116:119], v[112:115], v[16:31]
  v_mfma_f32_32x32x16_bf16 v[32:47], v[120:123], v[112:115], v[32:47]
  v_mfma_f32_32x32x16_bf16 v[48:63], v[124:127], v[112:115], v[48:63]
  v_mfma_f32_32x32x16_bf16 v[64:79], v[128:131], v[112:115], v[64:79]
  v_mfma_f32_32x32x16_bf16 v[80:95], v[132:135], v[112:115], v[80:95]
  v_mfma_f32_32x32x16_bf16 v[96:111], v[136:139], v[112:115], v[96:111]
  s_waitcnt vmcnt(3) lgkmcnt(0)
  s_barrier
  ds_read_b128 v[112:115], v168 offset:0
  ds_read_b64_tr_b16 v[116:117], v7 offset:0
  ds_read_b64_tr_b16 v[118:119], v7 offset:768
  ds_read_b64_tr_b16 v[120:121], v7 offset:64
  ds_read_b64_tr_b16 v[122:123], v7 offset:832
  ds_read_b64_tr_b16 v[124:125], v7 offset:128
  ds_read_b64_tr_b16 v[126:127], v7 offset:896
  ds_read_b64_tr_b16 v[128:129], v7 offset:3072
  ds_read_b64_tr_b16 v[130:131], v7 offset:3840
  ds_read_b64_tr_b16 v[132:133], v7 offset:3136
  ds_read_b64_tr_b16 v[134:135], v7 offset:3904
  ds_read_b64_tr_b16 v[136:137], v7 offset:3200
  ds_read_b64_tr_b16 v[138:139], v7 offset:3968
  v_mfma_f32_32x32x16_bf16 v[16:31], v[144:147], v[140:143], v[16:31]
  v_mfma_f32_32x32x16_bf16 v[32:47], v[148:151], v[140:143], v[32:47]
  v_mfma_f32_32x32x16_bf16 v[48:63], v[152:155], v[140:143], v[48:63]
  v_mfma_f32_32x32x16_bf16 v[64:79], v[156:159], v[140:143], v[64:79]
  v_mfma_f32_32x32x16_bf16 v[80:95], v[160:163], v[140:143], v[80:95]
  v_mfma_f32_32x32x16_bf16 v[96:111], v[164:167], v[140:143], v[96:111]
  s_add_u32 m0, s65, 36864
  s_add_u32 s66, s64, 968704
  buffer_load_dwordx4 v8, s[40:43], s66 offen lds
  s_add_u32 m0, s65, 37888
  s_add_u32 s66, s64, 968704
  buffer_load_dwordx4 v9, s[40:43], s66 offen lds
  s_add_u32 m0, s65, 38912
  s_add_u32 s66, s64, 968704
  buffer_load_dwordx4 v10, s[40:43], s66 offen lds
  s_add_u32 m0, s67, 16384
  s_mov_b32 s66, 640
  buffer_load_dwordx4 v14, s[44:47], s66 offen lds
  s_add_u32 m0, s67, 17408
  s_mov_b32 s66, 640
  buffer_load_dwordx4 v15, s[44:47], s66 offen lds
  s_add_u32 m0, s67, 18432
  s_mov_b32 s66, 17024
  buffer_load_dwordx4 v14, s[44:47], s66 offen lds
  s_add_u32 m0, s67, 19456
  s_mov_b32 s66, 17024
  buffer_load_dwordx4 v15, s[44:47], s66 offen lds
  s_waitcnt lgkmcnt(0)
  ds_read_b128 v[140:143], v169 offset:0
  ds_read_b64_tr_b16 v[144:145], v7 offset:6144
  ds_read_b64_tr_b16 v[146:147], v7 offset:6912
  ds_read_b64_tr_b16 v[148:149], v7 offset:6208
  ds_read_b64_tr_b16 v[150:151], v7 offset:6976
  ds_read_b64_tr_b16 v[152:153], v7 offset:6272
  ds_read_b64_tr_b16 v[154:155], v7 offset:7040
  ds_read_b64_tr_b16 v[156:157], v7 offset:9216
  ds_read_b64_tr_b16 v[158:159], v7 offset:9984
  ds_read_b64_tr_b16 v[160:161], v7 offset:9280
  ds_read_b64_tr_b16 v[162:163], v7 offset:10048
  ds_read_b64_tr_b16 v[164:165], v7 offset:9344
  ds_read_b64_tr_b16 v[166:167], v7 offset:10112
  v_mfma_f32_32x32x16_bf16 v[16:31], v[116:119], v[112:115], v[16:31]
  v_mfma_f32_32x32x16_bf16 v[32:47], v[120:123], v[112:115], v[32:47]
  v_mfma_f32_32x32x16_bf16 v[48:63], v[124:127], v[112:115], v[48:63]
  v_mfma_f32_32x32x16_bf16 v[64:79], v[128:131], v[112:115], v[64:79]
  v_mfma_f32_32x32x16_bf16 v[80:95], v[132:135], v[112:115], v[80:95]
  v_mfma_f32_32x32x16_bf16 v[96:111], v[136:139], v[112:115], v[96:111]
  s_waitcnt vmcnt(10) lgkmcnt(0)
  s_barrier
  ds_read_b128 v[112:115], v170 offset:0
  ds_read_b64_tr_b16 v[116:117], v7 offset:12288
  ds_read_b64_tr_b16 v[118:119], v7 offset:13056
  ds_read_b64_tr_b16 v[120:121], v7 offset:12352
  ds_read_b64_tr_b16 v[122:123], v7 offset:13120
  ds_read_b64_tr_b16 v[124:125], v7 offset:12416
  ds_read_b64_tr_b16 v[126:127], v7 offset:13184
  ds_read_b64_tr_b16 v[128:129], v7 offset:15360
  ds_read_b64_tr_b16 v[130:131], v7 offset:16128
  ds_read_b64_tr_b16 v[132:133], v7 offset:15424
  ds_read_b64_tr_b16 v[134:135], v7 offset:16192
  ds_read_b64_tr_b16 v[136:137], v7 offset:15488
  ds_read_b64_tr_b16 v[138:139], v7 offset:16256
  v_mfma_f32_32x32x16_bf16 v[16:31], v[144:147], v[140:143], v[16:31]
  v_mfma_f32_32x32x16_bf16 v[32:47], v[148:151], v[140:143], v[32:47]
  v_mfma_f32_32x32x16_bf16 v[48:63], v[152:155], v[140:143], v[48:63]
  v_mfma_f32_32x32x16_bf16 v[64:79], v[156:159], v[140:143], v[64:79]
  v_mfma_f32_32x32x16_bf16 v[80:95], v[160:163], v[140:143], v[80:95]
  v_mfma_f32_32x32x16_bf16 v[96:111], v[164:167], v[140:143], v[96:111]
  s_add_u32 m0, s65, 0
  s_add_u32 s66, s64, 1056768
  buffer_load_dwordx4 v8, s[40:43], s66 offen lds
  s_add_u32 m0, s65, 1024
  s_add_u32 s66, s64, 1056768
  buffer_load_dwordx4 v9, s[40:43], s66 offen lds
  s_add_u32 m0, s65, 2048
  s_add_u32 s66, s64, 1056768
  buffer_load_dwordx4 v10, s[40:43], s66 offen lds
  s_waitcnt lgkmcnt(0)
  ds_read_b128 v[140:143], v171 offset:0
  ds_read_b64_tr_b16 v[144:145], v7 offset:18432
  ds_read_b64_tr_b16 v[146:147], v7 offset:19200
  ds_read_b64_tr_b16 v[148:149], v7 offset:18496
  ds_read_b64_tr_b16 v[150:151], v7 offset:19264
  ds_read_b64_tr_b16 v[152:153], v7 offset:18560
  ds_read_b64_tr_b16 v[154:155], v7 offset:19328
  ds_read_b64_tr_b16 v[156:157], v7 offset:21504
  ds_read_b64_tr_b16 v[158:159], v7 offset:22272
  ds_read_b64_tr_b16 v[160:161], v7 offset:21568
  ds_read_b64_tr_b16 v[162:163], v7 offset:22336
  ds_read_b64_tr_b16 v[164:165], v7 offset:21632
  ds_read_b64_tr_b16 v[166:167], v7 offset:22400
  v_mfma_f32_32x32x16_bf16 v[16:31], v[116:119], v[112:115], v[16:31]
  v_mfma_f32_32x32x16_bf16 v[32:47], v[120:123], v[112:115], v[32:47]
  v_mfma_f32_32x32x16_bf16 v[48:63], v[124:127], v[112:115], v[48:63]
  v_mfma_f32_32x32x16_bf16 v[64:79], v[128:131], v[112:115], v[64:79]
  v_mfma_f32_32x32x16_bf16 v[80:95], v[132:135], v[112:115], v[80:95]
  v_mfma_f32_32x32x16_bf16 v[96:111], v[136:139], v[112:115], v[96:111]
  s_waitcnt vmcnt(3) lgkmcnt(0)
  s_barrier
  ds_read_b128 v[112:115], v168 offset:16384
  ds_read_b64_tr_b16 v[116:117], v7 offset:24576
  ds_read_b64_tr_b16 v[118:119], v7 offset:25344
  ds_read_b64_tr_b16 v[120:121], v7 offset:24640
  ds_read_b64_tr_b16 v[122:123], v7 offset:25408
  ds_read_b64_tr_b16 v[124:125], v7 offset:24704
  ds_read_b64_tr_b16 v[126:127], v7 offset:25472
  ds_read_b64_tr_b16 v[128:129], v7 offset:27648
  ds_read_b64_tr_b16 v[130:131], v7 offset:28416
  ds_read_b64_tr_b16 v[132:133], v7 offset:27712
  ds_read_b64_tr_b16 v[134:135], v7 offset:28480
  ds_read_b64_tr_b16 v[136:137], v7 offset:27776
  ds_read_b64_tr_b16 v[138:139], v7 offset:28544
  v_mfma_f32_32x32x16_bf16 v[16:31], v[144:147], v[140:143], v[16:31]
  v_mfma_f32_32x32x16_bf16 v[32:47], v[148:151], v[140:143], v[32:47]
  v_mfma_f32_32x32x16_bf16 v[48:63], v[152:155], v[140:143], v[48:63]
  v_mfma_f32_32x32x16_bf16 v[64:79], v[156:159], v[140:143], v[64:79]
  v_mfma_f32_32x32x16_bf16 v[80:95], v[160:163], v[140:143], v[80:95]
  v_mfma_f32_32x32x16_bf16 v[96:111], v[164:167], v[140:143], v[96:111]
  s_add_u32 m0, s65, 12288
  s_add_u32 s66, s64, 1144832
  buffer_load_dwordx4 v8, s[40:43], s66 offen lds
  s_add_u32 m0, s65, 13312
  s_add_u32 s66, s64, 1144832
  buffer_load_dwordx4 v9, s[40:43], s66 offen lds
  s_add_u32 m0, s65, 14336
  s_add_u32 s66, s64, 1144832
  buffer_load_dwordx4 v10, s[40:43], s66 offen lds
  s_add_u32 m0, s67, 0
  s_mov_b32 s66, 768
  buffer_load_dwordx4 v14, s[44:47], s66 offen lds
  s_add_u32 m0, s67, 1024
  s_mov_b32 s66, 768
  buffer_load_dwordx4 v15, s[44:47], s66 offen lds
  s_add_u32 m0, s67, 2048
  s_mov_b32 s66, 17152
  buffer_load_dwordx4 v14, s[44:47], s66 offen lds
  s_add_u32 m0, s67, 3072
  s_mov_b32 s66, 17152
  buffer_load_dwordx4 v15, s[44:47], s66 offen lds
  s_waitcnt lgkmcnt(0)
  ds_read_b128 v[140:143], v169 offset:16384
  ds_read_b64_tr_b16 v[144:145], v7 offset:30720
  ds_read_b64_tr_b16 v[146:147], v7 offset:31488
  ds_read_b64_tr_b16 v[148:149], v7 offset:30784
  ds_read_b64_tr_b16 v[150:151], v7 offset:31552
  ds_read_b64_tr_b16 v[152:153], v7 offset:30848
  ds_read_b64_tr_b16 v[154:155], v7 offset:31616
  ds_read_b64_tr_b16 v[156:157], v7 offset:33792
  ds_read_b64_tr_b16 v[158:159], v7 offset:34560
  ds_read_b64_tr_b16 v[160:161], v7 offset:33856
  ds_read_b64_tr_b16 v[162:163], v7 offset:34624
  ds_read_b64_tr_b16 v[164:165], v7 offset:33920
  ds_read_b64_tr_b16 v[166:167], v7 offset:34688
  v_mfma_f32_32x32x16_bf16 v[16:31], v[116:119], v[112:115], v[16:31]
  v_mfma_f32_32x32x16_bf16 v[32:47], v[120:123], v[112:115], v[32:47]
  v_mfma_f32_32x32x16_bf16 v[48:63], v[124:127], v[112:115], v[48:63]
  v_mfma_f32_32x32x16_bf16 v[64:79], v[128:131], v[112:115], v[64:79]
  v_mfma_f32_32x32x16_bf16 v[80:95], v[132:135], v[112:115], v[80:95]
  v_mfma_f32_32x32x16_bf16 v[96:111], v[136:139], v[112:115], v[96:111]
  s_waitcnt vmcnt(10) lgkmcnt(0)
  s_barrier
  ds_read_b128 v[112:115], v170 offset:16384
  ds_read_b64_tr_b16 v[116:117], v7 offset:36864
  ds_read_b64_tr_b16 v[118:119], v7 offset:37632
  ds_read_b64_tr_b16 v[120:121], v7 offset:36928
  ds_read_b64_tr_b16 v[122:123], v7 offset:37696
  ds_read_b64_tr_b16 v[124:125], v7 offset:36992
  ds_read_b64_tr_b16 v[126:127], v7 offset:37760
  ds_read_b64_tr_b16 v[128:129], v7 offset:39936
  ds_read_b64_tr_b16 v[130:131], v7 offset:40704
  ds_read_b64_tr_b16 v[132:133], v7 offset:40000
  ds_read_b64_tr_b16 v[134:135], v7 offset:40768
  ds_read_b64_tr_b16 v[136:137], v7 offset:40064
  ds_read_b64_tr_b16 v[138:139], v7 offset:40832
  v_mfma_f32_32x32x16_bf16 v[16:31], v[144:147], v[140:143], v[16:31]
  v_mfma_f32_32x32x16_bf16 v[32:47], v[148:151], v[140:143], v[32:47]
  v_mfma_f32_32x32x16_bf16 v[48:63], v[152:155], v[140:143], v[48:63]
  v_mfma_f32_32x32x16_bf16 v[64:79], v[156:159], v[140:143], v[64:79]
  v_mfma_f32_32x32x16_bf16 v[80:95], v[160:163], v[140:143], v[80:95]
  v_mfma_f32_32x32x16_bf16 v[96:111], v[164:167], v[140:143], v[96:111]
  s_add_u32 m0, s65, 24576
  s_add_u32 s66, s64, 1232896
  buffer_load_dwordx4 v8, s[40:43], s66 offen lds
  s_add_u32 m0, s65, 25600
  s_add_u32 s66, s64, 1232896
  buffer_load_dwordx4 v9, s[40:43], s66 offen lds
  s_add_u32 m0, s65, 26624
  s_add_u32 s66, s64, 1232896
  buffer_load_dwordx4 v10, s[40:43], s66 offen lds
  s_waitcnt lgkmcnt(0)
  ds_read_b128 v[140:143], v171 offset:16384
  ds_read_b64_tr_b16 v[144:145], v7 offset:43008
  ds_read_b64_tr_b16 v[146:147], v7 offset:43776
  ds_read_b64_tr_b16 v[148:149], v7 offset:43072
  ds_read_b64_tr_b16 v[150:151], v7 offset:43840
  ds_read_b64_tr_b16 v[152:153], v7 offset:43136
  ds_read_b64_tr_b16 v[154:155], v7 offset:43904
  ds_read_b64_tr_b16 v[156:157], v7 offset:46080
  ds_read_b64_tr_b16 v[158:159], v7 offset:46848
  ds_read_b64_tr_b16 v[160:161], v7 offset:46144
  ds_read_b64_tr_b16 v[162:163], v7 offset:46912
  ds_read_b64_tr_b16 v[164:165], v7 offset:46208
  ds_read_b64_tr_b16 v[166:167], v7 offset:46976
  v_mfma_f32_32x32x16_bf16 v[16:31], v[116:119], v[112:115], v[16:31]
  v_mfma_f32_32x32x16_bf16 v[32:47], v[120:123], v[112:115], v[32:47]
  v_mfma_f32_32x32x16_bf16 v[48:63], v[124:127], v[112:115], v[48:63]
  v_mfma_f32_32x32x16_bf16 v[64:79], v[128:131], v[112:115], v[64:79]
  v_mfma_f32_32x32x16_bf16 v[80:95], v[132:135], v[112:115], v[80:95]
  v_mfma_f32_32x32x16_bf16 v[96:111], v[136:139], v[112:115], v[96:111]
  s_waitcnt vmcnt(3) lgkmcnt(0)
  s_barrier
  ds_read_b128 v[112:115], v168 offset:0
  ds_read_b64_tr_b16 v[116:117], v7 offset:0
  ds_read_b64_tr_b16 v[118:119], v7 offset:768
  ds_read_b64_tr_b16 v[120:121], v7 offset:64
  ds_read_b64_tr_b16 v[122:123], v7 offset:832
  ds_read_b64_tr_b16 v[124:125], v7 offset:128
  ds_read_b64_tr_b16 v[126:127], v7 offset:896
  ds_read_b64_tr_b16 v[128:129], v7 offset:3072
  ds_read_b64_tr_b16 v[130:131], v7 offset:3840
  ds_read_b64_tr_b16 v[132:133], v7 offset:3136
  ds_read_b64_tr_b16 v[134:135], v7 offset:3904
  ds_read_b64_tr_b16 v[136:137], v7 offset:3200
  ds_read_b64_tr_b16 v[138:139], v7 offset:3968
  v_mfma_f32_32x32x16_bf16 v[16:31], v[144:147], v[140:143], v[16:31]
  v_mfma_f32_32x32x16_bf16 v[32:47], v[148:151], v[140:143], v[32:47]
  v_mfma_f32_32x32x16_bf16 v[48:63], v[152:155], v[140:143], v[48:63]
  v_mfma_f32_32x32x16_bf16 v[64:79], v[156:159], v[140:143], v[64:79]
  v_mfma_f32_32x32x16_bf16 v[80:95], v[160:163], v[140:143], v[80:95]
  v_mfma_f32_32x32x16_bf16 v[96:111], v[164:167], v[140:143], v[96:111]
  s_add_u32 m0, s65, 36864
  s_add_u32 s66, s64, 1320960
  buffer_load_dwordx4 v8, s[40:43], s66 offen lds
  s_add_u32 m0, s65, 37888
  s_add_u32 s66, s64, 1320960
  buffer_load_dwordx4 v9, s[40:43], s66 offen lds
  s_add_u32 m0, s65, 38912
  s_add_u32 s66, s64, 1320960
  buffer_load_dwordx4 v10, s[40:43], s66 offen lds
  s_add_u32 m0, s67, 16384
  s_mov_b32 s66, 896
  buffer_load_dwordx4 v14, s[44:47], s66 offen lds
  s_add_u32 m0, s67, 17408
  s_mov_b32 s66, 896
  buffer_load_dwordx4 v15, s[44:47], s66 offen lds
  s_add_u32 m0, s67, 18432
  s_mov_b32 s66, 17280
  buffer_load_dwordx4 v14, s[44:47], s66 offen lds
  s_add_u32 m0, s67, 19456
  s_mov_b32 s66, 17280
  buffer_load_dwordx4 v15, s[44:47], s66 offen lds
  s_waitcnt lgkmcnt(0)
  ds_read_b128 v[140:143], v169 offset:0
  ds_read_b64_tr_b16 v[144:145], v7 offset:6144
  ds_read_b64_tr_b16 v[146:147], v7 offset:6912
  ds_read_b64_tr_b16 v[148:149], v7 offset:6208
  ds_read_b64_tr_b16 v[150:151], v7 offset:6976
  ds_read_b64_tr_b16 v[152:153], v7 offset:6272
  ds_read_b64_tr_b16 v[154:155], v7 offset:7040
  ds_read_b64_tr_b16 v[156:157], v7 offset:9216
  ds_read_b64_tr_b16 v[158:159], v7 offset:9984
  ds_read_b64_tr_b16 v[160:161], v7 offset:9280
  ds_read_b64_tr_b16 v[162:163], v7 offset:10048
  ds_read_b64_tr_b16 v[164:165], v7 offset:9344
  ds_read_b64_tr_b16 v[166:167], v7 offset:10112
  v_mfma_f32_32x32x16_bf16 v[16:31], v[116:119], v[112:115], v[16:31]
  v_mfma_f32_32x32x16_bf16 v[32:47], v[120:123], v[112:115], v[32:47]
  v_mfma_f32_32x32x16_bf16 v[48:63], v[124:127], v[112:115], v[48:63]
  v_mfma_f32_32x32x16_bf16 v[64:79], v[128:131], v[112:115], v[64:79]
  v_mfma_f32_32x32x16_bf16 v[80:95], v[132:135], v[112:115], v[80:95]
  v_mfma_f32_32x32x16_bf16 v[96:111], v[136:139], v[112:115], v[96:111]
  s_waitcnt vmcnt(10) lgkmcnt(0)
  s_barrier
  ds_read_b128 v[112:115], v170 offset:0
  ds_read_b64_tr_b16 v[116:117], v7 offset:12288
  ds_read_b64_tr_b16 v[118:119], v7 offset:13056
  ds_read_b64_tr_b16 v[120:121], v7 offset:12352
  ds_read_b64_tr_b16 v[122:123], v7 offset:13120
  ds_read_b64_tr_b16 v[124:125], v7 offset:12416
  ds_read_b64_tr_b16 v[126:127], v7 offset:13184
  ds_read_b64_tr_b16 v[128:129], v7 offset:15360
  ds_read_b64_tr_b16 v[130:131], v7 offset:16128
  ds_read_b64_tr_b16 v[132:133], v7 offset:15424
  ds_read_b64_tr_b16 v[134:135], v7 offset:16192
  ds_read_b64_tr_b16 v[136:137], v7 offset:15488
  ds_read_b64_tr_b16 v[138:139], v7 offset:16256
  v_mfma_f32_32x32x16_bf16 v[16:31], v[144:147], v[140:143], v[16:31]
  v_mfma_f32_32x32x16_bf16 v[32:47], v[148:151], v[140:143], v[32:47]
  v_mfma_f32_32x32x16_bf16 v[48:63], v[152:155], v[140:143], v[48:63]
  v_mfma_f32_32x32x16_bf16 v[64:79], v[156:159], v[140:143], v[64:79]
  v_mfma_f32_32x32x16_bf16 v[80:95], v[160:163], v[140:143], v[80:95]
  v_mfma_f32_32x32x16_bf16 v[96:111], v[164:167], v[140:143], v[96:111]
  s_waitcnt lgkmcnt(0)
  ds_read_b128 v[140:143], v171 offset:0
  ds_read_b64_tr_b16 v[144:145], v7 offset:18432
  ds_read_b64_tr_b16 v[146:147], v7 offset:19200
  ds_read_b64_tr_b16 v[148:149], v7 offset:18496
  ds_read_b64_tr_b16 v[150:151], v7 offset:19264
  ds_read_b64_tr_b16 v[152:153], v7 offset:18560
  ds_read_b64_tr_b16 v[154:155], v7 offset:19328
  ds_read_b64_tr_b16 v[156:157], v7 offset:21504
  ds_read_b64_tr_b16 v[158:159], v7 offset:22272
  ds_read_b64_tr_b16 v[160:161], v7 offset:21568
  ds_read_b64_tr_b16 v[162:163], v7 offset:22336
  ds_read_b64_tr_b16 v[164:165], v7 offset:21632
  ds_read_b64_tr_b16 v[166:167], v7 offset:22400
  v_mfma_f32_32x32x16_bf16 v[16:31], v[116:119], v[112:115], v[16:31]
  v_mfma_f32_32x32x16_bf16 v[32:47], v[120:123], v[112:115], v[32:47]
  v_mfma_f32_32x32x16_bf16 v[48:63], v[124:127], v[112:115], v[48:63]
  v_mfma_f32_32x32x16_bf16 v[64:79], v[128:131], v[112:115], v[64:79]
  v_mfma_f32_32x32x16_bf16 v[80:95], v[132:135], v[112:115], v[80:95]
  v_mfma_f32_32x32x16_bf16 v[96:111], v[136:139], v[112:115], v[96:111]
  s_waitcnt vmcnt(0) lgkmcnt(0)
  s_barrier
  ds_read_b128 v[112:115], v168 offset:16384
  ds_read_b64_tr_b16 v[116:117], v7 offset:24576
  ds_read_b64_tr_b16 v[118:119], v7 offset:25344
  ds_read_b64_tr_b16 v[120:121], v7 offset:24640
  ds_read_b64_tr_b16 v[122:123], v7 offset:25408
  ds_read_b64_tr_b16 v[124:125], v7 offset:24704
  ds_read_b64_tr_b16 v[126:127], v7 offset:25472
  ds_read_b64_tr_b16 v[128:129], v7 offset:27648
  ds_read_b64_tr_b16 v[130:131], v7 offset:28416
  ds_read_b64_tr_b16 v[132:133], v7 offset:27712
  ds_read_b64_tr_b16 v[134:135], v7 offset:28480
  ds_read_b64_tr_b16 v[136:137], v7 offset:27776
  ds_read_b64_tr_b16 v[138:139], v7 offset:28544
  v_mfma_f32_32x32x16_bf16 v[16:31], v[144:147], v[140:143], v[16:31]
  v_mfma_f32_32x32x16_bf16 v[32:47], v[148:151], v[140:143], v[32:47]
  v_mfma_f32_32x32x16_bf16 v[48:63], v[152:155], v[140:143], v[48:63]
  v_mfma_f32_32x32x16_bf16 v[64:79], v[156:159], v[140:143], v[64:79]
  v_mfma_f32_32x32x16_bf16 v[80:95], v[160:163], v[140:143], v[80:95]
  v_mfma_f32_32x32x16_bf16 v[96:111], v[164:167], v[140:143], v[96:111]
  s_waitcnt lgkmcnt(0)
  ds_read_b128 v[140:143], v169 offset:16384
  ds_read_b64_tr_b16 v[144:145], v7 offset:30720
  ds_read_b64_tr_b16 v[146:147], v7 offset:31488
  ds_read_b64_tr_b16 v[148:149], v7 offset:30784
  ds_read_b64_tr_b16 v[150:151], v7 offset:31552
  ds_read_b64_tr_b16 v[152:153], v7 offset:30848
  ds_read_b64_tr_b16 v[154:155], v7 offset:31616
  ds_read_b64_tr_b16 v[156:157], v7 offset:33792
  ds_read_b64_tr_b16 v[158:159], v7 offset:34560
  ds_read_b64_tr_b16 v[160:161], v7 offset:33856
  ds_read_b64_tr_b16 v[162:163], v7 offset:34624
  ds_read_b64_tr_b16 v[164:165], v7 offset:33920
  ds_read_b64_tr_b16 v[166:167], v7 offset:34688
  v_mfma_f32_32x32x16_bf16 v[16:31], v[116:119], v[112:115], v[16:31]
  v_mfma_f32_32x32x16_bf16 v[32:47], v[120:123], v[112:115], v[32:47]
  v_mfma_f32_32x32x16_bf16 v[48:63], v[124:127], v[112:115], v[48:63]
  v_mfma_f32_32x32x16_bf16 v[64:79], v[128:131], v[112:115], v[64:79]
  v_mfma_f32_32x32x16_bf16 v[80:95], v[132:135], v[112:115], v[80:95]
  v_mfma_f32_32x32x16_bf16 v[96:111], v[136:139], v[112:115], v[96:111]
  s_waitcnt vmcnt(0) lgkmcnt(0)
  s_barrier
  ds_read_b128 v[112:115], v170 offset:16384
  ds_read_b64_tr_b16 v[116:117], v7 offset:36864
  ds_read_b64_tr_b16 v[118:119], v7 offset:37632
  ds_read_b64_tr_b16 v[120:121], v7 offset:36928
  ds_read_b64_tr_b16 v[122:123], v7 offset:37696
  ds_read_b64_tr_b16 v[124:125], v7 offset:36992
  ds_read_b64_tr_b16 v[126:127], v7 offset:37760
  ds_read_b64_tr_b16 v[128:129], v7 offset:39936
  ds_read_b64_tr_b16 v[130:131], v7 offset:40704
  ds_read_b64_tr_b16 v[132:133], v7 offset:40000
  ds_read_b64_tr_b16 v[134:135], v7 offset:40768
  ds_read_b64_tr_b16 v[136:137], v7 offset:40064
  ds_read_b64_tr_b16 v[138:139], v7 offset:40832
  v_mfma_f32_32x32x16_bf16 v[16:31], v[144:147], v[140:143], v[16:31]
  v_mfma_f32_32x32x16_bf16 v[32:47], v[148:151], v[140:143], v[32:47]
  v_mfma_f32_32x32x16_bf16 v[48:63], v[152:155], v[140:143], v[48:63]
  v_mfma_f32_32x32x16_bf16 v[64:79], v[156:159], v[140:143], v[64:79]
  v_mfma_f32_32x32x16_bf16 v[80:95], v[160:163], v[140:143], v[80:95]
  v_mfma_f32_32x32x16_bf16 v[96:111], v[164:167], v[140:143], v[96:111]
  s_waitcnt lgkmcnt(0)
  ds_read_b128 v[140:143], v171 offset:16384
  ds_read_b64_tr_b16 v[144:145], v7 offset:43008
  ds_read_b64_tr_b16 v[146:147], v7 offset:43776
  ds_read_b64_tr_b16 v[148:149], v7 offset:43072
  ds_read_b64_tr_b16 v[150:151], v7 offset:43840
  ds_read_b64_tr_b16 v[152:153], v7 offset:43136
  ds_read_b64_tr_b16 v[154:155], v7 offset:43904
  ds_read_b64_tr_b16 v[156:157], v7 offset:46080
  ds_read_b64_tr_b16 v[158:159], v7 offset:46848
  ds_read_b64_tr_b16 v[160:161], v7 offset:46144
  ds_read_b64_tr_b16 v[162:163], v7 offset:46912
  ds_read_b64_tr_b16 v[164:165], v7 offset:46208
  ds_read_b64_tr_b16 v[166:167], v7 offset:46976
  v_mfma_f32_32x32x16_bf16 v[16:31], v[116:119], v[112:115], v[16:31]
  v_mfma_f32_32x32x16_bf16 v[32:47], v[120:123], v[112:115], v[32:47]
  v_mfma_f32_32x32x16_bf16 v[48:63], v[124:127], v[112:115], v[48:63]
  v_mfma_f32_32x32x16_bf16 v[64:79], v[128:131], v[112:115], v[64:79]
  v_mfma_f32_32x32x16_bf16 v[80:95], v[132:135], v[112:115], v[80:95]
  v_mfma_f32_32x32x16_bf16 v[96:111], v[136:139], v[112:115], v[96:111]
  s_waitcnt lgkmcnt(0)
  v_mfma_f32_32x32x16_bf16 v[16:31], v[144:147], v[140:143], v[16:31]
  v_mfma_f32_32x32x16_bf16 v[32:47], v[148:151], v[140:143], v[32:47]
  v_mfma_f32_32x32x16_bf16 v[48:63], v[152:155], v[140:143], v[48:63]
  v_mfma_f32_32x32x16_bf16 v[64:79], v[156:159], v[140:143], v[64:79]
  v_mfma_f32_32x32x16_bf16 v[80:95], v[160:163], v[140:143], v[80:95]
  v_mfma_f32_32x32x16_bf16 v[96:111], v[164:167], v[140:143], v[96:111]
  s_setprio 3
  s_nop 5
  v_mul_f32 v112, 0xbfb8aa3b, v16
  v_mul_f32 v113, 0xbfb8aa3b, v17
  v_mul_f32 v114, 0xbfb8aa3b, v18
  v_mul_f32 v115, 0xbfb8aa3b, v19
  v_mul_f32 v116, 0xbfb8aa3b, v20
  v_mul_f32 v117, 0xbfb8aa3b, v21
  v_mul_f32 v118, 0xbfb8aa3b, v22
  v_mul_f32 v119, 0xbfb8aa3b, v23
  v_mul_f32 v120, 0xbfb8aa3b, v24
  v_mul_f32 v121, 0xbfb8aa3b, v25
  v_mul_f32 v122, 0xbfb8aa3b, v26
  v_mul_f32 v123, 0xbfb8aa3b, v27
  v_mul_f32 v124, 0xbfb8aa3b, v28
  v_mul_f32 v125, 0xbfb8aa3b, v29
  v_mul_f32 v126, 0xbfb8aa3b, v30
  v_mul_f32 v127, 0xbfb8aa3b, v31
  v_exp_f32 v112, v112
  v_exp_f32 v113, v113
  v_exp_f32 v114, v114
  v_exp_f32 v115, v115
  v_exp_f32 v116, v116
  v_exp_f32 v117, v117
  v_exp_f32 v118, v118
  v_exp_f32 v119, v119
  v_exp_f32 v120, v120
  v_exp_f32 v121, v121
  v_exp_f32 v122, v122
  v_exp_f32 v123, v123
  v_exp_f32 v124, v124
  v_exp_f32 v125, v125
  v_exp_f32 v126, v126
  v_exp_f32 v127, v127
  v_mul_f32 v16, v16, v64
  v_mul_f32 v17, v17, v65
  v_mul_f32 v18, v18, v66
  v_mul_f32 v19, v19, v67
  v_mul_f32 v20, v20, v68
  v_mul_f32 v21, v21, v69
  v_mul_f32 v22, v22, v70
  v_mul_f32 v23, v23, v71
  v_mul_f32 v24, v24, v72
  v_mul_f32 v25, v25, v73
  v_mul_f32 v26, v26, v74
  v_mul_f32 v27, v27, v75
  v_mul_f32 v28, v28, v76
  v_mul_f32 v29, v29, v77
  v_mul_f32 v30, v30, v78
  v_mul_f32 v31, v31, v79
  v_add_f32 v112, 1.0, v112
  v_add_f32 v113, 1.0, v113
  v_add_f32 v114, 1.0, v114
  v_add_f32 v115, 1.0, v115
  v_add_f32 v116, 1.0, v116
  v_add_f32 v117, 1.0, v117
  v_add_f32 v118, 1.0, v118
  v_add_f32 v119, 1.0, v119
  v_add_f32 v120, 1.0, v120
  v_add_f32 v121, 1.0, v121
  v_add_f32 v122, 1.0, v122
  v_add_f32 v123, 1.0, v123
  v_add_f32 v124, 1.0, v124
  v_add_f32 v125, 1.0, v125
  v_add_f32 v126, 1.0, v126
  v_add_f32 v127, 1.0, v127
  v_rcp_f32 v112, v112
  v_rcp_f32 v113, v113
  v_rcp_f32 v114, v114
  v_rcp_f32 v115, v115
  v_rcp_f32 v116, v116
  v_rcp_f32 v117, v117
  v_rcp_f32 v118, v118
  v_rcp_f32 v119, v119
  v_rcp_f32 v120, v120
  v_rcp_f32 v121, v121
  v_rcp_f32 v122, v122
  v_rcp_f32 v123, v123
  v_rcp_f32 v124, v124
  v_rcp_f32 v125, v125
  v_rcp_f32 v126, v126
  v_rcp_f32 v127, v127
  v_mul_f32 v16, v16, v112
  v_mul_f32 v17, v17, v113
  v_mul_f32 v18, v18, v114
  v_mul_f32 v19, v19, v115
  v_mul_f32 v20, v20, v116
  v_mul_f32 v21, v21, v117
  v_mul_f32 v22, v22, v118
  v_mul_f32 v23, v23, v119
  v_mul_f32 v24, v24, v120
  v_mul_f32 v25, v25, v121
  v_mul_f32 v26, v26, v122
  v_mul_f32 v27, v27, v123
  v_mul_f32 v28, v28, v124
  v_mul_f32 v29, v29, v125
  v_mul_f32 v30, v30, v126
  v_mul_f32 v31, v31, v127
  v_cvt_pk_bf16_f32 v64, v16, v17
  v_cvt_pk_bf16_f32 v65, v18, v19
  v_cvt_pk_bf16_f32 v66, v20, v21
  v_cvt_pk_bf16_f32 v67, v22, v23
  v_cvt_pk_bf16_f32 v68, v24, v25
  v_cvt_pk_bf16_f32 v69, v26, v27
  v_cvt_pk_bf16_f32 v70, v28, v29
  v_cvt_pk_bf16_f32 v71, v30, v31
  s_mul_i32 s66, s63, 86
  s_lshl_b32 s68, s62, 1
  s_add_u32 s66, s66, s68
  s_lshl_b32 s66, s66, 10
  s_add_u32 s66, s66, 8388608
  buffer_store_dwordx4 v[64:67], v5, s[48:51], s66 offen sc0 sc1
  buffer_store_dwordx4 v[68:71], v5, s[48:51], s66 offen offset:1024 sc0 sc1
  v_mul_f32 v112, 0xbfb8aa3b, v32
  v_mul_f32 v113, 0xbfb8aa3b, v33
  v_mul_f32 v114, 0xbfb8aa3b, v34
  v_mul_f32 v115, 0xbfb8aa3b, v35
  v_mul_f32 v116, 0xbfb8aa3b, v36
  v_mul_f32 v117, 0xbfb8aa3b, v37
  v_mul_f32 v118, 0xbfb8aa3b, v38
  v_mul_f32 v119, 0xbfb8aa3b, v39
  v_mul_f32 v120, 0xbfb8aa3b, v40
  v_mul_f32 v121, 0xbfb8aa3b, v41
  v_mul_f32 v122, 0xbfb8aa3b, v42
  v_mul_f32 v123, 0xbfb8aa3b, v43
  v_mul_f32 v124, 0xbfb8aa3b, v44
  v_mul_f32 v125, 0xbfb8aa3b, v45
  v_mul_f32 v126, 0xbfb8aa3b, v46
  v_mul_f32 v127, 0xbfb8aa3b, v47
  v_exp_f32 v112, v112
  v_exp_f32 v113, v113
  v_exp_f32 v114, v114
  v_exp_f32 v115, v115
  v_exp_f32 v116, v116
  v_exp_f32 v117, v117
  v_exp_f32 v118, v118
  v_exp_f32 v119, v119
  v_exp_f32 v120, v120
  v_exp_f32 v121, v121
  v_exp_f32 v122, v122
  v_exp_f32 v123, v123
  v_exp_f32 v124, v124
  v_exp_f32 v125, v125
  v_exp_f32 v126, v126
  v_exp_f32 v127, v127
  v_mul_f32 v32, v32, v80
  v_mul_f32 v33, v33, v81
  v_mul_f32 v34, v34, v82
  v_mul_f32 v35, v35, v83
  v_mul_f32 v36, v36, v84
  v_mul_f32 v37, v37, v85
  v_mul_f32 v38, v38, v86
  v_mul_f32 v39, v39, v87
  v_mul_f32 v40, v40, v88
  v_mul_f32 v41, v41, v89
  v_mul_f32 v42, v42, v90
  v_mul_f32 v43, v43, v91
  v_mul_f32 v44, v44, v92
  v_mul_f32 v45, v45, v93
  v_mul_f32 v46, v46, v94
  v_mul_f32 v47, v47, v95
  v_add_f32 v112, 1.0, v112
  v_add_f32 v113, 1.0, v113
  v_add_f32 v114, 1.0, v114
  v_add_f32 v115, 1.0, v115
  v_add_f32 v116, 1.0, v116
  v_add_f32 v117, 1.0, v117
  v_add_f32 v118, 1.0, v118
  v_add_f32 v119, 1.0, v119
  v_add_f32 v120, 1.0, v120
  v_add_f32 v121, 1.0, v121
  v_add_f32 v122, 1.0, v122
  v_add_f32 v123, 1.0, v123
  v_add_f32 v124, 1.0, v124
  v_add_f32 v125, 1.0, v125
  v_add_f32 v126, 1.0, v126
  v_add_f32 v127, 1.0, v127
  v_rcp_f32 v112, v112
  v_rcp_f32 v113, v113
  v_rcp_f32 v114, v114
  v_rcp_f32 v115, v115
  v_rcp_f32 v116, v116
  v_rcp_f32 v117, v117
  v_rcp_f32 v118, v118
  v_rcp_f32 v119, v119
  v_rcp_f32 v120, v120
  v_rcp_f32 v121, v121
  v_rcp_f32 v122, v122
  v_rcp_f32 v123, v123
  v_rcp_f32 v124, v124
  v_rcp_f32 v125, v125
  v_rcp_f32 v126, v126
  v_rcp_f32 v127, v127
  v_mul_f32 v32, v32, v112
  v_mul_f32 v33, v33, v113
  v_mul_f32 v34, v34, v114
  v_mul_f32 v35, v35, v115
  v_mul_f32 v36, v36, v116
  v_mul_f32 v37, v37, v117
  v_mul_f32 v38, v38, v118
  v_mul_f32 v39, v39, v119
  v_mul_f32 v40, v40, v120
  v_mul_f32 v41, v41, v121
  v_mul_f32 v42, v42, v122
  v_mul_f32 v43, v43, v123
  v_mul_f32 v44, v44, v124
  v_mul_f32 v45, v45, v125
  v_mul_f32 v46, v46, v126
  v_mul_f32 v47, v47, v127
  v_cvt_pk_bf16_f32 v80, v32, v33
  v_cvt_pk_bf16_f32 v81, v34, v35
  v_cvt_pk_bf16_f32 v82, v36, v37
  v_cvt_pk_bf16_f32 v83, v38, v39
  v_cvt_pk_bf16_f32 v84, v40, v41
  v_cvt_pk_bf16_f32 v85, v42, v43
  v_cvt_pk_bf16_f32 v86, v44, v45
  v_cvt_pk_bf16_f32 v87, v46, v47
  s_add_u32 s66, s66, 2048
  buffer_store_dwordx4 v[80:83], v5, s[48:51], s66 offen sc0 sc1
  buffer_store_dwordx4 v[84:87], v5, s[48:51], s66 offen offset:1024 sc0 sc1
  v_mul_f32 v112, 0xbfb8aa3b, v48
  v_mul_f32 v113, 0xbfb8aa3b, v49
  v_mul_f32 v114, 0xbfb8aa3b, v50
  v_mul_f32 v115, 0xbfb8aa3b, v51
  v_mul_f32 v116, 0xbfb8aa3b, v52
  v_mul_f32 v117, 0xbfb8aa3b, v53
  v_mul_f32 v118, 0xbfb8aa3b, v54
  v_mul_f32 v119, 0xbfb8aa3b, v55
  v_mul_f32 v120, 0xbfb8aa3b, v56
  v_mul_f32 v121, 0xbfb8aa3b, v57
  v_mul_f32 v122, 0xbfb8aa3b, v58
  v_mul_f32 v123, 0xbfb8aa3b, v59
  v_mul_f32 v124, 0xbfb8aa3b, v60
  v_mul_f32 v125, 0xbfb8aa3b, v61
  v_mul_f32 v126, 0xbfb8aa3b, v62
  v_mul_f32 v127, 0xbfb8aa3b, v63
  v_exp_f32 v112, v112
  v_exp_f32 v113, v113
  v_exp_f32 v114, v114
  v_exp_f32 v115, v115
  v_exp_f32 v116, v116
  v_exp_f32 v117, v117
  v_exp_f32 v118, v118
  v_exp_f32 v119, v119
  v_exp_f32 v120, v120
  v_exp_f32 v121, v121
  v_exp_f32 v122, v122
  v_exp_f32 v123, v123
  v_exp_f32 v124, v124
  v_exp_f32 v125, v125
  v_exp_f32 v126, v126
  v_exp_f32 v127, v127
  v_mul_f32 v48, v48, v96
  v_mul_f32 v49, v49, v97
  v_mul_f32 v50, v50, v98
  v_mul_f32 v51, v51, v99
  v_mul_f32 v52, v52, v100
  v_mul_f32 v53, v53, v101
  v_mul_f32 v54, v54, v102
  v_mul_f32 v55, v55, v103
  v_mul_f32 v56, v56, v104
  v_mul_f32 v57, v57, v105
  v_mul_f32 v58, v58, v106
  v_mul_f32 v59, v59, v107
  v_mul_f32 v60, v60, v108
  v_mul_f32 v61, v61, v109
  v_mul_f32 v62, v62, v110
  v_mul_f32 v63, v63, v111
  v_add_f32 v112, 1.0, v112
  v_add_f32 v113, 1.0, v113
  v_add_f32 v114, 1.0, v114
  v_add_f32 v115, 1.0, v115
  v_add_f32 v116, 1.0, v116
  v_add_f32 v117, 1.0, v117
  v_add_f32 v118, 1.0, v118
  v_add_f32 v119, 1.0, v119
  v_add_f32 v120, 1.0, v120
  v_add_f32 v121, 1.0, v121
  v_add_f32 v122, 1.0, v122
  v_add_f32 v123, 1.0, v123
  v_add_f32 v124, 1.0, v124
  v_add_f32 v125, 1.0, v125
  v_add_f32 v126, 1.0, v126
  v_add_f32 v127, 1.0, v127
  v_rcp_f32 v112, v112
  v_rcp_f32 v113, v113
  v_rcp_f32 v114, v114
  v_rcp_f32 v115, v115
  v_rcp_f32 v116, v116
  v_rcp_f32 v117, v117
  v_rcp_f32 v118, v118
  v_rcp_f32 v119, v119
  v_rcp_f32 v120, v120
  v_rcp_f32 v121, v121
  v_rcp_f32 v122, v122
  v_rcp_f32 v123, v123
  v_rcp_f32 v124, v124
  v_rcp_f32 v125, v125
  v_rcp_f32 v126, v126
  v_rcp_f32 v127, v127
  v_mul_f32 v48, v48, v112
  v_mul_f32 v49, v49, v113
  v_mul_f32 v50, v50, v114
  v_mul_f32 v51, v51, v115
  v_mul_f32 v52, v52, v116
  v_mul_f32 v53, v53, v117
  v_mul_f32 v54, v54, v118
  v_mul_f32 v55, v55, v119
  v_mul_f32 v56, v56, v120
  v_mul_f32 v57, v57, v121
  v_mul_f32 v58, v58, v122
  v_mul_f32 v59, v59, v123
  v_mul_f32 v60, v60, v124
  v_mul_f32 v61, v61, v125
  v_mul_f32 v62, v62, v126
  v_mul_f32 v63, v63, v127
  v_cvt_pk_bf16_f32 v96, v48, v49
  v_cvt_pk_bf16_f32 v97, v50, v51
  v_cvt_pk_bf16_f32 v98, v52, v53
  v_cvt_pk_bf16_f32 v99, v54, v55
  v_cvt_pk_bf16_f32 v100, v56, v57
  v_cvt_pk_bf16_f32 v101, v58, v59
  v_cvt_pk_bf16_f32 v102, v60, v61
  v_cvt_pk_bf16_f32 v103, v62, v63
  s_add_u32 s66, s66, 2048
  buffer_store_dwordx4 v[96:99], v5, s[48:51], s66 offen sc0 sc1
  buffer_store_dwordx4 v[100:103], v5, s[48:51], s66 offen offset:1024 sc0 sc1
  s_branch k2_mix_kernel_U_updone
k2_mix_kernel_U_up2:
  s_lshl_b32 s62, s59, 1
  s_add_u32 s62, s62, 11
  s_lshl_b32 s63, s61, 2
  s_add_u32 s63, s63, s60
  v_lshrrev_b32 v6, 3, v1
  s_lshl_b32 s68, s63, 5
  v_add_u32 v6, s68, v6
  v_lshlrev_b32 v6, 10, v6
  v_and_b32 v7, 7, v1
  v_lshrrev_b32 v11, 4, v1
  v_xor_b32 v7, v7, v11
  v_xor_b32 v12, 4, v7
  v_lshlrev_b32 v7, 4, v7
  v_lshlrev_b32 v12, 4, v12
  v_add_u32 v14, v6, v7
  v_add_u32 v15, v6, v12
  v_add_u32 v15, 0x2000, v15
  s_lshl_b32 s67, s60, 12
  s_add_u32 s67, s67, 49152
  v_add_u32 v6, 0, v1
  v_lshrrev_b32 v7, 3, v6
  v_mul_u32_u24 v11, 8, v7
  v_sub_u32 v11, v6, v11
  v_mul_u32_u24 v7, 2752, v7
  v_lshlrev_b32 v11, 4, v11
  v_add_u32 v8, v7, v11
  v_add_u32 v6, 64, v1
  v_lshrrev_b32 v7, 3, v6
  v_mul_u32_u24 v11, 8, v7
  v_sub_u32 v11, v6, v11
  v_mul_u32_u24 v7, 2752, v7
  v_lshlrev_b32 v11, 4, v11
  v_add_u32 v9, v7, v11
  s_lshr_b32 s64, s60, 1
  s_mul_i32 s64, s64, 44032
  s_lshl_b32 s65, s62, 6
  s_add_u32 s64, s64, s65
  s_mul_i32 s65, s60, 2048
  s_add_u32 m0, s65, 0
  s_add_u32 s66, s64, 0
  buffer_load_dwordx4 v8, s[40:43], s66 offen lds
  s_add_u32 m0, s65, 1024
  s_add_u32 s66, s64, 0
  buffer_load_dwordx4 v9, s[40:43], s66 offen lds
  s_add_u32 m0, s67, 0
  s_mov_b32 s66, 0
  buffer_load_dwordx4 v14, s[44:47], s66 offen lds
  s_add_u32 m0, s67, 1024
  s_mov_b32 s66, 0
  buffer_load_dwordx4 v15, s[44:47], s66 offen lds
  s_add_u32 m0, s67, 2048
  s_mov_b32 s66, 16384
  buffer_load_dwordx4 v14, s[44:47], s66 offen lds
  s_add_u32 m0, s67, 3072
  s_mov_b32 s66, 16384
  buffer_load_dwordx4 v15, s[44:47], s66 offen lds
  s_add_u32 m0, s65, 8192
  s_add_u32 s66, s64, 88064
  buffer_load_dwordx4 v8, s[40:43], s66 offen lds
  s_add_u32 m0, s65, 9216
  s_add_u32 s66, s64, 88064
  buffer_load_dwordx4 v9, s[40:43], s66 offen lds
  s_add_u32 m0, s65, 16384
  s_add_u32 s66, s64, 176128
  buffer_load_dwordx4 v8, s[40:43], s66 offen lds
  s_add_u32 m0, s65, 17408
  s_add_u32 s66, s64, 176128
  buffer_load_dwordx4 v9, s[40:43], s66 offen lds
  s_add_u32 m0, s67, 16384
  s_mov_b32 s66, 128
  buffer_load_dwordx4 v14, s[44:47], s66 offen lds
  s_add_u32 m0, s67, 17408
  s_mov_b32 s66, 128
  buffer_load_dwordx4 v15, s[44:47], s66 offen lds
  s_add_u32 m0, s67, 18432
  s_mov_b32 s66, 16512
  buffer_load_dwordx4 v14, s[44:47], s66 offen lds
  s_add_u32 m0, s67, 19456
  s_mov_b32 s66, 16512
  buffer_load_dwordx4 v15, s[44:47], s66 offen lds
  s_add_u32 m0, s65, 24576
  s_add_u32 s66, s64, 264192
  buffer_load_dwordx4 v8, s[40:43], s66 offen lds
  s_add_u32 m0, s65, 25600
  s_add_u32 s66, s64, 264192
  buffer_load_dwordx4 v9, s[40:43], s66 offen lds
  v_lshrrev_b32 v6, 4, v1
  v_lshrrev_b32 v7, 1, v6
  v_lshlrev_b32 v7, 3, v7
  v_and_b32 v11, 15, v1
  v_lshrrev_b32 v12, 2, v11
  v_add_u32 v7, v7, v12
  v_mul_u32_u24 v7, 128, v7
  v_and_b32 v12, 1, v6
  v_lshlrev_b32 v12, 5, v12
  v_add_u32 v7, v7, v12
  v_and_b32 v12, 3, v11
  v_lshlrev_b32 v12, 3, v12
  v_add_u32 v7, v7, v12
  v_lshrrev_b32 v11, 1, v3
  v_and_b32 v11, 7, v11
  v_lshlrev_b32 v12, 7, v3
  v_add_u32 v12, s67, v12
  v_add_u32 v6, 0, v4
  v_xor_b32 v6, v6, v11
  v_lshlrev_b32 v6, 4, v6
  v_add_u32 v168, v12, v6
  v_add_u32 v6, 2, v4
  v_xor_b32 v6, v6, v11
  v_lshlrev_b32 v6, 4, v6
  v_add_u32 v169, v12, v6
  v_add_u32 v6, 4, v4
  v_xor_b32 v6, v6, v11
  v_lshlrev_b32 v6, 4, v6
  v_add_u32 v170, v12, v6
  v_add_u32 v6, 6, v4
  v_xor_b32 v6, v6, v11
  v_lshlrev_b32 v6, 4, v6
  v_add_u32 v171, v12, v6
  s_setprio 1
  s_waitcnt vmcnt(10) lgkmcnt(0)
  s_barrier
  ds_read_b128 v[112:115], v168 offset:0
  ds_read_b64_tr_b16 v[116:117], v7 offset:0
  ds_read_b64_tr_b16 v[118:119], v7 offset:512
  ds_read_b64_tr_b16 v[120:121], v7 offset:64
  ds_read_b64_tr_b16 v[122:123], v7 offset:576
  ds_read_b64_tr_b16 v[124:125], v7 offset:2048
  ds_read_b64_tr_b16 v[126:127], v7 offset:2560
  ds_read_b64_tr_b16 v[128:129], v7 offset:2112
  ds_read_b64_tr_b16 v[130:131], v7 offset:2624
  s_waitcnt lgkmcnt(0)
  ds_read_b128 v[140:143], v169 offset:0
  ds_read_b64_tr_b16 v[144:145], v7 offset:4096
  ds_read_b64_tr_b16 v[146:147], v7 offset:4608
  ds_read_b64_tr_b16 v[148:149], v7 offset:4160
  ds_read_b64_tr_b16 v[150:151], v7 offset:4672
  ds_read_b64_tr_b16 v[152:153], v7 offset:6144
  ds_read_b64_tr_b16 v[154:155], v7 offset:6656
  ds_read_b64_tr_b16 v[156:157], v7 offset:6208
  ds_read_b64_tr_b16 v[158:159], v7 offset:6720
  v_mfma_f32_32x32x16_bf16 v[16:31], v[116:119], v[112:115], 0
  v_mfma_f32_32x32x16_bf16 v[32:47], v[120:123], v[112:115], 0
  v_mfma_f32_32x32x16_bf16 v[48:63], v[124:127], v[112:115], 0
  v_mfma_f32_32x32x16_bf16 v[64:79], v[128:131], v[112:115], 0
  s_waitcnt vmcnt(8) lgkmcnt(0)
  s_barrier
  ds_read_b128 v[112:115], v170 offset:0
  ds_read_b64_tr_b16 v[116:117], v7 offset:8192
  ds_read_b64_tr_b16 v[118:119], v7 offset:8704
  ds_read_b64_tr_b16 v[120:121], v7 offset:8256
  ds_read_b64_tr_b16 v[122:123], v7 offset:8768
  ds_read_b64_tr_b16 v[124:125], v7 offset:10240
  ds_read_b64_tr_b16 v[126:127], v7 offset:10752
  ds_read_b64_tr_b16 v[128:129], v7 offset:10304
  ds_read_b64_tr_b16 v[130:131], v7 offset:10816
  v_mfma_f32_32x32x16_bf16 v[16:31], v[144:147], v[140:143], v[16:31]
  v_mfma_f32_32x32x16_bf16 v[32:47], v[148:151], v[140:143], v[32:47]
  v_mfma_f32_32x32x16_bf16 v[48:63], v[152:155], v[140:143], v[48:63]
  v_mfma_f32_32x32x16_bf16 v[64:79], v[156:159], v[140:143], v[64:79]
  s_add_u32 m0, s65, 0
  s_add_u32 s66, s64, 352256
  buffer_load_dwordx4 v8, s[40:43], s66 offen lds
  s_add_u32 m0, s65, 1024
  s_add_u32 s66, s64, 352256
  buffer_load_dwordx4 v9, s[40:43], s66 offen lds
  s_waitcnt lgkmcnt(0)
  ds_read_b128 v[140:143], v171 offset:0
  ds_read_b64_tr_b16 v[144:145], v7 offset:12288
  ds_read_b64_tr_b16 v[146:147], v7 offset:12800
  ds_read_b64_tr_b16 v[148:149], v7 offset:12352
  ds_read_b64_tr_b16 v[150:151], v7 offset:12864
  ds_read_b64_tr_b16 v[152:153], v7 offset:14336
  ds_read_b64_tr_b16 v[154:155], v7 offset:14848
  ds_read_b64_tr_b16 v[156:157], v7 offset:14400
  ds_read_b64_tr_b16 v[158:159], v7 offset:14912
  v_mfma_f32_32x32x16_bf16 v[16:31], v[116:119], v[112:115], v[16:31]
  v_mfma_f32_32x32x16_bf16 v[32:47], v[120:123], v[112:115], v[32:47]
  v_mfma_f32_32x32x16_bf16 v[48:63], v[124:127], v[112:115], v[48:63]
  v_mfma_f32_32x32x16_bf16 v[64:79], v[128:131], v[112:115], v[64:79]
  s_waitcnt vmcnt(4) lgkmcnt(0)
  s_barrier
  ds_read_b128 v[112:115], v168 offset:16384
  ds_read_b64_tr_b16 v[116:117], v7 offset:16384
  ds_read_b64_tr_b16 v[118:119], v7 offset:16896
  ds_read_b64_tr_b16 v[120:121], v7 offset:16448
  ds_read_b64_tr_b16 v[122:123], v7 offset:16960
  ds_read_b64_tr_b16 v[124:125], v7 offset:18432
  ds_read_b64_tr_b16 v[126:127], v7 offset:18944
  ds_read_b64_tr_b16 v[128:129], v7 offset:18496
  ds_read_b64_tr_b16 v[130:131], v7 offset:19008
  v_mfma_f32_32x32x16_bf16 v[16:31], v[144:147], v[140:143], v[16:31]
  v_mfma_f32_32x32x16_bf16 v[32:47], v[148:151], v[140:143], v[32:47]
  v_mfma_f32_32x32x16_bf16 v[48:63], v[152:155], v[140:143], v[48:63]
  v_mfma_f32_32x32x16_bf16 v[64:79], v[156:159], v[140:143], v[64:79]
  s_add_u32 m0, s65, 8192
  s_add_u32 s66, s64, 440320
  buffer_load_dwordx4 v8, s[40:43], s66 offen lds
  s_add_u32 m0, s65, 9216
  s_add_u32 s66, s64, 440320
  buffer_load_dwordx4 v9, s[40:43], s66 offen lds
  s_add_u32 m0, s67, 0
  s_mov_b32 s66, 256
  buffer_load_dwordx4 v14, s[44:47], s66 offen lds
  s_add_u32 m0, s67, 1024
  s_mov_b32 s66, 256
  buffer_load_dwordx4 v15, s[44:47], s66 offen lds
  s_add_u32 m0, s67, 2048
  s_mov_b32 s66, 16640
  buffer_load_dwordx4 v14, s[44:47], s66 offen lds
  s_add_u32 m0, s67, 3072
  s_mov_b32 s66, 16640
  buffer_load_dwordx4 v15, s[44:47], s66 offen lds
  s_waitcnt lgkmcnt(0)
  ds_read_b128 v[140:143], v169 offset:16384
  ds_read_b64_tr_b16 v[144:145], v7 offset:20480
  ds_read_b64_tr_b16 v[146:147], v7 offset:20992
  ds_read_b64_tr_b16 v[148:149], v7 offset:20544
  ds_read_b64_tr_b16 v[150:151], v7 offset:21056
  ds_read_b64_tr_b16 v[152:153], v7 offset:22528
  ds_read_b64_tr_b16 v[154:155], v7 offset:23040
  ds_read_b64_tr_b16 v[156:157], v7 offset:22592
  ds_read_b64_tr_b16 v[158:159], v7 offset:23104
  v_mfma_f32_32x32x16_bf16 v[16:31], v[116:119], v[112:115], v[16:31]
  v_mfma_f32_32x32x16_bf16 v[32:47], v[120:123], v[112:115], v[32:47]
  v_mfma_f32_32x32x16_bf16 v[48:63], v[124:127], v[112:115], v[48:63]
  v_mfma_f32_32x32x16_bf16 v[64:79], v[128:131], v[112:115], v[64:79]
  s_waitcnt vmcnt(8) lgkmcnt(0)
  s_barrier
  ds_read_b128 v[112:115], v170 offset:16384
  ds_read_b64_tr_b16 v[116:117], v7 offset:24576
  ds_read_b64_tr_b16 v[118:119], v7 offset:25088
  ds_read_b64_tr_b16 v[120:121], v7 offset:24640
  ds_read_b64_tr_b16 v[122:123], v7 offset:25152
  ds_read_b64_tr_b16 v[124:125], v7 offset:26624
  ds_read_b64_tr_b16 v[126:127], v7 offset:27136
  ds_read_b64_tr_b16 v[128:129], v7 offset:26688
  ds_read_b64_tr_b16 v[130:131], v7 offset:27200
  v_mfma_f32_32x32x16_bf16 v[16:31], v[144:147], v[140:143], v[16:31]
  v_mfma_f32_32x32x16_bf16 v[32:47], v[148:151], v[140:143], v[32:47]
  v_mfma_f32_32x32x16_bf16 v[48:63], v[152:155], v[140:143], v[48:63]
  v_mfma_f32_32x32x16_bf16 v[64:79], v[156:159], v[140:143], v[64:79]
  s_add_u32 m0, s65, 16384
  s_add_u32 s66, s64, 528384
  buffer_load_dwordx4 v8, s[40:43], s66 offen lds
  s_add_u32 m0, s65, 17408
  s_add_u32 s66, s64, 528384
  buffer_load_dwordx4 v9, s[40:43], s66 offen lds
  s_waitcnt lgkmcnt(0)
  ds_read_b128 v[140:143], v171 offset:16384
  ds_read_b64_tr_b16 v[144:145], v7 offset:28672
  ds_read_b64_tr_b16 v[146:147], v7 offset:29184
  ds_read_b64_tr_b16 v[148:149], v7 offset:28736
  ds_read_b64_tr_b16 v[150:151], v7 offset:29248
  ds_read_b64_tr_b16 v[152:153], v7 offset:30720
  ds_read_b64_tr_b16 v[154:155], v7 offset:31232
  ds_read_b64_tr_b16 v[156:157], v7 offset:30784
  ds_read_b64_tr_b16 v[158:159], v7 offset:31296
  v_mfma_f32_32x32x16_bf16 v[16:31], v[116:119], v[112:115], v[16:31]
  v_mfma_f32_32x32x16_bf16 v[32:47], v[120:123], v[112:115], v[32:47]
  v_mfma_f32_32x32x16_bf16 v[48:63], v[124:127], v[112:115], v[48:63]
  v_mfma_f32_32x32x16_bf16 v[64:79], v[128:131], v[112:115], v[64:79]
  s_waitcnt vmcnt(2) lgkmcnt(0)
  s_barrier
  ds_read_b128 v[112:115], v168 offset:0
  ds_read_b64_tr_b16 v[116:117], v7 offset:0
  ds_read_b64_tr_b16 v[118:119], v7 offset:512
  ds_read_b64_tr_b16 v[120:121], v7 offset:64
  ds_read_b64_tr_b16 v[122:123], v7 offset:576
  ds_read_b64_tr_b16 v[124:125], v7 offset:2048
  ds_read_b64_tr_b16 v[126:127], v7 offset:2560
  ds_read_b64_tr_b16 v[128:129], v7 offset:2112
  ds_read_b64_tr_b16 v[130:131], v7 offset:2624
  v_mfma_f32_32x32x16_bf16 v[16:31], v[144:147], v[140:143], v[16:31]
  v_mfma_f32_32x32x16_bf16 v[32:47], v[148:151], v[140:143], v[32:47]
  v_mfma_f32_32x32x16_bf16 v[48:63], v[152:155], v[140:143], v[48:63]
  v_mfma_f32_32x32x16_bf16 v[64:79], v[156:159], v[140:143], v[64:79]
  s_add_u32 m0, s65, 24576
  s_add_u32 s66, s64, 616448
  buffer_load_dwordx4 v8, s[40:43], s66 offen lds
  s_add_u32 m0, s65, 25600
  s_add_u32 s66, s64, 616448
  buffer_load_dwordx4 v9, s[40:43], s66 offen lds
  s_add_u32 m0, s67, 16384
  s_mov_b32 s66, 384
  buffer_load_dwordx4 v14, s[44:47], s66 offen lds
  s_add_u32 m0, s67, 17408
  s_mov_b32 s66, 384
  buffer_load_dwordx4 v15, s[44:47], s66 offen lds
  s_add_u32 m0, s67, 18432
  s_mov_b32 s66, 16768
  buffer_load_dwordx4 v14, s[44:47], s66 offen lds
  s_add_u32 m0, s67, 19456
  s_mov_b32 s66, 16768
  buffer_load_dwordx4 v15, s[44:47], s66 offen lds
  s_waitcnt lgkmcnt(0)
  ds_read_b128 v[140:143], v169 offset:0
  ds_read_b64_tr_b16 v[144:145], v7 offset:4096
  ds_read_b64_tr_b16 v[146:147], v7 offset:4608
  ds_read_b64_tr_b16 v[148:149], v7 offset:4160
  ds_read_b64_tr_b16 v[150:151], v7 offset:4672
  ds_read_b64_tr_b16 v[152:153], v7 offset:6144
  ds_read_b64_tr_b16 v[154:155], v7 offset:6656
  ds_read_b64_tr_b16 v[156:157], v7 offset:6208
  ds_read_b64_tr_b16 v[158:159], v7 offset:6720
  v_mfma_f32_32x32x16_bf16 v[16:31], v[116:119], v[112:115], v[16:31]
  v_mfma_f32_32x32x16_bf16 v[32:47], v[120:123], v[112:115], v[32:47]
  v_mfma_f32_32x32x16_bf16 v[48:63], v[124:127], v[112:115], v[48:63]
  v_mfma_f32_32x32x16_bf16 v[64:79], v[128:131], v[112:115], v[64:79]
  s_waitcnt vmcnt(8) lgkmcnt(0)
  s_barrier
  ds_read_b128 v[112:115], v170 offset:0
  ds_read_b64_tr_b16 v[116:117], v7 offset:8192
  ds_read_b64_tr_b16 v[118:119], v7 offset:8704
  ds_read_b64_tr_b16 v[120:121], v7 offset:8256
  ds_read_b64_tr_b16 v[122:123], v7 offset:8768
  ds_read_b64_tr_b16 v[124:125], v7 offset:10240
  ds_read_b64_tr_b16 v[126:127], v7 offset:10752
  ds_read_b64_tr_b16 v[128:129], v7 offset:10304
  ds_read_b64_tr_b16 v[130:131], v7 offset:10816
  v_mfma_f32_32x32x16_bf16 v[16:31], v[144:147], v[140:143], v[16:31]
  v_mfma_f32_32x32x16_bf16 v[32:47], v[148:151], v[140:143], v[32:47]
  v_mfma_f32_32x32x16_bf16 v[48:63], v[152:155], v[140:143], v[48:63]
  v_mfma_f32_32x32x16_bf16 v[64:79], v[156:159], v[140:143], v[64:79]
  s_add_u32 m0, s65, 0
  s_add_u32 s66, s64, 704512
  buffer_load_dwordx4 v8, s[40:43], s66 offen lds
  s_add_u32 m0, s65, 1024
  s_add_u32 s66, s64, 704512
  buffer_load_dwordx4 v9, s[40:43], s66 offen lds
  s_waitcnt lgkmcnt(0)
  ds_read_b128 v[140:143], v171 offset:0
  ds_read_b64_tr_b16 v[144:145], v7 offset:12288
  ds_read_b64_tr_b16 v[146:147], v7 offset:12800
  ds_read_b64_tr_b16 v[148:149], v7 offset:12352
  ds_read_b64_tr_b16 v[150:151], v7 offset:12864
  ds_read_b64_tr_b16 v[152:153], v7 offset:14336
  ds_read_b64_tr_b16 v[154:155], v7 offset:14848
  ds_read_b64_tr_b16 v[156:157], v7 offset:14400
  ds_read_b64_tr_b16 v[158:159], v7 offset:14912
  v_mfma_f32_32x32x16_bf16 v[16:31], v[116:119], v[112:115], v[16:31]
  v_mfma_f32_32x32x16_bf16 v[32:47], v[120:123], v[112:115], v[32:47]
  v_mfma_f32_32x32x16_bf16 v[48:63], v[124:127], v[112:115], v[48:63]
  v_mfma_f32_32x32x16_bf16 v[64:79], v[128:131], v[112:115], v[64:79]
  s_waitcnt vmcnt(2) lgkmcnt(0)
  s_barrier
  ds_read_b128 v[112:115], v168 offset:16384
  ds_read_b64_tr_b16 v[116:117], v7 offset:16384
  ds_read_b64_tr_b16 v[118:119], v7 offset:16896
  ds_read_b64_tr_b16 v[120:121], v7 offset:16448
  ds_read_b64_tr_b16 v[122:123], v7 offset:16960
  ds_read_b64_tr_b16 v[124:125], v7 offset:18432
  ds_read_b64_tr_b16 v[126:127], v7 offset:18944
  ds_read_b64_tr_b16 v[128:129], v7 offset:18496
  ds_read_b64_tr_b16 v[130:131], v7 offset:19008
  v_mfma_f32_32x32x16_bf16 v[16:31], v[144:147], v[140:143], v[16:31]
  v_mfma_f32_32x32x16_bf16 v[32:47], v[148:151], v[140:143], v[32:47]
  v_mfma_f32_32x32x16_bf16 v[48:63], v[152:155], v[140:143], v[48:63]
  v_mfma_f32_32x32x16_bf16 v[64:79], v[156:159], v[140:143], v[64:79]
  s_add_u32 m0, s65, 8192
  s_add_u32 s66, s64, 792576
  buffer_load_dwordx4 v8, s[40:43], s66 offen lds
  s_add_u32 m0, s65, 9216
  s_add_u32 s66, s64, 792576
  buffer_load_dwordx4 v9, s[40:43], s66 offen lds
  s_add_u32 m0, s67, 0
  s_mov_b32 s66, 512
  buffer_load_dwordx4 v14, s[44:47], s66 offen lds
  s_add_u32 m0, s67, 1024
  s_mov_b32 s66, 512
  buffer_load_dwordx4 v15, s[44:47], s66 offen lds
  s_add_u32 m0, s67, 2048
  s_mov_b32 s66, 16896
  buffer_load_dwordx4 v14, s[44:47], s66 offen lds
  s_add_u32 m0, s67, 3072
  s_mov_b32 s66, 16896
  buffer_load_dwordx4 v15, s[44:47], s66 offen lds
  s_waitcnt lgkmcnt(0)
  ds_read_b128 v[140:143], v169 offset:16384
  ds_read_b64_tr_b16 v[144:145], v7 offset:20480
  ds_read_b64_tr_b16 v[146:147], v7 offset:20992
  ds_read_b64_tr_b16 v[148:149], v7 offset:20544
  ds_read_b64_tr_b16 v[150:151], v7 offset:21056
  ds_read_b64_tr_b16 v[152:153], v7 offset:22528
  ds_read_b64_tr_b16 v[154:155], v7 offset:23040
  ds_read_b64_tr_b16 v[156:157], v7 offset:22592
  ds_read_b64_tr_b16 v[158:159], v7 offset:23104
  v_mfma_f32_32x32x16_bf16 v[16:31], v[116:119], v[112:115], v[16:31]
  v_mfma_f32_32x32x16_bf16 v[32:47], v[120:123], v[112:115], v[32:47]
  v_mfma_f32_32x32x16_bf16 v[48:63], v[124:127], v[112:115], v[48:63]
  v_mfma_f32_32x32x16_bf16 v[64:79], v[128:131], v[112:115], v[64:79]
  s_waitcnt vmcnt(8) lgkmcnt(0)
  s_barrier
  ds_read_b128 v[112:115], v170 offset:16384
  ds_read_b64_tr_b16 v[116:117], v7 offset:24576
  ds_read_b64_tr_b16 v[118:119], v7 offset:25088
  ds_read_b64_tr_b16 v[120:121], v7 offset:24640
  ds_read_b64_tr_b16 v[122:123], v7 offset:25152
  ds_read_b64_tr_b16 v[124:125], v7 offset:26624
  ds_read_b64_tr_b16 v[126:127], v7 offset:27136
  ds_read_b64_tr_b16 v[128:129], v7 offset:26688
  ds_read_b64_tr_b16 v[130:131], v7 offset:27200
  v_mfma_f32_32x32x16_bf16 v[16:31], v[144:147], v[140:143], v[16:31]
  v_mfma_f32_32x32x16_bf16 v[32:47], v[148:151], v[140:143], v[32:47]
  v_mfma_f32_32x32x16_bf16 v[48:63], v[152:155], v[140:143], v[48:63]
  v_mfma_f32_32x32x16_bf16 v[64:79], v[156:159], v[140:143], v[64:79]
  s_add_u32 m0, s65, 16384
  s_add_u32 s66, s64, 880640
  buffer_load_dwordx4 v8, s[40:43], s66 offen lds
  s_add_u32 m0, s65, 17408
  s_add_u32 s66, s64, 880640
  buffer_load_dwordx4 v9, s[40:43], s66 offen lds
  s_waitcnt lgkmcnt(0)
  ds_read_b128 v[140:143], v171 offset:16384
  ds_read_b64_tr_b16 v[144:145], v7 offset:28672
  ds_read_b64_tr_b16 v[146:147], v7 offset:29184
  ds_read_b64_tr_b16 v[148:149], v7 offset:28736
  ds_read_b64_tr_b16 v[150:151], v7 offset:29248
  ds_read_b64_tr_b16 v[152:153], v7 offset:30720
  ds_read_b64_tr_b16 v[154:155], v7 offset:31232
  ds_read_b64_tr_b16 v[156:157], v7 offset:30784
  ds_read_b64_tr_b16 v[158:159], v7 offset:31296
  v_mfma_f32_32x32x16_bf16 v[16:31], v[116:119], v[112:115], v[16:31]
  v_mfma_f32_32x32x16_bf16 v[32:47], v[120:123], v[112:115], v[32:47]
  v_mfma_f32_32x32x16_bf16 v[48:63], v[124:127], v[112:115], v[48:63]
  v_mfma_f32_32x32x16_bf16 v[64:79], v[128:131], v[112:115], v[64:79]
  s_waitcnt vmcnt(2) lgkmcnt(0)
  s_barrier
  ds_read_b128 v[112:115], v168 offset:0
  ds_read_b64_tr_b16 v[116:117], v7 offset:0
  ds_read_b64_tr_b16 v[118:119], v7 offset:512
  ds_read_b64_tr_b16 v[120:121], v7 offset:64
  ds_read_b64_tr_b16 v[122:123], v7 offset:576
  ds_read_b64_tr_b16 v[124:125], v7 offset:2048
  ds_read_b64_tr_b16 v[126:127], v7 offset:2560
  ds_read_b64_tr_b16 v[128:129], v7 offset:2112
  ds_read_b64_tr_b16 v[130:131], v7 offset:2624
  v_mfma_f32_32x32x16_bf16 v[16:31], v[144:147], v[140:143], v[16:31]
  v_mfma_f32_32x32x16_bf16 v[32:47], v[148:151], v[140:143], v[32:47]
  v_mfma_f32_32x32x16_bf16 v[48:63], v[152:155], v[140:143], v[48:63]
  v_mfma_f32_32x32x16_bf16 v[64:79], v[156:159], v[140:143], v[64:79]
  s_add_u32 m0, s65, 24576
  s_add_u32 s66, s64, 968704
  buffer_load_dwordx4 v8, s[40:43], s66 offen lds
  s_add_u32 m0, s65, 25600
  s_add_u32 s66, s64, 968704
  buffer_load_dwordx4 v9, s[40:43], s66 offen lds
  s_add_u32 m0, s67, 16384
  s_mov_b32 s66, 640
  buffer_load_dwordx4 v14, s[44:47], s66 offen lds
  s_add_u32 m0, s67, 17408
  s_mov_b32 s66, 640
  buffer_load_dwordx4 v15, s[44:47], s66 offen lds
  s_add_u32 m0, s67, 18432
  s_mov_b32 s66, 17024
  buffer_load_dwordx4 v14, s[44:47], s66 offen lds
  s_add_u32 m0, s67, 19456
  s_mov_b32 s66, 17024
  buffer_load_dwordx4 v15, s[44:47], s66 offen lds
  s_waitcnt lgkmcnt(0)
  ds_read_b128 v[140:143], v169 offset:0
  ds_read_b64_tr_b16 v[144:145], v7 offset:4096
  ds_read_b64_tr_b16 v[146:147], v7 offset:4608
  ds_read_b64_tr_b16 v[148:149], v7 offset:4160
  ds_read_b64_tr_b16 v[150:151], v7 offset:4672
  ds_read_b64_tr_b16 v[152:153], v7 offset:6144
  ds_read_b64_tr_b16 v[154:155], v7 offset:6656
  ds_read_b64_tr_b16 v[156:157], v7 offset:6208
  ds_read_b64_tr_b16 v[158:159], v7 offset:6720
  v_mfma_f32_32x32x16_bf16 v[16:31], v[116:119], v[112:115], v[16:31]
  v_mfma_f32_32x32x16_bf16 v[32:47], v[120:123], v[112:115], v[32:47]
  v_mfma_f32_32x32x16_bf16 v[48:63], v[124:127], v[112:115], v[48:63]
  v_mfma_f32_32x32x16_bf16 v[64:79], v[128:131], v[112:115], v[64:79]
  s_waitcnt vmcnt(8) lgkmcnt(0)
  s_barrier
  ds_read_b128 v[112:115], v170 offset:0
  ds_read_b64_tr_b16 v[116:117], v7 offset:8192
  ds_read_b64_tr_b16 v[118:119], v7 offset:8704
  ds_read_b64_tr_b16 v[120:121], v7 offset:8256
  ds_read_b64_tr_b16 v[122:123], v7 offset:8768
  ds_read_b64_tr_b16 v[124:125], v7 offset:10240
  ds_read_b64_tr_b16 v[126:127], v7 offset:10752
  ds_read_b64_tr_b16 v[128:129], v7 offset:10304
  ds_read_b64_tr_b16 v[130:131], v7 offset:10816
  v_mfma_f32_32x32x16_bf16 v[16:31], v[144:147], v[140:143], v[16:31]
  v_mfma_f32_32x32x16_bf16 v[32:47], v[148:151], v[140:143], v[32:47]
  v_mfma_f32_32x32x16_bf16 v[48:63], v[152:155], v[140:143], v[48:63]
  v_mfma_f32_32x32x16_bf16 v[64:79], v[156:159], v[140:143], v[64:79]
  s_add_u32 m0, s65, 0
  s_add_u32 s66, s64, 1056768
  buffer_load_dwordx4 v8, s[40:43], s66 offen lds
  s_add_u32 m0, s65, 1024
  s_add_u32 s66, s64, 1056768
  buffer_load_dwordx4 v9, s[40:43], s66 offen lds
  s_waitcnt lgkmcnt(0)
  ds_read_b128 v[140:143], v171 offset:0
  ds_read_b64_tr_b16 v[144:145], v7 offset:12288
  ds_read_b64_tr_b16 v[146:147], v7 offset:12800
  ds_read_b64_tr_b16 v[148:149], v7 offset:12352
  ds_read_b64_tr_b16 v[150:151], v7 offset:12864
  ds_read_b64_tr_b16 v[152:153], v7 offset:14336
  ds_read_b64_tr_b16 v[154:155], v7 offset:14848
  ds_read_b64_tr_b16 v[156:157], v7 offset:14400
  ds_read_b64_tr_b16 v[158:159], v7 offset:14912
  v_mfma_f32_32x32x16_bf16 v[16:31], v[116:119], v[112:115], v[16:31]
  v_mfma_f32_32x32x16_bf16 v[32:47], v[120:123], v[112:115], v[32:47]
  v_mfma_f32_32x32x16_bf16 v[48:63], v[124:127], v[112:115], v[48:63]
  v_mfma_f32_32x32x16_bf16 v[64:79], v[128:131], v[112:115], v[64:79]
  s_waitcnt vmcnt(2) lgkmcnt(0)
  s_barrier
  ds_read_b128 v[112:115], v168 offset:16384
  ds_read_b64_tr_b16 v[116:117], v7 offset:16384
  ds_read_b64_tr_b16 v[118:119], v7 offset:16896
  ds_read_b64_tr_b16 v[120:121], v7 offset:16448
  ds_read_b64_tr_b16 v[122:123], v7 offset:16960
  ds_read_b64_tr_b16 v[124:125], v7 offset:18432
  ds_read_b64_tr_b16 v[126:127], v7 offset:18944
  ds_read_b64_tr_b16 v[128:129], v7 offset:18496
  ds_read_b64_tr_b16 v[130:131], v7 offset:19008
  v_mfma_f32_32x32x16_bf16 v[16:31], v[144:147], v[140:143], v[16:31]
  v_mfma_f32_32x32x16_bf16 v[32:47], v[148:151], v[140:143], v[32:47]
  v_mfma_f32_32x32x16_bf16 v[48:63], v[152:155], v[140:143], v[48:63]
  v_mfma_f32_32x32x16_bf16 v[64:79], v[156:159], v[140:143], v[64:79]
  s_add_u32 m0, s65, 8192
  s_add_u32 s66, s64, 1144832
  buffer_load_dwordx4 v8, s[40:43], s66 offen lds
  s_add_u32 m0, s65, 9216
  s_add_u32 s66, s64, 1144832
  buffer_load_dwordx4 v9, s[40:43], s66 offen lds
  s_add_u32 m0, s67, 0
  s_mov_b32 s66, 768
  buffer_load_dwordx4 v14, s[44:47], s66 offen lds
  s_add_u32 m0, s67, 1024
  s_mov_b32 s66, 768
  buffer_load_dwordx4 v15, s[44:47], s66 offen lds
  s_add_u32 m0, s67, 2048
  s_mov_b32 s66, 17152
  buffer_load_dwordx4 v14, s[44:47], s66 offen lds
  s_add_u32 m0, s67, 3072
  s_mov_b32 s66, 17152
  buffer_load_dwordx4 v15, s[44:47], s66 offen lds
  s_waitcnt lgkmcnt(0)
  ds_read_b128 v[140:143], v169 offset:16384
  ds_read_b64_tr_b16 v[144:145], v7 offset:20480
  ds_read_b64_tr_b16 v[146:147], v7 offset:20992
  ds_read_b64_tr_b16 v[148:149], v7 offset:20544
  ds_read_b64_tr_b16 v[150:151], v7 offset:21056
  ds_read_b64_tr_b16 v[152:153], v7 offset:22528
  ds_read_b64_tr_b16 v[154:155], v7 offset:23040
  ds_read_b64_tr_b16 v[156:157], v7 offset:22592
  ds_read_b64_tr_b16 v[158:159], v7 offset:23104
  v_mfma_f32_32x32x16_bf16 v[16:31], v[116:119], v[112:115], v[16:31]
  v_mfma_f32_32x32x16_bf16 v[32:47], v[120:123], v[112:115], v[32:47]
  v_mfma_f32_32x32x16_bf16 v[48:63], v[124:127], v[112:115], v[48:63]
  v_mfma_f32_32x32x16_bf16 v[64:79], v[128:131], v[112:115], v[64:79]
  s_waitcnt vmcnt(8) lgkmcnt(0)
  s_barrier
  ds_read_b128 v[112:115], v170 offset:16384
  ds_read_b64_tr_b16 v[116:117], v7 offset:24576
  ds_read_b64_tr_b16 v[118:119], v7 offset:25088
  ds_read_b64_tr_b16 v[120:121], v7 offset:24640
  ds_read_b64_tr_b16 v[122:123], v7 offset:25152
  ds_read_b64_tr_b16 v[124:125], v7 offset:26624
  ds_read_b64_tr_b16 v[126:127], v7 offset:27136
  ds_read_b64_tr_b16 v[128:129], v7 offset:26688
  ds_read_b64_tr_b16 v[130:131], v7 offset:27200
  v_mfma_f32_32x32x16_bf16 v[16:31], v[144:147], v[140:143], v[16:31]
  v_mfma_f32_32x32x16_bf16 v[32:47], v[148:151], v[140:143], v[32:47]
  v_mfma_f32_32x32x16_bf16 v[48:63], v[152:155], v[140:143], v[48:63]
  v_mfma_f32_32x32x16_bf16 v[64:79], v[156:159], v[140:143], v[64:79]
  s_add_u32 m0, s65, 16384
  s_add_u32 s66, s64, 1232896
  buffer_load_dwordx4 v8, s[40:43], s66 offen lds
  s_add_u32 m0, s65, 17408
  s_add_u32 s66, s64, 1232896
  buffer_load_dwordx4 v9, s[40:43], s66 offen lds
  s_waitcnt lgkmcnt(0)
  ds_read_b128 v[140:143], v171 offset:16384
  ds_read_b64_tr_b16 v[144:145], v7 offset:28672
  ds_read_b64_tr_b16 v[146:147], v7 offset:29184
  ds_read_b64_tr_b16 v[148:149], v7 offset:28736
  ds_read_b64_tr_b16 v[150:151], v7 offset:29248
  ds_read_b64_tr_b16 v[152:153], v7 offset:30720
  ds_read_b64_tr_b16 v[154:155], v7 offset:31232
  ds_read_b64_tr_b16 v[156:157], v7 offset:30784
  ds_read_b64_tr_b16 v[158:159], v7 offset:31296
  v_mfma_f32_32x32x16_bf16 v[16:31], v[116:119], v[112:115], v[16:31]
  v_mfma_f32_32x32x16_bf16 v[32:47], v[120:123], v[112:115], v[32:47]
  v_mfma_f32_32x32x16_bf16 v[48:63], v[124:127], v[112:115], v[48:63]
  v_mfma_f32_32x32x16_bf16 v[64:79], v[128:131], v[112:115], v[64:79]
  s_waitcnt vmcnt(2) lgkmcnt(0)
  s_barrier
  ds_read_b128 v[112:115], v168 offset:0
  ds_read_b64_tr_b16 v[116:117], v7 offset:0
  ds_read_b64_tr_b16 v[118:119], v7 offset:512
  ds_read_b64_tr_b16 v[120:121], v7 offset:64
  ds_read_b64_tr_b16 v[122:123], v7 offset:576
  ds_read_b64_tr_b16 v[124:125], v7 offset:2048
  ds_read_b64_tr_b16 v[126:127], v7 offset:2560
  ds_read_b64_tr_b16 v[128:129], v7 offset:2112
  ds_read_b64_tr_b16 v[130:131], v7 offset:2624
  v_mfma_f32_32x32x16_bf16 v[16:31], v[144:147], v[140:143], v[16:31]
  v_mfma_f32_32x32x16_bf16 v[32:47], v[148:151], v[140:143], v[32:47]
  v_mfma_f32_32x32x16_bf16 v[48:63], v[152:155], v[140:143], v[48:63]
  v_mfma_f32_32x32x16_bf16 v[64:79], v[156:159], v[140:143], v[64:79]
  s_add_u32 m0, s65, 24576
  s_add_u32 s66, s64, 1320960
  buffer_load_dwordx4 v8, s[40:43], s66 offen lds
  s_add_u32 m0, s65, 25600
  s_add_u32 s66, s64, 1320960
  buffer_load_dwordx4 v9, s[40:43], s66 offen lds
  s_add_u32 m0, s67, 16384
  s_mov_b32 s66, 896
  buffer_load_dwordx4 v14, s[44:47], s66 offen lds
  s_add_u32 m0, s67, 17408
  s_mov_b32 s66, 896
  buffer_load_dwordx4 v15, s[44:47], s66 offen lds
  s_add_u32 m0, s67, 18432
  s_mov_b32 s66, 17280
  buffer_load_dwordx4 v14, s[44:47], s66 offen lds
  s_add_u32 m0, s67, 19456
  s_mov_b32 s66, 17280
  buffer_load_dwordx4 v15, s[44:47], s66 offen lds
  s_waitcnt lgkmcnt(0)
  ds_read_b128 v[140:143], v169 offset:0
  ds_read_b64_tr_b16 v[144:145], v7 offset:4096
  ds_read_b64_tr_b16 v[146:147], v7 offset:4608
  ds_read_b64_tr_b16 v[148:149], v7 offset:4160
  ds_read_b64_tr_b16 v[150:151], v7 offset:4672
  ds_read_b64_tr_b16 v[152:153], v7 offset:6144
  ds_read_b64_tr_b16 v[154:155], v7 offset:6656
  ds_read_b64_tr_b16 v[156:157], v7 offset:6208
  ds_read_b64_tr_b16 v[158:159], v7 offset:6720
  v_mfma_f32_32x32x16_bf16 v[16:31], v[116:119], v[112:115], v[16:31]
  v_mfma_f32_32x32x16_bf16 v[32:47], v[120:123], v[112:115], v[32:47]
  v_mfma_f32_32x32x16_bf16 v[48:63], v[124:127], v[112:115], v[48:63]
  v_mfma_f32_32x32x16_bf16 v[64:79], v[128:131], v[112:115], v[64:79]
  s_waitcnt vmcnt(8) lgkmcnt(0)
  s_barrier
  ds_read_b128 v[112:115], v170 offset:0
  ds_read_b64_tr_b16 v[116:117], v7 offset:8192
  ds_read_b64_tr_b16 v[118:119], v7 offset:8704
  ds_read_b64_tr_b16 v[120:121], v7 offset:8256
  ds_read_b64_tr_b16 v[122:123], v7 offset:8768
  ds_read_b64_tr_b16 v[124:125], v7 offset:10240
  ds_read_b64_tr_b16 v[126:127], v7 offset:10752
  ds_read_b64_tr_b16 v[128:129], v7 offset:10304
  ds_read_b64_tr_b16 v[130:131], v7 offset:10816
  v_mfma_f32_32x32x16_bf16 v[16:31], v[144:147], v[140:143], v[16:31]
  v_mfma_f32_32x32x16_bf16 v[32:47], v[148:151], v[140:143], v[32:47]
  v_mfma_f32_32x32x16_bf16 v[48:63], v[152:155], v[140:143], v[48:63]
  v_mfma_f32_32x32x16_bf16 v[64:79], v[156:159], v[140:143], v[64:79]
  s_waitcnt lgkmcnt(0)
  ds_read_b128 v[140:143], v171 offset:0
  ds_read_b64_tr_b16 v[144:145], v7 offset:12288
  ds_read_b64_tr_b16 v[146:147], v7 offset:12800
  ds_read_b64_tr_b16 v[148:149], v7 offset:12352
  ds_read_b64_tr_b16 v[150:151], v7 offset:12864
  ds_read_b64_tr_b16 v[152:153], v7 offset:14336
  ds_read_b64_tr_b16 v[154:155], v7 offset:14848
  ds_read_b64_tr_b16 v[156:157], v7 offset:14400
  ds_read_b64_tr_b16 v[158:159], v7 offset:14912
  v_mfma_f32_32x32x16_bf16 v[16:31], v[116:119], v[112:115], v[16:31]
  v_mfma_f32_32x32x16_bf16 v[32:47], v[120:123], v[112:115], v[32:47]
  v_mfma_f32_32x32x16_bf16 v[48:63], v[124:127], v[112:115], v[48:63]
  v_mfma_f32_32x32x16_bf16 v[64:79], v[128:131], v[112:115], v[64:79]
  s_waitcnt vmcnt(0) lgkmcnt(0)
  s_barrier
  ds_read_b128 v[112:115], v168 offset:16384
  ds_read_b64_tr_b16 v[116:117], v7 offset:16384
  ds_read_b64_tr_b16 v[118:119], v7 offset:16896
  ds_read_b64_tr_b16 v[120:121], v7 offset:16448
  ds_read_b64_tr_b16 v[122:123], v7 offset:16960
  ds_read_b64_tr_b16 v[124:125], v7 offset:18432
  ds_read_b64_tr_b16 v[126:127], v7 offset:18944
  ds_read_b64_tr_b16 v[128:129], v7 offset:18496
  ds_read_b64_tr_b16 v[130:131], v7 offset:19008
  v_mfma_f32_32x32x16_bf16 v[16:31], v[144:147], v[140:143], v[16:31]
  v_mfma_f32_32x32x16_bf16 v[32:47], v[148:151], v[140:143], v[32:47]
  v_mfma_f32_32x32x16_bf16 v[48:63], v[152:155], v[140:143], v[48:63]
  v_mfma_f32_32x32x16_bf16 v[64:79], v[156:159], v[140:143], v[64:79]
  s_waitcnt lgkmcnt(0)
  ds_read_b128 v[140:143], v169 offset:16384
  ds_read_b64_tr_b16 v[144:145], v7 offset:20480
  ds_read_b64_tr_b16 v[146:147], v7 offset:20992
  ds_read_b64_tr_b16 v[148:149], v7 offset:20544
  ds_read_b64_tr_b16 v[150:151], v7 offset:21056
  ds_read_b64_tr_b16 v[152:153], v7 offset:22528
  ds_read_b64_tr_b16 v[154:155], v7 offset:23040
  ds_read_b64_tr_b16 v[156:157], v7 offset:22592
  ds_read_b64_tr_b16 v[158:159], v7 offset:23104
  v_mfma_f32_32x32x16_bf16 v[16:31], v[116:119], v[112:115], v[16:31]
  v_mfma_f32_32x32x16_bf16 v[32:47], v[120:123], v[112:115], v[32:47]
  v_mfma_f32_32x32x16_bf16 v[48:63], v[124:127], v[112:115], v[48:63]
  v_mfma_f32_32x32x16_bf16 v[64:79], v[128:131], v[112:115], v[64:79]
  s_waitcnt vmcnt(0) lgkmcnt(0)
  s_barrier
  ds_read_b128 v[112:115], v170 offset:16384
  ds_read_b64_tr_b16 v[116:117], v7 offset:24576
  ds_read_b64_tr_b16 v[118:119], v7 offset:25088
  ds_read_b64_tr_b16 v[120:121], v7 offset:24640
  ds_read_b64_tr_b16 v[122:123], v7 offset:25152
  ds_read_b64_tr_b16 v[124:125], v7 offset:26624
  ds_read_b64_tr_b16 v[126:127], v7 offset:27136
  ds_read_b64_tr_b16 v[128:129], v7 offset:26688
  ds_read_b64_tr_b16 v[130:131], v7 offset:27200
  v_mfma_f32_32x32x16_bf16 v[16:31], v[144:147], v[140:143], v[16:31]
  v_mfma_f32_32x32x16_bf16 v[32:47], v[148:151], v[140:143], v[32:47]
  v_mfma_f32_32x32x16_bf16 v[48:63], v[152:155], v[140:143], v[48:63]
  v_mfma_f32_32x32x16_bf16 v[64:79], v[156:159], v[140:143], v[64:79]
  s_waitcnt lgkmcnt(0)
  ds_read_b128 v[140:143], v171 offset:16384
  ds_read_b64_tr_b16 v[144:145], v7 offset:28672
  ds_read_b64_tr_b16 v[146:147], v7 offset:29184
  ds_read_b64_tr_b16 v[148:149], v7 offset:28736
  ds_read_b64_tr_b16 v[150:151], v7 offset:29248
  ds_read_b64_tr_b16 v[152:153], v7 offset:30720
  ds_read_b64_tr_b16 v[154:155], v7 offset:31232
  ds_read_b64_tr_b16 v[156:157], v7 offset:30784
  ds_read_b64_tr_b16 v[158:159], v7 offset:31296
  v_mfma_f32_32x32x16_bf16 v[16:31], v[116:119], v[112:115], v[16:31]
  v_mfma_f32_32x32x16_bf16 v[32:47], v[120:123], v[112:115], v[32:47]
  v_mfma_f32_32x32x16_bf16 v[48:63], v[124:127], v[112:115], v[48:63]
  v_mfma_f32_32x32x16_bf16 v[64:79], v[128:131], v[112:115], v[64:79]
  s_waitcnt lgkmcnt(0)
  v_mfma_f32_32x32x16_bf16 v[16:31], v[144:147], v[140:143], v[16:31]
  v_mfma_f32_32x32x16_bf16 v[32:47], v[148:151], v[140:143], v[32:47]
  v_mfma_f32_32x32x16_bf16 v[48:63], v[152:155], v[140:143], v[48:63]
  v_mfma_f32_32x32x16_bf16 v[64:79], v[156:159], v[140:143], v[64:79]
  s_setprio 3
  s_nop 7
  v_mul_f32 v112, 0xbfb8aa3b, v16
  v_mul_f32 v113, 0xbfb8aa3b, v17
  v_mul_f32 v114, 0xbfb8aa3b, v18
  v_mul_f32 v115, 0xbfb8aa3b, v19
  v_mul_f32 v116, 0xbfb8aa3b, v20
  v_mul_f32 v117, 0xbfb8aa3b, v21
  v_mul_f32 v118, 0xbfb8aa3b, v22
  v_mul_f32 v119, 0xbfb8aa3b, v23
  v_mul_f32 v120, 0xbfb8aa3b, v24
  v_mul_f32 v121, 0xbfb8aa3b, v25
  v_mul_f32 v122, 0xbfb8aa3b, v26
  v_mul_f32 v123, 0xbfb8aa3b, v27
  v_mul_f32 v124, 0xbfb8aa3b, v28
  v_mul_f32 v125, 0xbfb8aa3b, v29
  v_mul_f32 v126, 0xbfb8aa3b, v30
  v_mul_f32 v127, 0xbfb8aa3b, v31
  v_exp_f32 v112, v112
  v_exp_f32 v113, v113
  v_exp_f32 v114, v114
  v_exp_f32 v115, v115
  v_exp_f32 v116, v116
  v_exp_f32 v117, v117
  v_exp_f32 v118, v118
  v_exp_f32 v119, v119
  v_exp_f32 v120, v120
  v_exp_f32 v121, v121
  v_exp_f32 v122, v122
  v_exp_f32 v123, v123
  v_exp_f32 v124, v124
  v_exp_f32 v125, v125
  v_exp_f32 v126, v126
  v_exp_f32 v127, v127
  v_mul_f32 v16, v16, v48
  v_mul_f32 v17, v17, v49
  v_mul_f32 v18, v18, v50
  v_mul_f32 v19, v19, v51
  v_mul_f32 v20, v20, v52
  v_mul_f32 v21, v21, v53
  v_mul_f32 v22, v22, v54
  v_mul_f32 v23, v23, v55
  v_mul_f32 v24, v24, v56
  v_mul_f32 v25, v25, v57
  v_mul_f32 v26, v26, v58
  v_mul_f32 v27, v27, v59
  v_mul_f32 v28, v28, v60
  v_mul_f32 v29, v29, v61
  v_mul_f32 v30, v30, v62
  v_mul_f32 v31, v31, v63
  v_add_f32 v112, 1.0, v112
  v_add_f32 v113, 1.0, v113
  v_add_f32 v114, 1.0, v114
  v_add_f32 v115, 1.0, v115
  v_add_f32 v116, 1.0, v116
  v_add_f32 v117, 1.0, v117
  v_add_f32 v118, 1.0, v118
  v_add_f32 v119, 1.0, v119
  v_add_f32 v120, 1.0, v120
  v_add_f32 v121, 1.0, v121
  v_add_f32 v122, 1.0, v122
  v_add_f32 v123, 1.0, v123
  v_add_f32 v124, 1.0, v124
  v_add_f32 v125, 1.0, v125
  v_add_f32 v126, 1.0, v126
  v_add_f32 v127, 1.0, v127
  v_rcp_f32 v112, v112
  v_rcp_f32 v113, v113
  v_rcp_f32 v114, v114
  v_rcp_f32 v115, v115
  v_rcp_f32 v116, v116
  v_rcp_f32 v117, v117
  v_rcp_f32 v118, v118
  v_rcp_f32 v119, v119
  v_rcp_f32 v120, v120
  v_rcp_f32 v121, v121
  v_rcp_f32 v122, v122
  v_rcp_f32 v123, v123
  v_rcp_f32 v124, v124
  v_rcp_f32 v125, v125
  v_rcp_f32 v126, v126
  v_rcp_f32 v127, v127
  v_mul_f32 v16, v16, v112
  v_mul_f32 v17, v17, v113
  v_mul_f32 v18, v18, v114
  v_mul_f32 v19, v19, v115
  v_mul_f32 v20, v20, v116
  v_mul_f32 v21, v21, v117
  v_mul_f32 v22, v22, v118
  v_mul_f32 v23, v23, v119
  v_mul_f32 v24, v24, v120
  v_mul_f32 v25, v25, v121
  v_mul_f32 v26, v26, v122
  v_mul_f32 v27, v27, v123
  v_mul_f32 v28, v28, v124
  v_mul_f32 v29, v29, v125
  v_mul_f32 v30, v30, v126
  v_mul_f32 v31, v31, v127
  v_cvt_pk_bf16_f32 v48, v16, v17
  v_cvt_pk_bf16_f32 v49, v18, v19
  v_cvt_pk_bf16_f32 v50, v20, v21
  v_cvt_pk_bf16_f32 v51, v22, v23
  v_cvt_pk_bf16_f32 v52, v24, v25
  v_cvt_pk_bf16_f32 v53, v26, v27
  v_cvt_pk_bf16_f32 v54, v28, v29
  v_cvt_pk_bf16_f32 v55, v30, v31
  s_mul_i32 s66, s63, 86
  s_lshl_b32 s68, s62, 1
  s_add_u32 s66, s66, s68
  s_lshl_b32 s66, s66, 10
  s_add_u32 s66, s66, 8388608
  buffer_store_dwordx4 v[48:51], v5, s[48:51], s66 offen sc0 sc1
  buffer_store_dwordx4 v[52:55], v5, s[48:51], s66 offen offset:1024 sc0 sc1
  v_mul_f32 v112, 0xbfb8aa3b, v32
  v_mul_f32 v113, 0xbfb8aa3b, v33
  v_mul_f32 v114, 0xbfb8aa3b, v34
  v_mul_f32 v115, 0xbfb8aa3b, v35
  v_mul_f32 v116, 0xbfb8aa3b, v36
  v_mul_f32 v117, 0xbfb8aa3b, v37
  v_mul_f32 v118, 0xbfb8aa3b, v38
  v_mul_f32 v119, 0xbfb8aa3b, v39
  v_mul_f32 v120, 0xbfb8aa3b, v40
  v_mul_f32 v121, 0xbfb8aa3b, v41
  v_mul_f32 v122, 0xbfb8aa3b, v42
  v_mul_f32 v123, 0xbfb8aa3b, v43
  v_mul_f32 v124, 0xbfb8aa3b, v44
  v_mul_f32 v125, 0xbfb8aa3b, v45
  v_mul_f32 v126, 0xbfb8aa3b, v46
  v_mul_f32 v127, 0xbfb8aa3b, v47
  v_exp_f32 v112, v112
  v_exp_f32 v113, v113
  v_exp_f32 v114, v114
  v_exp_f32 v115, v115
  v_exp_f32 v116, v116
  v_exp_f32 v117, v117
  v_exp_f32 v118, v118
  v_exp_f32 v119, v119
  v_exp_f32 v120, v120
  v_exp_f32 v121, v121
  v_exp_f32 v122, v122
  v_exp_f32 v123, v123
  v_exp_f32 v124, v124
  v_exp_f32 v125, v125
  v_exp_f32 v126, v126
  v_exp_f32 v127, v127
  v_mul_f32 v32, v32, v64
  v_mul_f32 v33, v33, v65
  v_mul_f32 v34, v34, v66
  v_mul_f32 v35, v35, v67
  v_mul_f32 v36, v36, v68
  v_mul_f32 v37, v37, v69
  v_mul_f32 v38, v38, v70
  v_mul_f32 v39, v39, v71
  v_mul_f32 v40, v40, v72
  v_mul_f32 v41, v41, v73
  v_mul_f32 v42, v42, v74
  v_mul_f32 v43, v43, v75
  v_mul_f32 v44, v44, v76
  v_mul_f32 v45, v45, v77
  v_mul_f32 v46, v46, v78
  v_mul_f32 v47, v47, v79
  v_add_f32 v112, 1.0, v112
  v_add_f32 v113, 1.0, v113
  v_add_f32 v114, 1.0, v114
  v_add_f32 v115, 1.0, v115
  v_add_f32 v116, 1.0, v116
  v_add_f32 v117, 1.0, v117
  v_add_f32 v118, 1.0, v118
  v_add_f32 v119, 1.0, v119
  v_add_f32 v120, 1.0, v120
  v_add_f32 v121, 1.0, v121
  v_add_f32 v122, 1.0, v122
  v_add_f32 v123, 1.0, v123
  v_add_f32 v124, 1.0, v124
  v_add_f32 v125, 1.0, v125
  v_add_f32 v126, 1.0, v126
  v_add_f32 v127, 1.0, v127
  v_rcp_f32 v112, v112
  v_rcp_f32 v113, v113
  v_rcp_f32 v114, v114
  v_rcp_f32 v115, v115
  v_rcp_f32 v116, v116
  v_rcp_f32 v117, v117
  v_rcp_f32 v118, v118
  v_rcp_f32 v119, v119
  v_rcp_f32 v120, v120
  v_rcp_f32 v121, v121
  v_rcp_f32 v122, v122
  v_rcp_f32 v123, v123
  v_rcp_f32 v124, v124
  v_rcp_f32 v125, v125
  v_rcp_f32 v126, v126
  v_rcp_f32 v127, v127
  v_mul_f32 v32, v32, v112
  v_mul_f32 v33, v33, v113
  v_mul_f32 v34, v34, v114
  v_mul_f32 v35, v35, v115
  v_mul_f32 v36, v36, v116
  v_mul_f32 v37, v37, v117
  v_mul_f32 v38, v38, v118
  v_mul_f32 v39, v39, v119
  v_mul_f32 v40, v40, v120
  v_mul_f32 v41, v41, v121
  v_mul_f32 v42, v42, v122
  v_mul_f32 v43, v43, v123
  v_mul_f32 v44, v44, v124
  v_mul_f32 v45, v45, v125
  v_mul_f32 v46, v46, v126
  v_mul_f32 v47, v47, v127
  v_cvt_pk_bf16_f32 v64, v32, v33
  v_cvt_pk_bf16_f32 v65, v34, v35
  v_cvt_pk_bf16_f32 v66, v36, v37
  v_cvt_pk_bf16_f32 v67, v38, v39
  v_cvt_pk_bf16_f32 v68, v40, v41
  v_cvt_pk_bf16_f32 v69, v42, v43
  v_cvt_pk_bf16_f32 v70, v44, v45
  v_cvt_pk_bf16_f32 v71, v46, v47
  s_add_u32 s66, s66, 2048
  buffer_store_dwordx4 v[64:67], v5, s[48:51], s66 offen sc0 sc1
  buffer_store_dwordx4 v[68:71], v5, s[48:51], s66 offen offset:1024 sc0 sc1
k2_mix_kernel_U_updone:
  s_lshl_b32 s59, s61, 7
  s_add_u32 s59, s59, 20987904
  s_waitcnt vmcnt(0)
  s_barrier
  s_cmp_lg_u32 s60, 0
  s_cbranch_scc1 k2_mix_kernel_S_nosig
  v_mov_b32 v6, 0
  v_mov_b32 v7, 1
  s_mov_b64 exec, 1
  buffer_atomic_add v7, v6, s[48:51], s59 offen sc1
  s_mov_b64 exec, -1
k2_mix_kernel_S_nosig:
  s_and_b32 s3, s56, 7
  s_lshl_b32 s3, s3, 2
  s_lshr_b32 s55, s56, 3
  s_and_b32 s55, s55, 3
  s_add_u32 s3, s3, s55
  s_lshr_b32 s55, s3, 2
  s_lshr_b32 s3, s3, 1
  s_lshl_b32 s59, s3, 7
  s_add_u32 s59, s59, 20987904
  s_lshl_b32 s3, s55, 7
  s_add_u32 s3, s3, 20989952
  s_and_b32 s61, s56, 7
  s_lshl_b32 s61, s61, 2
  s_lshr_b32 s62, s56, 3
  s_and_b32 s62, s62, 3
  s_add_u32 s61, s61, s62
  s_lshr_b32 s62, s56, 5
  s_mov_b32 s48, s34
  s_mov_b32 s49, s35
  s_mov_b32 s50, 0x1600000
  s_mov_b32 s51, 0x20000
  s_mov_b32 s40, s28
  s_mov_b32 s41, s29
  s_mov_b32 s42, 0x158000
  s_mov_b32 s43, 0x20000
  s_mov_b32 s44, s20
  s_mov_b32 s45, s21
  s_mov_b32 s46, 0x80000
  s_mov_b32 s47, 0x20000
  s_mov_b32 s52, s32
  s_mov_b32 s53, s33
  s_mov_b32 s54, 0x200000
  s_mov_b32 s55, 0x20000
  s_mul_i32 s63, s60, 22
  s_cmp_eq_u32 s60, 3
  s_cselect_b32 s64, 1, 0
  s_sub_u32 s63, s63, s64
  s_mul_i32 s64, s61, 172
  s_add_u32 s64, s64, s63
  s_lshl_b32 s64, s64, 10
  s_add_u32 s64, s64, 8388608
  s_add_u32 s65, s64, 88064
  s_lshl_b32 s66, s63, 14
  s_lshl_b32 s67, s62, 7
  s_add_u32 s66, s66, s67
  s_lshl_b32 s4, s60, 17
  s_add_u32 s4, s4, s67
  s_lshl_b32 s5, s61, 6
  s_lshl_b32 s6, s60, 3
  s_add_u32 s5, s5, s6
  s_lshl_b32 s5, s5, 10
  s_add_u32 s5, s5, 14680064
  s_add_u32 s6, s5, 0x8000
  s_lshl_b32 s7, s61, 8
  s_add_u32 s7, s7, 20979712
  s_lshl_b32 s67, s60, 14
  v_lshrrev_b32 v6, 3, v1
  v_and_b32 v7, 7, v1
  v_lshrrev_b32 v8, 1, v6
  v_and_b32 v8, 1, v8
  v_lshlrev_b32 v8, 2, v8
  v_xor_b32 v7, v7, v8
  v_lshlrev_b32 v7, 4, v7
  v_lshlrev_b32 v6, 10, v6
  v_add_u32 v8, v6, v7
  s_add_u32 m0, s67, 0
  s_add_u32 s68, s66, 0
  buffer_load_dwordx4 v8, s[40:43], s68 offen lds
  s_add_u32 m0, s67, 1024
  s_add_u32 s68, s66, 8192
  buffer_load_dwordx4 v8, s[40:43], s68 offen lds
  s_add_u32 m0, s67, 2048
  s_add_u32 s68, s66, 16384
  buffer_load_dwordx4 v8, s[40:43], s68 offen lds
  s_add_u32 m0, s67, 3072
  s_add_u32 s68, s66, 24576
  buffer_load_dwordx4 v8, s[40:43], s68 offen lds
  s_add_u32 m0, s67, 4096
  s_add_u32 s68, s66, 32768
  buffer_load_dwordx4 v8, s[40:43], s68 offen lds
  s_add_u32 m0, s67, 5120
  s_add_u32 s68, s66, 40960
  buffer_load_dwordx4 v8, s[40:43], s68 offen lds
  s_add_u32 m0, s67, 6144
  s_add_u32 s68, s66, 49152
  buffer_load_dwordx4 v8, s[40:43], s68 offen lds
  s_add_u32 m0, s67, 7168
  s_add_u32 s68, s66, 57344
  buffer_load_dwordx4 v8, s[40:43], s68 offen lds
  s_add_u32 m0, s67, 8192
  s_add_u32 s68, s66, 65536
  buffer_load_dwordx4 v8, s[40:43], s68 offen lds
  s_add_u32 m0, s67, 9216
  s_add_u32 s68, s66, 73728
  buffer_load_dwordx4 v8, s[40:43], s68 offen lds
  s_add_u32 m0, s67, 10240
  s_add_u32 s68, s66, 81920
  buffer_load_dwordx4 v8, s[40:43], s68 offen lds
  s_add_u32 m0, s67, 11264
  s_add_u32 s68, s66, 90112
  buffer_load_dwordx4 v8, s[40:43], s68 offen lds
  s_add_u32 m0, s67, 12288
  s_add_u32 s68, s66, 98304
  buffer_load_dwordx4 v8, s[40:43], s68 offen lds
  s_add_u32 m0, s67, 13312
  s_add_u32 s68, s66, 106496
  buffer_load_dwordx4 v8, s[40:43], s68 offen lds
  s_add_u32 m0, s67, 14336
  s_add_u32 s68, s66, 114688
  buffer_load_dwordx4 v8, s[40:43], s68 offen lds
  s_add_u32 m0, s67, 15360
  s_add_u32 s68, s66, 122880
  buffer_load_dwordx4 v8, s[40:43], s68 offen lds
  v_lshrrev_b32 v6, 4, v1
  v_and_b32 v7, 15, v1
  v_lshrrev_b32 v9, 2, v7
  v_and_b32 v10, 3, v7
  v_lshrrev_b32 v11, 1, v6
  v_lshlrev_b32 v11, 2, v11
  v_add_u32 v11, v11, v9
  v_lshlrev_b32 v11, 7, v11
  v_and_b32 v12, 1, v10
  v_lshlrev_b32 v12, 5, v12
  v_add_u32 v11, v11, v12
  v_and_b32 v12, 1, v6
  v_lshlrev_b32 v12, 4, v12
  v_add_u32 v11, v11, v12
  v_lshrrev_b32 v12, 1, v10
  v_lshlrev_b32 v12, 3, v12
  v_add_u32 v11, v11, v12
  v_lshrrev_b32 v12, 1, v9
  v_lshlrev_b32 v12, 6, v12
  v_add_u32 v11, v11, v12
  v_add_u32 v11, s67, v11
  v_xor_b32 v12, 64, v11
  s_cmp_lg_u32 s60, 0
  s_cbranch_scc1 k2_mix_kernel_W_wdone
  v_mov_b32 v6, 0
  s_mov_b32 s58, 0
k2_mix_kernel_W_poll:
  buffer_load_dword v7, v6, s[48:51], s59 offen sc0 sc1
  s_waitcnt vmcnt(0)
  v_readfirstlane_b32 s57, v7
  s_nop 3
  s_cmp_ge_u32 s57, 16
  s_cbranch_scc1 k2_mix_kernel_W_wdone
  s_add_u32 s58, s58, 1
  s_cmp_lt_u32 s58, 65536
  s_cbranch_scc1 k2_mix_kernel_W_poll
k2_mix_kernel_W_wdone:
  s_barrier
  s_add_u32 s68, s64, 0
  buffer_load_dwordx4 v[80:83], v5, s[48:51], s68 offen sc0 sc1
  s_add_u32 s68, s65, 0
  buffer_load_dwordx4 v[84:87], v5, s[48:51], s68 offen sc0 sc1
  s_add_u32 s68, s64, 1024
  buffer_load_dwordx4 v[88:91], v5, s[48:51], s68 offen sc0 sc1
  s_add_u32 s68, s65, 1024
  buffer_load_dwordx4 v[92:95], v5, s[48:51], s68 offen sc0 sc1
  s_add_u32 s68, s64, 2048
  buffer_load_dwordx4 v[96:99], v5, s[48:51], s68 offen sc0 sc1
  s_add_u32 s68, s65, 2048
  buffer_load_dwordx4 v[100:103], v5, s[48:51], s68 offen sc0 sc1
  s_add_u32 s68, s64, 3072
  buffer_load_dwordx4 v[104:107], v5, s[48:51], s68 offen sc0 sc1
  s_add_u32 s68, s65, 3072
  buffer_load_dwordx4 v[108:111], v5, s[48:51], s68 offen sc0 sc1
  s_add_u32 s68, s64, 4096
  buffer_load_dwordx4 v[112:115], v5, s[48:51], s68 offen sc0 sc1
  s_add_u32 s68, s65, 4096
  buffer_load_dwordx4 v[116:119], v5, s[48:51], s68 offen sc0 sc1
  s_add_u32 s68, s64, 5120
  buffer_load_dwordx4 v[120:123], v5, s[48:51], s68 offen sc0 sc1
  s_add_u32 s68, s65, 5120
  buffer_load_dwordx4 v[124:127], v5, s[48:51], s68 offen sc0 sc1
  s_add_u32 s68, s64, 6144
  buffer_load_dwordx4 v[128:131], v5, s[48:51], s68 offen sc0 sc1
  s_add_u32 s68, s65, 6144
  buffer_load_dwordx4 v[132:135], v5, s[48:51], s68 offen sc0 sc1
  s_add_u32 s68, s64, 7168
  buffer_load_dwordx4 v[136:139], v5, s[48:51], s68 offen sc0 sc1
  s_add_u32 s68, s65, 7168
  buffer_load_dwordx4 v[140:143], v5, s[48:51], s68 offen sc0 sc1
  s_setprio 1
  s_waitcnt vmcnt(14)
  ds_read_b64_tr_b16 v[144:145], v11 offset:0
  ds_read_b64_tr_b16 v[146:147], v11 offset:1024
  ds_read_b64_tr_b16 v[148:149], v12 offset:0
  ds_read_b64_tr_b16 v[150:151], v12 offset:1024
  s_waitcnt vmcnt(12)
  ds_read_b64_tr_b16 v[152:153], v11 offset:2048
  ds_read_b64_tr_b16 v[154:155], v11 offset:3072
  ds_read_b64_tr_b16 v[156:157], v12 offset:2048
  ds_read_b64_tr_b16 v[158:159], v12 offset:3072
  s_waitcnt lgkmcnt(4)
  v_mfma_f32_32x32x16_bf16 v[16:31], v[144:147], v[80:83], 0
  v_mfma_f32_32x32x16_bf16 v[32:47], v[144:147], v[84:87], 0
  v_mfma_f32_32x32x16_bf16 v[48:63], v[148:151], v[80:83], 0
  v_mfma_f32_32x32x16_bf16 v[64:79], v[148:151], v[84:87], 0
  s_add_u32 m0, s67, 0
  s_add_u32 s68, s66, 131072
  buffer_load_dwordx4 v8, s[40:43], s68 offen lds
  s_add_u32 m0, s67, 1024
  s_add_u32 s68, s66, 139264
  buffer_load_dwordx4 v8, s[40:43], s68 offen lds
  s_add_u32 s68, s64, 8192
  buffer_load_dwordx4 v[80:83], v5, s[48:51], s68 offen sc0 sc1
  s_add_u32 s68, s65, 8192
  buffer_load_dwordx4 v[84:87], v5, s[48:51], s68 offen sc0 sc1
  s_waitcnt vmcnt(14)
  ds_read_b64_tr_b16 v[144:145], v11 offset:4096
  ds_read_b64_tr_b16 v[146:147], v11 offset:5120
  ds_read_b64_tr_b16 v[148:149], v12 offset:4096
  ds_read_b64_tr_b16 v[150:151], v12 offset:5120
  s_waitcnt lgkmcnt(4)
  v_mfma_f32_32x32x16_bf16 v[16:31], v[152:155], v[88:91], v[16:31]
  v_mfma_f32_32x32x16_bf16 v[32:47], v[152:155], v[92:95], v[32:47]
  v_mfma_f32_32x32x16_bf16 v[48:63], v[156:159], v[88:91], v[48:63]
  v_mfma_f32_32x32x16_bf16 v[64:79], v[156:159], v[92:95], v[64:79]
  s_add_u32 m0, s67, 2048
  s_add_u32 s68, s66, 147456
  buffer_load_dwordx4 v8, s[40:43], s68 offen lds
  s_add_u32 m0, s67, 3072
  s_add_u32 s68, s66, 155648
  buffer_load_dwordx4 v8, s[40:43], s68 offen lds
  s_add_u32 s68, s64, 9216
  buffer_load_dwordx4 v[88:91], v5, s[48:51], s68 offen sc0 sc1
  s_add_u32 s68, s65, 9216
  buffer_load_dwordx4 v[92:95], v5, s[48:51], s68 offen sc0 sc1
  s_waitcnt vmcnt(16)
  ds_read_b64_tr_b16 v[152:153], v11 offset:6144
  ds_read_b64_tr_b16 v[154:155], v11 offset:7168
  ds_read_b64_tr_b16 v[156:157], v12 offset:6144
  ds_read_b64_tr_b16 v[158:159], v12 offset:7168
  s_waitcnt lgkmcnt(4)
  v_mfma_f32_32x32x16_bf16 v[16:31], v[144:147], v[96:99], v[16:31]
  v_mfma_f32_32x32x16_bf16 v[32:47], v[144:147], v[100:103], v[32:47]
  v_mfma_f32_32x32x16_bf16 v[48:63], v[148:151], v[96:99], v[48:63]
  v_mfma_f32_32x32x16_bf16 v[64:79], v[148:151], v[100:103], v[64:79]
  s_add_u32 m0, s67, 4096
  s_add_u32 s68, s66, 163840
  buffer_load_dwordx4 v8, s[40:43], s68 offen lds
  s_add_u32 m0, s67, 5120
  s_add_u32 s68, s66, 172032
  buffer_load_dwordx4 v8, s[40:43], s68 offen lds
  s_add_u32 s68, s64, 10240
  buffer_load_dwordx4 v[96:99], v5, s[48:51], s68 offen sc0 sc1
  s_add_u32 s68, s65, 10240
  buffer_load_dwordx4 v[100:103], v5, s[48:51], s68 offen sc0 sc1
  s_waitcnt vmcnt(18)
  ds_read_b64_tr_b16 v[144:145], v11 offset:8192
  ds_read_b64_tr_b16 v[146:147], v11 offset:9216
  ds_read_b64_tr_b16 v[148:149], v12 offset:8192
  ds_read_b64_tr_b16 v[150:151], v12 offset:9216
  s_waitcnt lgkmcnt(4)
  v_mfma_f32_32x32x16_bf16 v[16:31], v[152:155], v[104:107], v[16:31]
  v_mfma_f32_32x32x16_bf16 v[32:47], v[152:155], v[108:111], v[32:47]
  v_mfma_f32_32x32x16_bf16 v[48:63], v[156:159], v[104:107], v[48:63]
  v_mfma_f32_32x32x16_bf16 v[64:79], v[156:159], v[108:111], v[64:79]
  s_add_u32 m0, s67, 6144
  s_add_u32 s68, s66, 180224
  buffer_load_dwordx4 v8, s[40:43], s68 offen lds
  s_add_u32 m0, s67, 7168
  s_add_u32 s68, s66, 188416
  buffer_load_dwordx4 v8, s[40:43], s68 offen lds
  s_add_u32 s68, s64, 11264
  buffer_load_dwordx4 v[104:107], v5, s[48:51], s68 offen sc0 sc1
  s_add_u32 s68, s65, 11264
  buffer_load_dwordx4 v[108:111], v5, s[48:51], s68 offen sc0 sc1
  s_waitcnt vmcnt(20)
  ds_read_b64_tr_b16 v[152:153], v11 offset:10240
  ds_read_b64_tr_b16 v[154:155], v11 offset:11264
  ds_read_b64_tr_b16 v[156:157], v12 offset:10240
  ds_read_b64_tr_b16 v[158:159], v12 offset:11264
  s_waitcnt lgkmcnt(4)
  v_mfma_f32_32x32x16_bf16 v[16:31], v[144:147], v[112:115], v[16:31]
  v_mfma_f32_32x32x16_bf16 v[32:47], v[144:147], v[116:119], v[32:47]
  v_mfma_f32_32x32x16_bf16 v[48:63], v[148:151], v[112:115], v[48:63]
  v_mfma_f32_32x32x16_bf16 v[64:79], v[148:151], v[116:119], v[64:79]
  s_add_u32 m0, s67, 8192
  s_add_u32 s68, s66, 196608
  buffer_load_dwordx4 v8, s[40:43], s68 offen lds
  s_add_u32 m0, s67, 9216
  s_add_u32 s68, s66, 204800
  buffer_load_dwordx4 v8, s[40:43], s68 offen lds
  s_add_u32 s68, s64, 12288
  buffer_load_dwordx4 v[112:115], v5, s[48:51], s68 offen sc0 sc1
  s_add_u32 s68, s65, 12288
  buffer_load_dwordx4 v[116:119], v5, s[48:51], s68 offen sc0 sc1
  s_waitcnt vmcnt(22)
  ds_read_b64_tr_b16 v[144:145], v11 offset:12288
  ds_read_b64_tr_b16 v[146:147], v11 offset:13312
  ds_read_b64_tr_b16 v[148:149], v12 offset:12288
  ds_read_b64_tr_b16 v[150:151], v12 offset:13312
  s_waitcnt lgkmcnt(4)
  v_mfma_f32_32x32x16_bf16 v[16:31], v[152:155], v[120:123], v[16:31]
  v_mfma_f32_32x32x16_bf16 v[32:47], v[152:155], v[124:127], v[32:47]
  v_mfma_f32_32x32x16_bf16 v[48:63], v[156:159], v[120:123], v[48:63]
  v_mfma_f32_32x32x16_bf16 v[64:79], v[156:159], v[124:127], v[64:79]
  s_add_u32 m0, s67, 10240
  s_add_u32 s68, s66, 212992
  buffer_load_dwordx4 v8, s[40:43], s68 offen lds
  s_add_u32 m0, s67, 11264
  s_add_u32 s68, s66, 221184
  buffer_load_dwordx4 v8, s[40:43], s68 offen lds
  s_add_u32 s68, s64, 13312
  buffer_load_dwordx4 v[120:123], v5, s[48:51], s68 offen sc0 sc1
  s_add_u32 s68, s65, 13312
  buffer_load_dwordx4 v[124:127], v5, s[48:51], s68 offen sc0 sc1
  s_waitcnt vmcnt(24)
  ds_read_b64_tr_b16 v[152:153], v11 offset:14336
  ds_read_b64_tr_b16 v[154:155], v11 offset:15360
  ds_read_b64_tr_b16 v[156:157], v12 offset:14336
  ds_read_b64_tr_b16 v[158:159], v12 offset:15360
  s_waitcnt lgkmcnt(4)
  v_mfma_f32_32x32x16_bf16 v[16:31], v[144:147], v[128:131], v[16:31]
  v_mfma_f32_32x32x16_bf16 v[32:47], v[144:147], v[132:135], v[32:47]
  v_mfma_f32_32x32x16_bf16 v[48:63], v[148:151], v[128:131], v[48:63]
  v_mfma_f32_32x32x16_bf16 v[64:79], v[148:151], v[132:135], v[64:79]
  s_add_u32 m0, s67, 12288
  s_add_u32 s68, s66, 229376
  buffer_load_dwordx4 v8, s[40:43], s68 offen lds
  s_add_u32 m0, s67, 13312
  s_add_u32 s68, s66, 237568
  buffer_load_dwordx4 v8, s[40:43], s68 offen lds
  s_add_u32 s68, s64, 14336
  buffer_load_dwordx4 v[128:131], v5, s[48:51], s68 offen sc0 sc1
  s_add_u32 s68, s65, 14336
  buffer_load_dwordx4 v[132:135], v5, s[48:51], s68 offen sc0 sc1
  s_waitcnt vmcnt(24)
  ds_read_b64_tr_b16 v[144:145], v11 offset:0
  ds_read_b64_tr_b16 v[146:147], v11 offset:1024
  ds_read_b64_tr_b16 v[148:149], v12 offset:0
  ds_read_b64_tr_b16 v[150:151], v12 offset:1024
  s_waitcnt lgkmcnt(4)
  v_mfma_f32_32x32x16_bf16 v[16:31], v[152:155], v[136:139], v[16:31]
  v_mfma_f32_32x32x16_bf16 v[32:47], v[152:155], v[140:143], v[32:47]
  v_mfma_f32_32x32x16_bf16 v[48:63], v[156:159], v[136:139], v[48:63]
  v_mfma_f32_32x32x16_bf16 v[64:79], v[156:159], v[140:143], v[64:79]
  s_add_u32 m0, s67, 14336
  s_add_u32 s68, s66, 245760
  buffer_load_dwordx4 v8, s[40:43], s68 offen lds
  s_add_u32 m0, s67, 15360
  s_add_u32 s68, s66, 253952
  buffer_load_dwordx4 v8, s[40:43], s68 offen lds
  s_add_u32 s68, s64, 15360
  buffer_load_dwordx4 v[136:139], v5, s[48:51], s68 offen sc0 sc1
  s_add_u32 s68, s65, 15360
  buffer_load_dwordx4 v[140:143], v5, s[48:51], s68 offen sc0 sc1
  s_waitcnt vmcnt(24)
  ds_read_b64_tr_b16 v[152:153], v11 offset:2048
  ds_read_b64_tr_b16 v[154:155], v11 offset:3072
  ds_read_b64_tr_b16 v[156:157], v12 offset:2048
  ds_read_b64_tr_b16 v[158:159], v12 offset:3072
  s_waitcnt lgkmcnt(4)
  v_mfma_f32_32x32x16_bf16 v[16:31], v[144:147], v[80:83], v[16:31]
  v_mfma_f32_32x32x16_bf16 v[32:47], v[144:147], v[84:87], v[32:47]
  v_mfma_f32_32x32x16_bf16 v[48:63], v[148:151], v[80:83], v[48:63]
  v_mfma_f32_32x32x16_bf16 v[64:79], v[148:151], v[84:87], v[64:79]
  s_add_u32 m0, s67, 0
  s_add_u32 s68, s66, 262144
  buffer_load_dwordx4 v8, s[40:43], s68 offen lds
  s_add_u32 m0, s67, 1024
  s_add_u32 s68, s66, 270336
  buffer_load_dwordx4 v8, s[40:43], s68 offen lds
  s_add_u32 s68, s64, 16384
  buffer_load_dwordx4 v[80:83], v5, s[48:51], s68 offen sc0 sc1
  s_add_u32 s68, s65, 16384
  buffer_load_dwordx4 v[84:87], v5, s[48:51], s68 offen sc0 sc1
  s_waitcnt vmcnt(24)
  ds_read_b64_tr_b16 v[144:145], v11 offset:4096
  ds_read_b64_tr_b16 v[146:147], v11 offset:5120
  ds_read_b64_tr_b16 v[148:149], v12 offset:4096
  ds_read_b64_tr_b16 v[150:151], v12 offset:5120
  s_waitcnt lgkmcnt(4)
  v_mfma_f32_32x32x16_bf16 v[16:31], v[152:155], v[88:91], v[16:31]
  v_mfma_f32_32x32x16_bf16 v[32:47], v[152:155], v[92:95], v[32:47]
  v_mfma_f32_32x32x16_bf16 v[48:63], v[156:159], v[88:91], v[48:63]
  v_mfma_f32_32x32x16_bf16 v[64:79], v[156:159], v[92:95], v[64:79]
  s_add_u32 m0, s67, 2048
  s_add_u32 s68, s66, 278528
  buffer_load_dwordx4 v8, s[40:43], s68 offen lds
  s_add_u32 m0, s67, 3072
  s_add_u32 s68, s66, 286720
  buffer_load_dwordx4 v8, s[40:43], s68 offen lds
  s_add_u32 s68, s64, 17408
  buffer_load_dwordx4 v[88:91], v5, s[48:51], s68 offen sc0 sc1
  s_add_u32 s68, s65, 17408
  buffer_load_dwordx4 v[92:95], v5, s[48:51], s68 offen sc0 sc1
  s_waitcnt vmcnt(24)
  ds_read_b64_tr_b16 v[152:153], v11 offset:6144
  ds_read_b64_tr_b16 v[154:155], v11 offset:7168
  ds_read_b64_tr_b16 v[156:157], v12 offset:6144
  ds_read_b64_tr_b16 v[158:159], v12 offset:7168
  s_waitcnt lgkmcnt(4)
  v_mfma_f32_32x32x16_bf16 v[16:31], v[144:147], v[96:99], v[16:31]
  v_mfma_f32_32x32x16_bf16 v[32:47], v[144:147], v[100:103], v[32:47]
  v_mfma_f32_32x32x16_bf16 v[48:63], v[148:151], v[96:99], v[48:63]
  v_mfma_f32_32x32x16_bf16 v[64:79], v[148:151], v[100:103], v[64:79]
  s_add_u32 m0, s67, 4096
  s_add_u32 s68, s66, 294912
  buffer_load_dwordx4 v8, s[40:43], s68 offen lds
  s_add_u32 m0, s67, 5120
  s_add_u32 s68, s66, 303104
  buffer_load_dwordx4 v8, s[40:43], s68 offen lds
  s_add_u32 s68, s64, 18432
  buffer_load_dwordx4 v[96:99], v5, s[48:51], s68 offen sc0 sc1
  s_add_u32 s68, s65, 18432
  buffer_load_dwordx4 v[100:103], v5, s[48:51], s68 offen sc0 sc1
  s_waitcnt vmcnt(24)
  ds_read_b64_tr_b16 v[144:145], v11 offset:8192
  ds_read_b64_tr_b16 v[146:147], v11 offset:9216
  ds_read_b64_tr_b16 v[148:149], v12 offset:8192
  ds_read_b64_tr_b16 v[150:151], v12 offset:9216
  s_waitcnt lgkmcnt(4)
  v_mfma_f32_32x32x16_bf16 v[16:31], v[152:155], v[104:107], v[16:31]
  v_mfma_f32_32x32x16_bf16 v[32:47], v[152:155], v[108:111], v[32:47]
  v_mfma_f32_32x32x16_bf16 v[48:63], v[156:159], v[104:107], v[48:63]
  v_mfma_f32_32x32x16_bf16 v[64:79], v[156:159], v[108:111], v[64:79]
  s_add_u32 m0, s67, 6144
  s_add_u32 s68, s66, 311296
  buffer_load_dwordx4 v8, s[40:43], s68 offen lds
  s_add_u32 m0, s67, 7168
  s_add_u32 s68, s66, 319488
  buffer_load_dwordx4 v8, s[40:43], s68 offen lds
  s_add_u32 s68, s64, 19456
  buffer_load_dwordx4 v[104:107], v5, s[48:51], s68 offen sc0 sc1
  s_add_u32 s68, s65, 19456
  buffer_load_dwordx4 v[108:111], v5, s[48:51], s68 offen sc0 sc1
  s_waitcnt vmcnt(24)
  ds_read_b64_tr_b16 v[152:153], v11 offset:10240
  ds_read_b64_tr_b16 v[154:155], v11 offset:11264
  ds_read_b64_tr_b16 v[156:157], v12 offset:10240
  ds_read_b64_tr_b16 v[158:159], v12 offset:11264
  s_waitcnt lgkmcnt(4)
  v_mfma_f32_32x32x16_bf16 v[16:31], v[144:147], v[112:115], v[16:31]
  v_mfma_f32_32x32x16_bf16 v[32:47], v[144:147], v[116:119], v[32:47]
  v_mfma_f32_32x32x16_bf16 v[48:63], v[148:151], v[112:115], v[48:63]
  v_mfma_f32_32x32x16_bf16 v[64:79], v[148:151], v[116:119], v[64:79]
  s_add_u32 m0, s67, 8192
  s_add_u32 s68, s66, 327680
  buffer_load_dwordx4 v8, s[40:43], s68 offen lds
  s_add_u32 m0, s67, 9216
  s_add_u32 s68, s66, 335872
  buffer_load_dwordx4 v8, s[40:43], s68 offen lds
  s_add_u32 s68, s64, 20480
  buffer_load_dwordx4 v[112:115], v5, s[48:51], s68 offen sc0 sc1
  s_add_u32 s68, s65, 20480
  buffer_load_dwordx4 v[116:119], v5, s[48:51], s68 offen sc0 sc1
  s_waitcnt vmcnt(24)
  ds_read_b64_tr_b16 v[144:145], v11 offset:12288
  ds_read_b64_tr_b16 v[146:147], v11 offset:13312
  ds_read_b64_tr_b16 v[148:149], v12 offset:12288
  ds_read_b64_tr_b16 v[150:151], v12 offset:13312
  s_waitcnt lgkmcnt(4)
  v_mfma_f32_32x32x16_bf16 v[16:31], v[152:155], v[120:123], v[16:31]
  v_mfma_f32_32x32x16_bf16 v[32:47], v[152:155], v[124:127], v[32:47]
  v_mfma_f32_32x32x16_bf16 v[48:63], v[156:159], v[120:123], v[48:63]
  v_mfma_f32_32x32x16_bf16 v[64:79], v[156:159], v[124:127], v[64:79]
  s_cmp_ge_u32 s60, 2
  s_cselect_b32 s69, 20, 21
  s_lshl_b32 s70, s69, 10
  s_lshl_b32 s69, s69, 14
  s_add_u32 m0, s67, 10240
  s_add_u32 s68, s66, s69
  buffer_load_dwordx4 v8, s[40:43], s68 offen lds
  s_add_u32 m0, s67, 11264
  s_add_u32 s68, s66, s69
  s_add_u32 s68, s68, 8192
  buffer_load_dwordx4 v8, s[40:43], s68 offen lds
  s_add_u32 s68, s64, s70
  buffer_load_dwordx4 v[120:123], v5, s[48:51], s68 offen sc0 sc1
  s_add_u32 s68, s65, s70
  buffer_load_dwordx4 v[124:127], v5, s[48:51], s68 offen sc0 sc1
  s_waitcnt vmcnt(24)
  ds_read_b64_tr_b16 v[152:153], v11 offset:14336
  ds_read_b64_tr_b16 v[154:155], v11 offset:15360
  ds_read_b64_tr_b16 v[156:157], v12 offset:14336
  ds_read_b64_tr_b16 v[158:159], v12 offset:15360
  s_waitcnt lgkmcnt(4)
  v_mfma_f32_32x32x16_bf16 v[16:31], v[144:147], v[128:131], v[16:31]
  v_mfma_f32_32x32x16_bf16 v[32:47], v[144:147], v[132:135], v[32:47]
  v_mfma_f32_32x32x16_bf16 v[48:63], v[148:151], v[128:131], v[48:63]
  v_mfma_f32_32x32x16_bf16 v[64:79], v[148:151], v[132:135], v[64:79]
  s_add_u32 m0, s67, 12288
  s_add_u32 s68, s4, 0
  buffer_load_dwordx4 v8, s[44:47], s68 offen lds
  s_add_u32 m0, s67, 13312
  s_add_u32 s68, s4, 8192
  buffer_load_dwordx4 v8, s[44:47], s68 offen lds
  s_waitcnt vmcnt(22)
  ds_read_b64_tr_b16 v[144:145], v11 offset:0
  ds_read_b64_tr_b16 v[146:147], v11 offset:1024
  ds_read_b64_tr_b16 v[148:149], v12 offset:0
  ds_read_b64_tr_b16 v[150:151], v12 offset:1024
  s_waitcnt lgkmcnt(4)
  v_mfma_f32_32x32x16_bf16 v[16:31], v[152:155], v[136:139], v[16:31]
  v_mfma_f32_32x32x16_bf16 v[32:47], v[152:155], v[140:143], v[32:47]
  v_mfma_f32_32x32x16_bf16 v[48:63], v[156:159], v[136:139], v[48:63]
  v_mfma_f32_32x32x16_bf16 v[64:79], v[156:159], v[140:143], v[64:79]
  s_add_u32 m0, s67, 14336
  s_add_u32 s68, s4, 16384
  buffer_load_dwordx4 v8, s[44:47], s68 offen lds
  s_add_u32 m0, s67, 15360
  s_add_u32 s68, s4, 24576
  buffer_load_dwordx4 v8, s[44:47], s68 offen lds
  s_waitcnt vmcnt(20)
  ds_read_b64_tr_b16 v[152:153], v11 offset:2048
  ds_read_b64_tr_b16 v[154:155], v11 offset:3072
  ds_read_b64_tr_b16 v[156:157], v12 offset:2048
  ds_read_b64_tr_b16 v[158:159], v12 offset:3072
  s_waitcnt lgkmcnt(4)
  v_mfma_f32_32x32x16_bf16 v[16:31], v[144:147], v[80:83], v[16:31]
  v_mfma_f32_32x32x16_bf16 v[32:47], v[144:147], v[84:87], v[32:47]
  v_mfma_f32_32x32x16_bf16 v[48:63], v[148:151], v[80:83], v[48:63]
  v_mfma_f32_32x32x16_bf16 v[64:79], v[148:151], v[84:87], v[64:79]
  s_add_u32 m0, s67, 0
  s_add_u32 s68, s4, 32768
  buffer_load_dwordx4 v8, s[44:47], s68 offen lds
  s_add_u32 m0, s67, 1024
  s_add_u32 s68, s4, 40960
  buffer_load_dwordx4 v8, s[44:47], s68 offen lds
  s_waitcnt vmcnt(18)
  ds_read_b64_tr_b16 v[144:145], v11 offset:4096
  ds_read_b64_tr_b16 v[146:147], v11 offset:5120
  ds_read_b64_tr_b16 v[148:149], v12 offset:4096
  ds_read_b64_tr_b16 v[150:151], v12 offset:5120
  s_waitcnt lgkmcnt(4)
  v_mfma_f32_32x32x16_bf16 v[16:31], v[152:155], v[88:91], v[16:31]
  v_mfma_f32_32x32x16_bf16 v[32:47], v[152:155], v[92:95], v[32:47]
  v_mfma_f32_32x32x16_bf16 v[48:63], v[156:159], v[88:91], v[48:63]
  v_mfma_f32_32x32x16_bf16 v[64:79], v[156:159], v[92:95], v[64:79]
  s_add_u32 m0, s67, 2048
  s_add_u32 s68, s4, 49152
  buffer_load_dwordx4 v8, s[44:47], s68 offen lds
  s_add_u32 m0, s67, 3072
  s_add_u32 s68, s4, 57344
  buffer_load_dwordx4 v8, s[44:47], s68 offen lds
  s_waitcnt vmcnt(16)
  ds_read_b64_tr_b16 v[152:153], v11 offset:6144
  ds_read_b64_tr_b16 v[154:155], v11 offset:7168
  ds_read_b64_tr_b16 v[156:157], v12 offset:6144
  ds_read_b64_tr_b16 v[158:159], v12 offset:7168
  s_waitcnt lgkmcnt(4)
  v_mfma_f32_32x32x16_bf16 v[16:31], v[144:147], v[96:99], v[16:31]
  v_mfma_f32_32x32x16_bf16 v[32:47], v[144:147], v[100:103], v[32:47]
  v_mfma_f32_32x32x16_bf16 v[48:63], v[148:151], v[96:99], v[48:63]
  v_mfma_f32_32x32x16_bf16 v[64:79], v[148:151], v[100:103], v[64:79]
  s_add_u32 m0, s67, 4096
  s_add_u32 s68, s4, 65536
  buffer_load_dwordx4 v8, s[44:47], s68 offen lds
  s_add_u32 m0, s67, 5120
  s_add_u32 s68, s4, 73728
  buffer_load_dwordx4 v8, s[44:47], s68 offen lds
  s_waitcnt vmcnt(14)
  ds_read_b64_tr_b16 v[144:145], v11 offset:8192
  ds_read_b64_tr_b16 v[146:147], v11 offset:9216
  ds_read_b64_tr_b16 v[148:149], v12 offset:8192
  ds_read_b64_tr_b16 v[150:151], v12 offset:9216
  s_waitcnt lgkmcnt(4)
  v_mfma_f32_32x32x16_bf16 v[16:31], v[152:155], v[104:107], v[16:31]
  v_mfma_f32_32x32x16_bf16 v[32:47], v[152:155], v[108:111], v[32:47]
  v_mfma_f32_32x32x16_bf16 v[48:63], v[156:159], v[104:107], v[48:63]
  v_mfma_f32_32x32x16_bf16 v[64:79], v[156:159], v[108:111], v[64:79]
  s_add_u32 m0, s67, 6144
  s_add_u32 s68, s4, 81920
  buffer_load_dwordx4 v8, s[44:47], s68 offen lds
  s_add_u32 m0, s67, 7168
  s_add_u32 s68, s4, 90112
  buffer_load_dwordx4 v8, s[44:47], s68 offen lds
  s_waitcnt vmcnt(12)
  ds_read_b64_tr_b16 v[152:153], v11 offset:10240
  ds_read_b64_tr_b16 v[154:155], v11 offset:11264
  ds_read_b64_tr_b16 v[156:157], v12 offset:10240
  ds_read_b64_tr_b16 v[158:159], v12 offset:11264
  s_waitcnt lgkmcnt(4)
  v_mfma_f32_32x32x16_bf16 v[16:31], v[144:147], v[112:115], v[16:31]
  v_mfma_f32_32x32x16_bf16 v[32:47], v[144:147], v[116:119], v[32:47]
  v_mfma_f32_32x32x16_bf16 v[48:63], v[148:151], v[112:115], v[48:63]
  v_mfma_f32_32x32x16_bf16 v[64:79], v[148:151], v[116:119], v[64:79]
  s_add_u32 m0, s67, 8192
  s_add_u32 s68, s4, 98304
  buffer_load_dwordx4 v8, s[44:47], s68 offen lds
  s_add_u32 m0, s67, 9216
  s_add_u32 s68, s4, 106496
  buffer_load_dwordx4 v8, s[44:47], s68 offen lds
  s_waitcnt vmcnt(12)
  ds_read_b64_tr_b16 v[144:145], v11 offset:12288
  ds_read_b64_tr_b16 v[146:147], v11 offset:13312
  ds_read_b64_tr_b16 v[148:149], v12 offset:12288
  ds_read_b64_tr_b16 v[150:151], v12 offset:13312
  s_waitcnt lgkmcnt(4)
  s_cmp_ge_u32 s60, 2
  s_cbranch_scc1 k2_mix_kernel_D_skiplast
  v_mfma_f32_32x32x16_bf16 v[16:31], v[152:155], v[120:123], v[16:31]
  v_mfma_f32_32x32x16_bf16 v[32:47], v[152:155], v[124:127], v[32:47]
  v_mfma_f32_32x32x16_bf16 v[48:63], v[156:159], v[120:123], v[48:63]
  v_mfma_f32_32x32x16_bf16 v[64:79], v[156:159], v[124:127], v[64:79]
k2_mix_kernel_D_skiplast:
  s_add_u32 m0, s67, 10240
  s_add_u32 s68, s4, 114688
  buffer_load_dwordx4 v8, s[44:47], s68 offen lds
  s_add_u32 m0, s67, 11264
  s_add_u32 s68, s4, 122880
  buffer_load_dwordx4 v8, s[44:47], s68 offen lds
  s_setprio 3
  s_setprio 0
  v_lshlrev_b32 v13, 2, v3
  buffer_load_dword v9, v13, s[48:51], s7 offen sc0 sc1
  buffer_load_dword v10, v13, s[48:51], s7 offen offset:128 sc0 sc1
  s_lshr_b32 s72, s60, 1
  s_and_b32 s71, s60, 1
  s_lshl_b32 s68, s72, 15
  s_sub_u32 s68, s68, s67
  s_lshl_b32 s69, s72, 6
  v_add_u32 v11, s68, v11
  v_xor_b32 v11, s69, v11
  v_xor_b32 v12, 64, v11
  s_lshl_b32 s5, s61, 1
  s_add_u32 s5, s5, s71
  s_lshl_b32 s5, s5, 5
  s_lshl_b32 s6, s72, 4
  s_add_u32 s5, s5, s6
  s_lshl_b32 s5, s5, 10
  s_add_u32 s5, s5, 14680064
  s_waitcnt vmcnt(0)
  s_barrier
  ds_read_b64_tr_b16 v[80:81], v11 offset:12288
  ds_read_b64_tr_b16 v[82:83], v11 offset:13312
  ds_read_b64_tr_b16 v[84:85], v12 offset:12288
  ds_read_b64_tr_b16 v[86:87], v12 offset:13312
  ds_read_b64_tr_b16 v[88:89], v11 offset:14336
  ds_read_b64_tr_b16 v[90:91], v11 offset:15360
  ds_read_b64_tr_b16 v[92:93], v12 offset:14336
  ds_read_b64_tr_b16 v[94:95], v12 offset:15360
  ds_read_b64_tr_b16 v[96:97], v11 offset:0
  ds_read_b64_tr_b16 v[98:99], v11 offset:1024
  ds_read_b64_tr_b16 v[100:101], v12 offset:0
  ds_read_b64_tr_b16 v[102:103], v12 offset:1024
  ds_read_b64_tr_b16 v[104:105], v11 offset:2048
  ds_read_b64_tr_b16 v[106:107], v11 offset:3072
  ds_read_b64_tr_b16 v[108:109], v12 offset:2048
  ds_read_b64_tr_b16 v[110:111], v12 offset:3072
  ds_read_b64_tr_b16 v[112:113], v11 offset:4096
  ds_read_b64_tr_b16 v[114:115], v11 offset:5120
  ds_read_b64_tr_b16 v[116:117], v12 offset:4096
  ds_read_b64_tr_b16 v[118:119], v12 offset:5120
  ds_read_b64_tr_b16 v[120:121], v11 offset:6144
  ds_read_b64_tr_b16 v[122:123], v11 offset:7168
  ds_read_b64_tr_b16 v[124:125], v12 offset:6144
  ds_read_b64_tr_b16 v[126:127], v12 offset:7168
  ds_read_b64_tr_b16 v[128:129], v11 offset:8192
  ds_read_b64_tr_b16 v[130:131], v11 offset:9216
  ds_read_b64_tr_b16 v[132:133], v12 offset:8192
  ds_read_b64_tr_b16 v[134:135], v12 offset:9216
  ds_read_b64_tr_b16 v[136:137], v11 offset:10240
  ds_read_b64_tr_b16 v[138:139], v11 offset:11264
  ds_read_b64_tr_b16 v[140:141], v12 offset:10240
  ds_read_b64_tr_b16 v[142:143], v12 offset:11264
  ds_read_b64_tr_b16 v[144:145], v11 offset:28672
  ds_read_b64_tr_b16 v[146:147], v11 offset:29696
  ds_read_b64_tr_b16 v[148:149], v12 offset:28672
  ds_read_b64_tr_b16 v[150:151], v12 offset:29696
  ds_read_b64_tr_b16 v[152:153], v11 offset:30720
  ds_read_b64_tr_b16 v[154:155], v11 offset:31744
  ds_read_b64_tr_b16 v[156:157], v12 offset:30720
  ds_read_b64_tr_b16 v[158:159], v12 offset:31744
  ds_read_b64_tr_b16 v[160:161], v11 offset:16384
  ds_read_b64_tr_b16 v[162:163], v11 offset:17408
  ds_read_b64_tr_b16 v[164:165], v12 offset:16384
  ds_read_b64_tr_b16 v[166:167], v12 offset:17408
  ds_read_b64_tr_b16 v[168:169], v11 offset:18432
  ds_read_b64_tr_b16 v[170:171], v11 offset:19456
  ds_read_b64_tr_b16 v[172:173], v12 offset:18432
  ds_read_b64_tr_b16 v[174:175], v12 offset:19456
  ds_read_b64_tr_b16 v[176:177], v11 offset:20480
  ds_read_b64_tr_b16 v[178:179], v11 offset:21504
  ds_read_b64_tr_b16 v[180:181], v12 offset:20480
  ds_read_b64_tr_b16 v[182:183], v12 offset:21504
  ds_read_b64_tr_b16 v[184:185], v11 offset:22528
  ds_read_b64_tr_b16 v[186:187], v11 offset:23552
  ds_read_b64_tr_b16 v[188:189], v12 offset:22528
  ds_read_b64_tr_b16 v[190:191], v12 offset:23552
  ds_read_b64_tr_b16 v[192:193], v11 offset:24576
  ds_read_b64_tr_b16 v[194:195], v11 offset:25600
  ds_read_b64_tr_b16 v[196:197], v12 offset:24576
  ds_read_b64_tr_b16 v[198:199], v12 offset:25600
  ds_read_b64_tr_b16 v[200:201], v11 offset:26624
  ds_read_b64_tr_b16 v[202:203], v11 offset:27648
  ds_read_b64_tr_b16 v[204:205], v12 offset:26624
  ds_read_b64_tr_b16 v[206:207], v12 offset:27648
  s_lshl_b32 s68, s60, 12
  v_add_u32 v6, s68, v5
  s_waitcnt lgkmcnt(0)
  s_barrier
  ds_write_b128 v6, v[16:19] offset:0
  ds_write_b128 v6, v[20:23] offset:1024
  ds_write_b128 v6, v[24:27] offset:2048
  ds_write_b128 v6, v[28:31] offset:3072
  ds_write_b128 v6, v[32:35] offset:16384
  ds_write_b128 v6, v[36:39] offset:17408
  ds_write_b128 v6, v[40:43] offset:18432
  ds_write_b128 v6, v[44:47] offset:19456
  ds_write_b128 v6, v[48:51] offset:32768
  ds_write_b128 v6, v[52:55] offset:33792
  ds_write_b128 v6, v[56:59] offset:34816
  ds_write_b128 v6, v[60:63] offset:35840
  ds_write_b128 v6, v[64:67] offset:49152
  ds_write_b128 v6, v[68:71] offset:50176
  ds_write_b128 v6, v[72:75] offset:51200
  ds_write_b128 v6, v[76:79] offset:52224
  s_waitcnt lgkmcnt(0)
  s_barrier
  s_lshl_b32 s68, s60, 14
  v_add_u32 v6, s68, v5
  ds_read_b128 v[16:19], v6 offset:0
  ds_read_b128 v[20:23], v6 offset:1024
  ds_read_b128 v[24:27], v6 offset:2048
  ds_read_b128 v[28:31], v6 offset:3072
  ds_read_b128 v[32:35], v6 offset:4096
  ds_read_b128 v[36:39], v6 offset:5120
  ds_read_b128 v[40:43], v6 offset:6144
  ds_read_b128 v[44:47], v6 offset:7168
  ds_read_b128 v[48:51], v6 offset:8192
  ds_read_b128 v[52:55], v6 offset:9216
  ds_read_b128 v[56:59], v6 offset:10240
  ds_read_b128 v[60:63], v6 offset:11264
  ds_read_b128 v[64:67], v6 offset:12288
  ds_read_b128 v[68:71], v6 offset:13312
  ds_read_b128 v[72:75], v6 offset:14336
  ds_read_b128 v[76:79], v6 offset:15360
  s_cmp_lg_u32 s71, 0
  s_cselect_b64 vcc, -1, 0
  v_cndmask_b32 v9, v9, v10, vcc
  v_sub_f32 v9, 1.0, v9
  s_waitcnt lgkmcnt(8)
  v_add_f32 v16, v16, v32
  v_add_f32 v17, v17, v33
  v_add_f32 v18, v18, v34
  v_add_f32 v19, v19, v35
  v_add_f32 v20, v20, v36
  v_add_f32 v21, v21, v37
  v_add_f32 v22, v22, v38
  v_add_f32 v23, v23, v39
  v_add_f32 v24, v24, v40
  v_add_f32 v25, v25, v41
  v_add_f32 v26, v26, v42
  v_add_f32 v27, v27, v43
  v_add_f32 v28, v28, v44
  v_add_f32 v29, v29, v45
  v_add_f32 v30, v30, v46
  v_add_f32 v31, v31, v47
  s_waitcnt lgkmcnt(0)
  v_add_f32 v48, v48, v64
  v_add_f32 v49, v49, v65
  v_add_f32 v50, v50, v66
  v_add_f32 v51, v51, v67
  v_add_f32 v52, v52, v68
  v_add_f32 v53, v53, v69
  v_add_f32 v54, v54, v70
  v_add_f32 v55, v55, v71
  v_add_f32 v56, v56, v72
  v_add_f32 v57, v57, v73
  v_add_f32 v58, v58, v74
  v_add_f32 v59, v59, v75
  v_add_f32 v60, v60, v76
  v_add_f32 v61, v61, v77
  v_add_f32 v62, v62, v78
  v_add_f32 v63, v63, v79
  v_add_f32 v16, v16, v48
  v_add_f32 v17, v17, v49
  v_add_f32 v18, v18, v50
  v_add_f32 v19, v19, v51
  v_add_f32 v20, v20, v52
  v_add_f32 v21, v21, v53
  v_add_f32 v22, v22, v54
  v_add_f32 v23, v23, v55
  v_add_f32 v24, v24, v56
  v_add_f32 v25, v25, v57
  v_add_f32 v26, v26, v58
  v_add_f32 v27, v27, v59
  v_add_f32 v28, v28, v60
  v_add_f32 v29, v29, v61
  v_add_f32 v30, v30, v62
  v_add_f32 v31, v31, v63
  v_mul_f32 v16, v16, v9
  v_mul_f32 v17, v17, v9
  v_mul_f32 v18, v18, v9
  v_mul_f32 v19, v19, v9
  v_mul_f32 v20, v20, v9
  v_mul_f32 v21, v21, v9
  v_mul_f32 v22, v22, v9
  v_mul_f32 v23, v23, v9
  v_mul_f32 v24, v24, v9
  v_mul_f32 v25, v25, v9
  v_mul_f32 v26, v26, v9
  v_mul_f32 v27, v27, v9
  v_mul_f32 v28, v28, v9
  v_mul_f32 v29, v29, v9
  v_mul_f32 v30, v30, v9
  v_mul_f32 v31, v31, v9
  s_lshl_b32 s73, s61, 1
  s_add_u32 s73, s73, s71
  s_lshl_b32 s74, s62, 1
  s_add_u32 s74, s74, s72
  s_lshl_b32 s73, s73, 15
  s_lshl_b32 s74, s74, 6
  s_add_u32 s73, s73, s74
  s_xor_b32 s68, s60, 2
  s_lshl_b32 s68, s68, 12
  v_add_u32 v13, s68, v5
  s_lshl_b32 s68, s60, 12
  v_add_u32 v14, s68, v5
  s_setprio 3
  s_cmp_lg_u32 s60, 0
  s_cbranch_scc1 k2_mix_kernel_WA_wdone
  v_mov_b32 v6, 0
  s_mov_b32 s58, 0
k2_mix_kernel_WA_poll:
  buffer_load_dword v7, v6, s[48:51], s3 offen sc0 sc1
  s_waitcnt vmcnt(0)
  v_readfirstlane_b32 s57, v7
  s_nop 3
  s_cmp_ge_u32 s57, 32
  s_cbranch_scc1 k2_mix_kernel_WA_wdone
  s_add_u32 s58, s58, 1
  s_cmp_lt_u32 s58, 65536
  s_cbranch_scc1 k2_mix_kernel_WA_poll
k2_mix_kernel_WA_wdone:
  s_barrier
  s_add_u32 s68, s5, 0
  s_add_u32 s69, s5, 4096
  s_add_u32 s70, s5, 8192
  s_add_u32 s71, s5, 12288
  buffer_load_dwordx4 v[48:51], v5, s[48:51], s68 offen offset:0 sc0 sc1
  buffer_load_dwordx4 v[52:55], v5, s[48:51], s68 offen offset:1024 sc0 sc1
  buffer_load_dwordx4 v[56:59], v5, s[48:51], s68 offen offset:2048 sc0 sc1
  buffer_load_dwordx4 v[60:63], v5, s[48:51], s68 offen offset:3072 sc0 sc1
  buffer_load_dwordx4 v[64:67], v5, s[48:51], s69 offen offset:0 sc0 sc1
  buffer_load_dwordx4 v[68:71], v5, s[48:51], s69 offen offset:1024 sc0 sc1
  buffer_load_dwordx4 v[72:75], v5, s[48:51], s69 offen offset:2048 sc0 sc1
  buffer_load_dwordx4 v[76:79], v5, s[48:51], s69 offen offset:3072 sc0 sc1
  buffer_load_dwordx4 v[208:211], v5, s[48:51], s70 offen offset:0 sc0 sc1
  buffer_load_dwordx4 v[212:215], v5, s[48:51], s70 offen offset:1024 sc0 sc1
  buffer_load_dwordx4 v[216:219], v5, s[48:51], s70 offen offset:2048 sc0 sc1
  buffer_load_dwordx4 v[220:223], v5, s[48:51], s70 offen offset:3072 sc0 sc1
  buffer_load_dwordx4 v[224:227], v5, s[48:51], s71 offen offset:0 sc0 sc1
  buffer_load_dwordx4 v[228:231], v5, s[48:51], s71 offen offset:1024 sc0 sc1
  buffer_load_dwordx4 v[232:235], v5, s[48:51], s71 offen offset:2048 sc0 sc1
  buffer_load_dwordx4 v[236:239], v5, s[48:51], s71 offen offset:3072 sc0 sc1
  v_lshlrev_b32 v6, 10, v3
  v_lshlrev_b32 v7, 5, v4
  v_add_u32 v6, v6, v7
  s_waitcnt vmcnt(15)
  v_mfma_f32_32x32x16_bf16 v[32:47], v[84:87], v[48:51], 0
  v_mfma_f32_32x32x16_bf16 v[16:31], v[80:83], v[48:51], v[16:31]
  s_waitcnt vmcnt(14)
  v_mfma_f32_32x32x16_bf16 v[32:47], v[92:95], v[52:55], v[32:47]
  v_mfma_f32_32x32x16_bf16 v[16:31], v[88:91], v[52:55], v[16:31]
  s_waitcnt vmcnt(13)
  v_mfma_f32_32x32x16_bf16 v[32:47], v[100:103], v[56:59], v[32:47]
  v_mfma_f32_32x32x16_bf16 v[16:31], v[96:99], v[56:59], v[16:31]
  s_waitcnt vmcnt(12)
  v_mfma_f32_32x32x16_bf16 v[32:47], v[108:111], v[60:63], v[32:47]
  v_mfma_f32_32x32x16_bf16 v[16:31], v[104:107], v[60:63], v[16:31]
  s_waitcnt vmcnt(11)
  v_mfma_f32_32x32x16_bf16 v[32:47], v[116:119], v[64:67], v[32:47]
  v_mfma_f32_32x32x16_bf16 v[16:31], v[112:115], v[64:67], v[16:31]
  s_waitcnt vmcnt(10)
  v_mfma_f32_32x32x16_bf16 v[32:47], v[124:127], v[68:71], v[32:47]
  v_mfma_f32_32x32x16_bf16 v[16:31], v[120:123], v[68:71], v[16:31]
  s_waitcnt vmcnt(9)
  v_mfma_f32_32x32x16_bf16 v[32:47], v[132:135], v[72:75], v[32:47]
  v_mfma_f32_32x32x16_bf16 v[16:31], v[128:131], v[72:75], v[16:31]
  s_waitcnt vmcnt(8)
  v_mfma_f32_32x32x16_bf16 v[32:47], v[140:143], v[76:79], v[32:47]
  v_mfma_f32_32x32x16_bf16 v[16:31], v[136:139], v[76:79], v[16:31]
  s_waitcnt vmcnt(7)
  v_mfma_f32_32x32x16_bf16 v[32:47], v[148:151], v[208:211], v[32:47]
  v_mfma_f32_32x32x16_bf16 v[16:31], v[144:147], v[208:211], v[16:31]
  s_waitcnt vmcnt(6)
  v_mfma_f32_32x32x16_bf16 v[32:47], v[156:159], v[212:215], v[32:47]
  v_mfma_f32_32x32x16_bf16 v[16:31], v[152:155], v[212:215], v[16:31]
  s_waitcnt vmcnt(5)
  v_mfma_f32_32x32x16_bf16 v[32:47], v[164:167], v[216:219], v[32:47]
  v_mfma_f32_32x32x16_bf16 v[16:31], v[160:163], v[216:219], v[16:31]
  s_waitcnt vmcnt(4)
  v_mfma_f32_32x32x16_bf16 v[32:47], v[172:175], v[220:223], v[32:47]
  v_mfma_f32_32x32x16_bf16 v[16:31], v[168:171], v[220:223], v[16:31]
  s_waitcnt vmcnt(3)
  v_mfma_f32_32x32x16_bf16 v[32:47], v[180:183], v[224:227], v[32:47]
  v_mfma_f32_32x32x16_bf16 v[16:31], v[176:179], v[224:227], v[16:31]
  s_waitcnt vmcnt(2)
  v_mfma_f32_32x32x16_bf16 v[32:47], v[188:191], v[228:231], v[32:47]
  v_mfma_f32_32x32x16_bf16 v[16:31], v[184:187], v[228:231], v[16:31]
  s_waitcnt vmcnt(1)
  v_mfma_f32_32x32x16_bf16 v[32:47], v[196:199], v[232:235], v[32:47]
  v_mfma_f32_32x32x16_bf16 v[16:31], v[192:195], v[232:235], v[16:31]
  s_waitcnt vmcnt(0)
  v_mfma_f32_32x32x16_bf16 v[32:47], v[204:207], v[236:239], v[32:47]
  v_mfma_f32_32x32x16_bf16 v[16:31], v[200:203], v[236:239], v[16:31]
  s_nop 7
  s_nop 2
  ds_write_b128 v13, v[32:35] offset:0
  ds_write_b128 v13, v[36:39] offset:1024
  ds_write_b128 v13, v[40:43] offset:2048
  ds_write_b128 v13, v[44:47] offset:3072
  s_waitcnt lgkmcnt(0)
  s_barrier
  ds_read_b128 v[32:35], v14 offset:0
  ds_read_b128 v[36:39], v14 offset:1024
  ds_read_b128 v[40:43], v14 offset:2048
  ds_read_b128 v[44:47], v14 offset:3072
  s_waitcnt lgkmcnt(3)
  v_add_f32 v16, v16, v32
  v_add_f32 v17, v17, v33
  v_add_f32 v18, v18, v34
  v_add_f32 v19, v19, v35
  s_waitcnt lgkmcnt(2)
  v_add_f32 v20, v20, v36
  v_add_f32 v21, v21, v37
  v_add_f32 v22, v22, v38
  v_add_f32 v23, v23, v39
  s_waitcnt lgkmcnt(1)
  v_add_f32 v24, v24, v40
  v_add_f32 v25, v25, v41
  v_add_f32 v26, v26, v42
  v_add_f32 v27, v27, v43
  s_waitcnt lgkmcnt(0)
  v_add_f32 v28, v28, v44
  v_add_f32 v29, v29, v45
  v_add_f32 v30, v30, v46
  v_add_f32 v31, v31, v47
  v_cvt_pk_bf16_f32 v48, v16, v17
  v_cvt_pk_bf16_f32 v49, v18, v19
  v_cvt_pk_bf16_f32 v50, v20, v21
  v_cvt_pk_bf16_f32 v51, v22, v23
  v_cvt_pk_bf16_f32 v52, v24, v25
  v_cvt_pk_bf16_f32 v53, v26, v27
  v_cvt_pk_bf16_f32 v54, v28, v29
  v_cvt_pk_bf16_f32 v55, v30, v31
  buffer_store_dwordx4 v[48:51], v6, s[52:55], s73 offen
  buffer_store_dwordx4 v[52:55], v6, s[52:55], s73 offen offset:16
k2_mix_kernel_end:
  s_endpgm
.section .rodata,"a"
.p2align 6
.amdhsa_kernel k1_qkv_kernel
  .amdhsa_next_free_vgpr 164
  .amdhsa_next_free_sgpr 96
  .amdhsa_accum_offset 164
  .amdhsa_group_segment_fixed_size 0
  .amdhsa_kernarg_size 88
  .amdhsa_user_sgpr_count 2
  .amdhsa_user_sgpr_kernarg_segment_ptr 1
  .amdhsa_system_sgpr_workgroup_id_x 1
.end_amdhsa_kernel
.p2align 6
.amdhsa_kernel k2_mix_kernel
  .amdhsa_next_free_vgpr 240
  .amdhsa_next_free_sgpr 96
  .amdhsa_accum_offset 240
  .amdhsa_group_segment_fixed_size 0
  .amdhsa_kernarg_size 88
  .amdhsa_user_sgpr_count 2
  .amdhsa_user_sgpr_kernarg_segment_ptr 1
  .amdhsa_system_sgpr_workgroup_id_x 1
.end_amdhsa_kernel
```
